```python
import torch

def _softmax(x, axis=-1):
    return torch.softmax(x, dim=axis)

def _gelu(x):
    return torch.nn.functional.gelu(x, approximate='tanh')

def _silu(x):
    return torch.nn.functional.silu(x)

def _sigmoid(x):
    return torch.sigmoid(x)

def _layernorm(x, axis=-1, eps=1e-05):
    m = x.mean(dim=axis, keepdim=True)
    v = x.var(dim=axis, keepdim=True, unbiased=False)
    return (x - m) / torch.sqrt(v + eps)

def _scatter_add(tgt, idx, src, axis=0):
    return tgt.clone().index_add_(axis, idx, src)

def _segment_sum(src, seg, n):
    out = torch.zeros((n,) + src.shape[1:], dtype=src.dtype)
    return out.index_add_(0, seg, src)

def _pad(x, pw):
    flat = tuple((v for pair in reversed(pw) for v in pair))
    return torch.nn.functional.pad(x, flat)
kernel_name = 'recurrent_scan__memory_aug_recurrent_mem_tr__dense_activation_gelu__prompt'

def setup_inputs():

    _w = lambda a: (lambda t: t.to(torch.bfloat16) if t.is_floating_point() else t)(torch.as_tensor(a))

    def _A_setup():
        B, S, Dm = (1, 2048, 640)
        H, Dh = (32, 192)
        M, seg = (8, 32)
        seg = min(seg, S)
        S = S // seg * seg
        return {'x': _w((lambda *s: torch.randn(*s, dtype=torch.bfloat16) * 0.1)(B, S, Dm)), 'mem0': _w((lambda *s: torch.randn(*s, dtype=torch.bfloat16) * 1.6)(B, M, Dm)), 'Wq': _w((lambda *s: torch.randn(*s, dtype=torch.bfloat16) * 0.8)(Dm, H, Dh) * Dm ** (-0.5)), 'Wk': _w((lambda *s: torch.randn(*s, dtype=torch.bfloat16) * 0.8)(Dm, H, Dh) * Dm ** (-0.5)), 'Wv': _w((lambda *s: torch.randn(*s, dtype=torch.bfloat16) * 1.6)(Dm, H, Dh) * Dm ** (-0.5)), 'Wo': _w((lambda *s: torch.randn(*s, dtype=torch.bfloat16) * 1.6)(H, Dh, Dm) * (H * Dh) ** (-0.5)), 'seg_len': seg}
    _A_in = _A_setup()

    def _B_setup():
        B, S, D, F = (1, 2048, 640, 1536)
        return {'x': _w((lambda *s: torch.randn(*s, dtype=torch.bfloat16) * 0.1)(B, S, D)), 'w1': _w((lambda *s: torch.randn(*s, dtype=torch.bfloat16) * 0.4)(D, F) * D ** (-0.5)), 'b1': _w((lambda *s: torch.randn(*s, dtype=torch.bfloat16) * 0.4)(F) * 0.01), 'w2': _w((lambda *s: torch.randn(*s, dtype=torch.bfloat16) * 0.4)(F, D) * F ** (-0.5)), 'b2': _w((lambda *s: torch.randn(*s, dtype=torch.bfloat16) * 0.4)(D) * 0.01)}
    _B_in = _B_setup()
    return {'A_x': _A_in['x'], 'A_mem0': _A_in['mem0'], 'A_Wq': _A_in['Wq'], 'A_Wk': _A_in['Wk'], 'A_Wv': _A_in['Wv'], 'A_Wo': _A_in['Wo'], 'A_seg_len': _A_in['seg_len'], 'B_x': _B_in['x'], 'B_w1': _B_in['w1'], 'B_b1': _B_in['b1'], 'B_w2': _B_in['w2'], 'B_b2': _B_in['b2']}

def reference(A_x, A_mem0, A_Wq, A_Wk, A_Wv, A_Wo, A_seg_len, B_x, B_w1, B_b1, B_w2, B_b2):

    def _A_ref(x, mem0, Wq, Wk, Wv, Wo, seg_len):
        B, S, Dm = x.shape
        H, Dh = (Wq.shape[1], Wq.shape[2])
        M = mem0.shape[1]
        scale = Dh ** (-0.5)
        n_seg = S // seg_len
        L = M + seg_len
        idx = torch.arange(L)
        mask = (idx[:, None] < M) | (idx[:, None] >= idx[None, :])
        mem = mem0
        outs = []
        for s in range(n_seg):
            xs = x[:, s * seg_len:(s + 1) * seg_len, :].clone()
            h = torch.concatenate([mem, xs], axis=1)
            q = torch.einsum('btd,dhe->bhte', h, Wq)
            k = torch.einsum('btd,dhe->bhte', h, Wk)
            v = torch.einsum('btd,dhe->bhte', h, Wv)
            scores = torch.einsum('bhqe,bhke->bhqk', q, k) * scale
            scores = torch.where(mask[None, None], scores, -1000000000.0)
            p = _softmax(scores, axis=-1)
            o = torch.einsum('bhqk,bhke->bhqe', p, v)
            o = torch.einsum('bhte,hed->btd', o, Wo)
            mem = o[:, :M, :].clone()
            outs.append(o[:, M:, :])
        return torch.concatenate(outs, axis=1)

    def _B_ref(x, w1, b1, w2, b2):
        h = torch.einsum('bsd,df->bsf', x, w1) + b1
        h = _gelu(h)
        return torch.einsum('bsf,fd->bsd', h, w2) + b2
    x = A_x
    xn = _layernorm(x, axis=-1)
    s = _A_ref(xn, A_mem0, A_Wq, A_Wk, A_Wv, A_Wo, A_seg_len)
    g = _silu(_B_ref(xn, B_w1, B_b1, B_w2, B_b2))
    return x + s * g
```

```asm
; @launch kernel=mega_kernel grid=(256,1,1) block=(256,1,1) lds=112640
; @launch kernel=final_kernel grid=(640,1,1) block=(256,1,1) lds=0
.amdgcn_target "amdgcn-amd-amdhsa--gfx950"
.text
.p2align 8
.globl mega_kernel
.type mega_kernel,@function
mega_kernel:
    s_cmp_ge_u32 s2, 256
    s_cbranch_scc1 rc_kend_3
    s_load_dwordx2 s[4:5], s[0:1], 16
    s_load_dwordx2 s[6:7], s[0:1], 24
    s_load_dwordx2 s[8:9], s[0:1], 32
    s_load_dwordx2 s[10:11], s[0:1], 40
    s_load_dwordx2 s[12:13], s[0:1], 104
    s_load_dwordx2 s[14:15], s[0:1], 112
    s_waitcnt lgkmcnt(0)
    s_mov_b32 s32, s12
    s_mov_b32 s33, s13
    s_mov_b32 s34, 0x00000100
    s_mov_b32 s35, 0x00020000
    v_lshrrev_b32 v1, 6, v0
    s_nop 0
    v_readfirstlane_b32 s59, v1
    s_mov_b32 s63, 0
    s_getreg_b32 s89, hwreg(HW_REG_XCC_ID)
    s_and_b32 s89, s89, 15
    s_cmp_lg_u32 s59, 3
    s_cbranch_scc1 rc_regdone_4
    s_mov_b64 s[66:67], exec
    s_mov_b64 exec, 1
    v_mov_b32 v2, 1
    v_mov_b32 v3, 1
    s_lshl_b32 s65, s89, 2
    v_mov_b32 v4, s65
    v_mov_b32 v5, 64
    buffer_atomic_add v2, v4, s[32:35], 0 offen sc0
    buffer_atomic_add v3, v5, s[32:35], 0 offen sc0
    v_mov_b32 v6, 98304
    s_waitcnt vmcnt(0)
    ds_write_b64 v6, v[2:3]
    s_waitcnt lgkmcnt(0)
    s_mov_b64 exec, s[66:67]
rc_regdone_4:
    s_load_dwordx2 s[64:65], s[0:1], 0
    s_load_dwordx2 s[66:67], s[0:1], 8
    s_waitcnt lgkmcnt(0)
    s_mov_b32 s68, s64
    s_mov_b32 s69, s65
    s_mov_b32 s70, 0x00280000
    s_mov_b32 s71, 0x00020000
    s_mov_b32 s72, s14
    s_mov_b32 s73, s15
    s_mov_b32 s74, 0x00280000
    s_mov_b32 s75, 0x00020000
    s_add_u32 s76, s14, 0x07a00000
    s_addc_u32 s77, s15, 0
    s_mov_b32 s78, 0x0012a000
    s_mov_b32 s79, 0x00020000
    s_mov_b32 s80, s66
    s_mov_b32 s81, s67
    s_mov_b32 s82, 0x00002800
    s_mov_b32 s83, 0x00020000
    s_add_u32 s84, s14, 0x07b2a000
    s_addc_u32 s85, s15, 0
    s_mov_b32 s86, 0x0000a000
    s_mov_b32 s87, 0x00020000
    s_cmp_ge_u32 s59, 2
    s_cbranch_scc1 in_fill_5
    v_lshrrev_b32 v1, 4, v0
    s_lshl_b32 s3, s2, 3
    v_add_u32 v1, s3, v1
    v_mul_u32_u24 v1, 1280, v1
    v_and_b32 v2, 15, v0
    v_lshl_add_u32 v1, v2, 4, v1
    buffer_load_dwordx4 v[4:7], v1, s[68:71], 0 offen offset:0
    buffer_load_dwordx4 v[8:11], v1, s[68:71], 0 offen offset:256
    buffer_load_dwordx4 v[12:15], v1, s[68:71], 0 offen offset:512
    buffer_load_dwordx4 v[16:19], v1, s[68:71], 0 offen offset:768
    buffer_load_dwordx4 v[20:23], v1, s[68:71], 0 offen offset:1024
    s_waitcnt vmcnt(0)
    v_lshlrev_b32 v32, 16, v4
    v_and_b32 v33, 0xffff0000, v4
    v_lshlrev_b32 v34, 16, v5
    v_and_b32 v35, 0xffff0000, v5
    v_lshlrev_b32 v36, 16, v6
    v_and_b32 v37, 0xffff0000, v6
    v_lshlrev_b32 v38, 16, v7
    v_and_b32 v39, 0xffff0000, v7
    v_lshlrev_b32 v40, 16, v8
    v_and_b32 v41, 0xffff0000, v8
    v_lshlrev_b32 v42, 16, v9
    v_and_b32 v43, 0xffff0000, v9
    v_lshlrev_b32 v44, 16, v10
    v_and_b32 v45, 0xffff0000, v10
    v_lshlrev_b32 v46, 16, v11
    v_and_b32 v47, 0xffff0000, v11
    v_lshlrev_b32 v48, 16, v12
    v_and_b32 v49, 0xffff0000, v12
    v_lshlrev_b32 v50, 16, v13
    v_and_b32 v51, 0xffff0000, v13
    v_lshlrev_b32 v52, 16, v14
    v_and_b32 v53, 0xffff0000, v14
    v_lshlrev_b32 v54, 16, v15
    v_and_b32 v55, 0xffff0000, v15
    v_lshlrev_b32 v56, 16, v16
    v_and_b32 v57, 0xffff0000, v16
    v_lshlrev_b32 v58, 16, v17
    v_and_b32 v59, 0xffff0000, v17
    v_lshlrev_b32 v60, 16, v18
    v_and_b32 v61, 0xffff0000, v18
    v_lshlrev_b32 v62, 16, v19
    v_and_b32 v63, 0xffff0000, v19
    v_lshlrev_b32 v64, 16, v20
    v_and_b32 v65, 0xffff0000, v20
    v_lshlrev_b32 v66, 16, v21
    v_and_b32 v67, 0xffff0000, v21
    v_lshlrev_b32 v68, 16, v22
    v_and_b32 v69, 0xffff0000, v22
    v_lshlrev_b32 v70, 16, v23
    v_and_b32 v71, 0xffff0000, v23
    v_add_f32 v2, v32, v33
    v_add_f32 v2, v2, v34
    v_add_f32 v2, v2, v35
    v_add_f32 v2, v2, v36
    v_add_f32 v2, v2, v37
    v_add_f32 v2, v2, v38
    v_add_f32 v2, v2, v39
    v_add_f32 v2, v2, v40
    v_add_f32 v2, v2, v41
    v_add_f32 v2, v2, v42
    v_add_f32 v2, v2, v43
    v_add_f32 v2, v2, v44
    v_add_f32 v2, v2, v45
    v_add_f32 v2, v2, v46
    v_add_f32 v2, v2, v47
    v_add_f32 v2, v2, v48
    v_add_f32 v2, v2, v49
    v_add_f32 v2, v2, v50
    v_add_f32 v2, v2, v51
    v_add_f32 v2, v2, v52
    v_add_f32 v2, v2, v53
    v_add_f32 v2, v2, v54
    v_add_f32 v2, v2, v55
    v_add_f32 v2, v2, v56
    v_add_f32 v2, v2, v57
    v_add_f32 v2, v2, v58
    v_add_f32 v2, v2, v59
    v_add_f32 v2, v2, v60
    v_add_f32 v2, v2, v61
    v_add_f32 v2, v2, v62
    v_add_f32 v2, v2, v63
    v_add_f32 v2, v2, v64
    v_add_f32 v2, v2, v65
    v_add_f32 v2, v2, v66
    v_add_f32 v2, v2, v67
    v_add_f32 v2, v2, v68
    v_add_f32 v2, v2, v69
    v_add_f32 v2, v2, v70
    v_add_f32 v2, v2, v71
    s_nop 1
    v_add_f32_dpp v2, v2, v2 row_ror:8 row_mask:0xf bank_mask:0xf
    s_nop 1
    v_add_f32_dpp v2, v2, v2 row_ror:4 row_mask:0xf bank_mask:0xf
    s_nop 1
    v_add_f32_dpp v2, v2, v2 row_ror:2 row_mask:0xf bank_mask:0xf
    s_nop 1
    v_add_f32_dpp v2, v2, v2 row_ror:1 row_mask:0xf bank_mask:0xf
    v_mul_f32 v2, 0x3acccccd, v2
    v_sub_f32 v3, v32, v2
    v_mul_f32 v24, v3, v3
    v_sub_f32 v3, v33, v2
    v_fmac_f32 v24, v3, v3
    v_sub_f32 v3, v34, v2
    v_fmac_f32 v24, v3, v3
    v_sub_f32 v3, v35, v2
    v_fmac_f32 v24, v3, v3
    v_sub_f32 v3, v36, v2
    v_fmac_f32 v24, v3, v3
    v_sub_f32 v3, v37, v2
    v_fmac_f32 v24, v3, v3
    v_sub_f32 v3, v38, v2
    v_fmac_f32 v24, v3, v3
    v_sub_f32 v3, v39, v2
    v_fmac_f32 v24, v3, v3
    v_sub_f32 v3, v40, v2
    v_fmac_f32 v24, v3, v3
    v_sub_f32 v3, v41, v2
    v_fmac_f32 v24, v3, v3
    v_sub_f32 v3, v42, v2
    v_fmac_f32 v24, v3, v3
    v_sub_f32 v3, v43, v2
    v_fmac_f32 v24, v3, v3
    v_sub_f32 v3, v44, v2
    v_fmac_f32 v24, v3, v3
    v_sub_f32 v3, v45, v2
    v_fmac_f32 v24, v3, v3
    v_sub_f32 v3, v46, v2
    v_fmac_f32 v24, v3, v3
    v_sub_f32 v3, v47, v2
    v_fmac_f32 v24, v3, v3
    v_sub_f32 v3, v48, v2
    v_fmac_f32 v24, v3, v3
    v_sub_f32 v3, v49, v2
    v_fmac_f32 v24, v3, v3
    v_sub_f32 v3, v50, v2
    v_fmac_f32 v24, v3, v3
    v_sub_f32 v3, v51, v2
    v_fmac_f32 v24, v3, v3
    v_sub_f32 v3, v52, v2
    v_fmac_f32 v24, v3, v3
    v_sub_f32 v3, v53, v2
    v_fmac_f32 v24, v3, v3
    v_sub_f32 v3, v54, v2
    v_fmac_f32 v24, v3, v3
    v_sub_f32 v3, v55, v2
    v_fmac_f32 v24, v3, v3
    v_sub_f32 v3, v56, v2
    v_fmac_f32 v24, v3, v3
    v_sub_f32 v3, v57, v2
    v_fmac_f32 v24, v3, v3
    v_sub_f32 v3, v58, v2
    v_fmac_f32 v24, v3, v3
    v_sub_f32 v3, v59, v2
    v_fmac_f32 v24, v3, v3
    v_sub_f32 v3, v60, v2
    v_fmac_f32 v24, v3, v3
    v_sub_f32 v3, v61, v2
    v_fmac_f32 v24, v3, v3
    v_sub_f32 v3, v62, v2
    v_fmac_f32 v24, v3, v3
    v_sub_f32 v3, v63, v2
    v_fmac_f32 v24, v3, v3
    v_sub_f32 v3, v64, v2
    v_fmac_f32 v24, v3, v3
    v_sub_f32 v3, v65, v2
    v_fmac_f32 v24, v3, v3
    v_sub_f32 v3, v66, v2
    v_fmac_f32 v24, v3, v3
    v_sub_f32 v3, v67, v2
    v_fmac_f32 v24, v3, v3
    v_sub_f32 v3, v68, v2
    v_fmac_f32 v24, v3, v3
    v_sub_f32 v3, v69, v2
    v_fmac_f32 v24, v3, v3
    v_sub_f32 v3, v70, v2
    v_fmac_f32 v24, v3, v3
    v_sub_f32 v3, v71, v2
    v_fmac_f32 v24, v3, v3
    s_nop 1
    v_add_f32_dpp v24, v24, v24 row_ror:8 row_mask:0xf bank_mask:0xf
    s_nop 1
    v_add_f32_dpp v24, v24, v24 row_ror:4 row_mask:0xf bank_mask:0xf
    s_nop 1
    v_add_f32_dpp v24, v24, v24 row_ror:2 row_mask:0xf bank_mask:0xf
    s_nop 1
    v_add_f32_dpp v24, v24, v24 row_ror:1 row_mask:0xf bank_mask:0xf
    v_mul_f32 v24, 0x3acccccd, v24
    v_cvt_pk_bf16_f32 v2, v2, v24
    v_and_b32 v24, 0xffff0000, v2
    v_lshlrev_b32 v2, 16, v2
    v_add_f32 v24, 0x3727c5ac, v24
    v_cvt_pk_bf16_f32 v24, v24, v24
    v_lshlrev_b32 v24, 16, v24
    v_sqrt_f32 v24, v24
    s_nop 0
    v_cvt_pk_bf16_f32 v24, v24, v24
    v_lshlrev_b32 v24, 16, v24
    v_rcp_f32 v25, v24
    s_nop 0
    v_sub_f32 v32, v32, v2
    v_sub_f32 v33, v33, v2
    v_cvt_pk_bf16_f32 v3, v32, v33
    v_lshlrev_b32 v32, 16, v3
    v_and_b32 v33, 0xffff0000, v3
    v_mul_f32 v26, v32, v25
    v_fma_f32 v27, -v26, v24, v32
    v_fma_f32 v32, v27, v25, v26
    v_mul_f32 v26, v33, v25
    v_fma_f32 v27, -v26, v24, v33
    v_fma_f32 v33, v27, v25, v26
    v_cvt_pk_bf16_f32 v4, v32, v33
    v_sub_f32 v34, v34, v2
    v_sub_f32 v35, v35, v2
    v_cvt_pk_bf16_f32 v3, v34, v35
    v_lshlrev_b32 v34, 16, v3
    v_and_b32 v35, 0xffff0000, v3
    v_mul_f32 v26, v34, v25
    v_fma_f32 v27, -v26, v24, v34
    v_fma_f32 v34, v27, v25, v26
    v_mul_f32 v26, v35, v25
    v_fma_f32 v27, -v26, v24, v35
    v_fma_f32 v35, v27, v25, v26
    v_cvt_pk_bf16_f32 v5, v34, v35
    v_sub_f32 v36, v36, v2
    v_sub_f32 v37, v37, v2
    v_cvt_pk_bf16_f32 v3, v36, v37
    v_lshlrev_b32 v36, 16, v3
    v_and_b32 v37, 0xffff0000, v3
    v_mul_f32 v26, v36, v25
    v_fma_f32 v27, -v26, v24, v36
    v_fma_f32 v36, v27, v25, v26
    v_mul_f32 v26, v37, v25
    v_fma_f32 v27, -v26, v24, v37
    v_fma_f32 v37, v27, v25, v26
    v_cvt_pk_bf16_f32 v6, v36, v37
    v_sub_f32 v38, v38, v2
    v_sub_f32 v39, v39, v2
    v_cvt_pk_bf16_f32 v3, v38, v39
    v_lshlrev_b32 v38, 16, v3
    v_and_b32 v39, 0xffff0000, v3
    v_mul_f32 v26, v38, v25
    v_fma_f32 v27, -v26, v24, v38
    v_fma_f32 v38, v27, v25, v26
    v_mul_f32 v26, v39, v25
    v_fma_f32 v27, -v26, v24, v39
    v_fma_f32 v39, v27, v25, v26
    v_cvt_pk_bf16_f32 v7, v38, v39
    v_sub_f32 v40, v40, v2
    v_sub_f32 v41, v41, v2
    v_cvt_pk_bf16_f32 v3, v40, v41
    v_lshlrev_b32 v40, 16, v3
    v_and_b32 v41, 0xffff0000, v3
    v_mul_f32 v26, v40, v25
    v_fma_f32 v27, -v26, v24, v40
    v_fma_f32 v40, v27, v25, v26
    v_mul_f32 v26, v41, v25
    v_fma_f32 v27, -v26, v24, v41
    v_fma_f32 v41, v27, v25, v26
    v_cvt_pk_bf16_f32 v8, v40, v41
    v_sub_f32 v42, v42, v2
    v_sub_f32 v43, v43, v2
    v_cvt_pk_bf16_f32 v3, v42, v43
    v_lshlrev_b32 v42, 16, v3
    v_and_b32 v43, 0xffff0000, v3
    v_mul_f32 v26, v42, v25
    v_fma_f32 v27, -v26, v24, v42
    v_fma_f32 v42, v27, v25, v26
    v_mul_f32 v26, v43, v25
    v_fma_f32 v27, -v26, v24, v43
    v_fma_f32 v43, v27, v25, v26
    v_cvt_pk_bf16_f32 v9, v42, v43
    v_sub_f32 v44, v44, v2
    v_sub_f32 v45, v45, v2
    v_cvt_pk_bf16_f32 v3, v44, v45
    v_lshlrev_b32 v44, 16, v3
    v_and_b32 v45, 0xffff0000, v3
    v_mul_f32 v26, v44, v25
    v_fma_f32 v27, -v26, v24, v44
    v_fma_f32 v44, v27, v25, v26
    v_mul_f32 v26, v45, v25
    v_fma_f32 v27, -v26, v24, v45
    v_fma_f32 v45, v27, v25, v26
    v_cvt_pk_bf16_f32 v10, v44, v45
    v_sub_f32 v46, v46, v2
    v_sub_f32 v47, v47, v2
    v_cvt_pk_bf16_f32 v3, v46, v47
    v_lshlrev_b32 v46, 16, v3
    v_and_b32 v47, 0xffff0000, v3
    v_mul_f32 v26, v46, v25
    v_fma_f32 v27, -v26, v24, v46
    v_fma_f32 v46, v27, v25, v26
    v_mul_f32 v26, v47, v25
    v_fma_f32 v27, -v26, v24, v47
    v_fma_f32 v47, v27, v25, v26
    v_cvt_pk_bf16_f32 v11, v46, v47
    v_sub_f32 v48, v48, v2
    v_sub_f32 v49, v49, v2
    v_cvt_pk_bf16_f32 v3, v48, v49
    v_lshlrev_b32 v48, 16, v3
    v_and_b32 v49, 0xffff0000, v3
    v_mul_f32 v26, v48, v25
    v_fma_f32 v27, -v26, v24, v48
    v_fma_f32 v48, v27, v25, v26
    v_mul_f32 v26, v49, v25
    v_fma_f32 v27, -v26, v24, v49
    v_fma_f32 v49, v27, v25, v26
    v_cvt_pk_bf16_f32 v12, v48, v49
    v_sub_f32 v50, v50, v2
    v_sub_f32 v51, v51, v2
    v_cvt_pk_bf16_f32 v3, v50, v51
    v_lshlrev_b32 v50, 16, v3
    v_and_b32 v51, 0xffff0000, v3
    v_mul_f32 v26, v50, v25
    v_fma_f32 v27, -v26, v24, v50
    v_fma_f32 v50, v27, v25, v26
    v_mul_f32 v26, v51, v25
    v_fma_f32 v27, -v26, v24, v51
    v_fma_f32 v51, v27, v25, v26
    v_cvt_pk_bf16_f32 v13, v50, v51
    v_sub_f32 v52, v52, v2
    v_sub_f32 v53, v53, v2
    v_cvt_pk_bf16_f32 v3, v52, v53
    v_lshlrev_b32 v52, 16, v3
    v_and_b32 v53, 0xffff0000, v3
    v_mul_f32 v26, v52, v25
    v_fma_f32 v27, -v26, v24, v52
    v_fma_f32 v52, v27, v25, v26
    v_mul_f32 v26, v53, v25
    v_fma_f32 v27, -v26, v24, v53
    v_fma_f32 v53, v27, v25, v26
    v_cvt_pk_bf16_f32 v14, v52, v53
    v_sub_f32 v54, v54, v2
    v_sub_f32 v55, v55, v2
    v_cvt_pk_bf16_f32 v3, v54, v55
    v_lshlrev_b32 v54, 16, v3
    v_and_b32 v55, 0xffff0000, v3
    v_mul_f32 v26, v54, v25
    v_fma_f32 v27, -v26, v24, v54
    v_fma_f32 v54, v27, v25, v26
    v_mul_f32 v26, v55, v25
    v_fma_f32 v27, -v26, v24, v55
    v_fma_f32 v55, v27, v25, v26
    v_cvt_pk_bf16_f32 v15, v54, v55
    v_sub_f32 v56, v56, v2
    v_sub_f32 v57, v57, v2
    v_cvt_pk_bf16_f32 v3, v56, v57
    v_lshlrev_b32 v56, 16, v3
    v_and_b32 v57, 0xffff0000, v3
    v_mul_f32 v26, v56, v25
    v_fma_f32 v27, -v26, v24, v56
    v_fma_f32 v56, v27, v25, v26
    v_mul_f32 v26, v57, v25
    v_fma_f32 v27, -v26, v24, v57
    v_fma_f32 v57, v27, v25, v26
    v_cvt_pk_bf16_f32 v16, v56, v57
    v_sub_f32 v58, v58, v2
    v_sub_f32 v59, v59, v2
    v_cvt_pk_bf16_f32 v3, v58, v59
    v_lshlrev_b32 v58, 16, v3
    v_and_b32 v59, 0xffff0000, v3
    v_mul_f32 v26, v58, v25
    v_fma_f32 v27, -v26, v24, v58
    v_fma_f32 v58, v27, v25, v26
    v_mul_f32 v26, v59, v25
    v_fma_f32 v27, -v26, v24, v59
    v_fma_f32 v59, v27, v25, v26
    v_cvt_pk_bf16_f32 v17, v58, v59
    v_sub_f32 v60, v60, v2
    v_sub_f32 v61, v61, v2
    v_cvt_pk_bf16_f32 v3, v60, v61
    v_lshlrev_b32 v60, 16, v3
    v_and_b32 v61, 0xffff0000, v3
    v_mul_f32 v26, v60, v25
    v_fma_f32 v27, -v26, v24, v60
    v_fma_f32 v60, v27, v25, v26
    v_mul_f32 v26, v61, v25
    v_fma_f32 v27, -v26, v24, v61
    v_fma_f32 v61, v27, v25, v26
    v_cvt_pk_bf16_f32 v18, v60, v61
    v_sub_f32 v62, v62, v2
    v_sub_f32 v63, v63, v2
    v_cvt_pk_bf16_f32 v3, v62, v63
    v_lshlrev_b32 v62, 16, v3
    v_and_b32 v63, 0xffff0000, v3
    v_mul_f32 v26, v62, v25
    v_fma_f32 v27, -v26, v24, v62
    v_fma_f32 v62, v27, v25, v26
    v_mul_f32 v26, v63, v25
    v_fma_f32 v27, -v26, v24, v63
    v_fma_f32 v63, v27, v25, v26
    v_cvt_pk_bf16_f32 v19, v62, v63
    v_sub_f32 v64, v64, v2
    v_sub_f32 v65, v65, v2
    v_cvt_pk_bf16_f32 v3, v64, v65
    v_lshlrev_b32 v64, 16, v3
    v_and_b32 v65, 0xffff0000, v3
    v_mul_f32 v26, v64, v25
    v_fma_f32 v27, -v26, v24, v64
    v_fma_f32 v64, v27, v25, v26
    v_mul_f32 v26, v65, v25
    v_fma_f32 v27, -v26, v24, v65
    v_fma_f32 v65, v27, v25, v26
    v_cvt_pk_bf16_f32 v20, v64, v65
    v_sub_f32 v66, v66, v2
    v_sub_f32 v67, v67, v2
    v_cvt_pk_bf16_f32 v3, v66, v67
    v_lshlrev_b32 v66, 16, v3
    v_and_b32 v67, 0xffff0000, v3
    v_mul_f32 v26, v66, v25
    v_fma_f32 v27, -v26, v24, v66
    v_fma_f32 v66, v27, v25, v26
    v_mul_f32 v26, v67, v25
    v_fma_f32 v27, -v26, v24, v67
    v_fma_f32 v67, v27, v25, v26
    v_cvt_pk_bf16_f32 v21, v66, v67
    v_sub_f32 v68, v68, v2
    v_sub_f32 v69, v69, v2
    v_cvt_pk_bf16_f32 v3, v68, v69
    v_lshlrev_b32 v68, 16, v3
    v_and_b32 v69, 0xffff0000, v3
    v_mul_f32 v26, v68, v25
    v_fma_f32 v27, -v26, v24, v68
    v_fma_f32 v68, v27, v25, v26
    v_mul_f32 v26, v69, v25
    v_fma_f32 v27, -v26, v24, v69
    v_fma_f32 v69, v27, v25, v26
    v_cvt_pk_bf16_f32 v22, v68, v69
    v_sub_f32 v70, v70, v2
    v_sub_f32 v71, v71, v2
    v_cvt_pk_bf16_f32 v3, v70, v71
    v_lshlrev_b32 v70, 16, v3
    v_and_b32 v71, 0xffff0000, v3
    v_mul_f32 v26, v70, v25
    v_fma_f32 v27, -v26, v24, v70
    v_fma_f32 v70, v27, v25, v26
    v_mul_f32 v26, v71, v25
    v_fma_f32 v27, -v26, v24, v71
    v_fma_f32 v71, v27, v25, v26
    v_cvt_pk_bf16_f32 v23, v70, v71
    buffer_store_dwordx4 v[4:7], v1, s[72:75], 0 offen offset:0 sc1
    buffer_store_dwordx4 v[8:11], v1, s[72:75], 0 offen offset:256 sc1
    buffer_store_dwordx4 v[12:15], v1, s[72:75], 0 offen offset:512 sc1
    buffer_store_dwordx4 v[16:19], v1, s[72:75], 0 offen offset:768 sc1
    buffer_store_dwordx4 v[20:23], v1, s[72:75], 0 offen offset:1024 sc1
    s_branch in_fin_6
in_fill_5:
    s_lshl_b32 s3, s2, 7
    v_subrev_u32 v1, 128, v0
    v_add_u32 v1, s3, v1
    v_lshlrev_b32 v2, 4, v1
    v_mov_b32 v4, -1
    v_mov_b32 v5, -1
    v_mov_b32 v6, -1
    v_mov_b32 v7, -1
    v_mov_b32 v12, 0
    v_mov_b32 v13, 0
    v_mov_b32 v14, 0
    v_mov_b32 v15, 0
    s_mov_b32 s3, 0x00000000
    buffer_store_dwordx4 v[4:7], v2, s[76:79], s3 offen sc1
    s_mov_b32 s3, 0x00080000
    buffer_store_dwordx4 v[4:7], v2, s[76:79], s3 offen sc1
    s_mov_b32 s3, 0x00100000
    buffer_store_dwordx4 v[4:7], v2, s[76:79], s3 offen sc1
    s_add_u32 s68, s14, 0x07b34000
    s_addc_u32 s69, s15, 0
    s_mov_b32 s70, 0x00018400
    s_mov_b32 s71, 0x00020000
    s_add_u32 s72, s14, 0x05600000
    s_addc_u32 s73, s15, 0
    s_mov_b32 s74, 0x00c00000
    s_mov_b32 s75, 0x00020000
    buffer_store_dwordx4 v[12:15], v2, s[68:71], 0 offen sc1
    v_min_u32 v1, 4095, v1
    s_mov_b32 s3, 0x00006667
    v_mul_lo_u32 v3, v1, s3
    v_lshrrev_b32 v3, 24, v3
    v_mul_u32_u24 v3, 640, v3
    v_sub_u32 v3, v1, v3
    v_and_b32 v8, 7, v3
    v_lshrrev_b32 v3, 3, v3
    v_mul_u32_u24 v8, 1280, v8
    v_lshl_add_u32 v3, v3, 4, v8
    buffer_load_dwordx4 v[8:11], v3, s[80:83], 0 offen
    s_waitcnt vmcnt(0)
    buffer_store_dwordx4 v[8:11], v2, s[84:87], 0 offen sc1
in_fin_6:
    s_waitcnt vmcnt(0)
    s_barrier
    s_cmp_lg_u32 s59, 0
    s_cbranch_scc1 in_sk_7
    s_mov_b64 s[66:67], exec
    s_mov_b64 exec, 1
    v_mov_b32 v1, 1
    v_mov_b32 v2, 68
    buffer_atomic_add v1, v2, s[32:35], 0 offen
    s_mov_b64 exec, s[66:67]
in_sk_7:
    v_mov_b32 v6, 98304
    ds_read_b64 v[2:3], v6
    s_waitcnt lgkmcnt(0)
    v_readfirstlane_b32 s57, v2
    v_readfirstlane_b32 s88, v3
    s_mov_b32 s56, s89
    s_mov_b32 s58, 0
    s_barrier
    s_cmp_ge_u32 s57, 32
    s_cselect_b32 s57, 0, s57
    s_and_b32 s56, s56, 7
rc_restart_8:
    s_cmp_ge_u32 s56, 4
    s_cbranch_scc1 wk_entry_2
    s_mov_b32 s16, s4
    s_mov_b32 s17, s5
    s_mov_b32 s18, 0x00780000
    s_mov_b32 s19, 0x00020000
    s_mov_b32 s20, s6
    s_mov_b32 s21, s7
    s_mov_b32 s22, 0x00780000
    s_mov_b32 s23, 0x00020000
    s_mov_b32 s24, s8
    s_mov_b32 s25, s9
    s_mov_b32 s26, 0x00780000
    s_mov_b32 s27, 0x00020000
    s_mov_b32 s28, s10
    s_mov_b32 s29, s11
    s_mov_b32 s30, 0x00780000
    s_mov_b32 s31, 0x00020000
    s_add_u32 s36, s14, 0x07a00000
    s_addc_u32 s37, s15, 0
    s_mov_b32 s38, 0x0014c400
    s_mov_b32 s39, 0x00020000
    s_add_u32 s40, s14, 0x01c00000
    s_addc_u32 s41, s15, 0
    s_mov_b32 s42, 0x01800000
    s_mov_b32 s43, 0x00020000
    s_add_u32 s44, s14, 0x03400000
    s_addc_u32 s45, s15, 0
    s_mov_b32 s46, 0x01800000
    s_mov_b32 s47, 0x00020000
    s_add_u32 s48, s14, 0x05600000
    s_addc_u32 s49, s15, 0
    s_mov_b32 s50, 0x00600000
    s_mov_b32 s51, 0x00020000
    s_add_u32 s52, s14, 0x05c00000
    s_addc_u32 s53, s15, 0
    s_mov_b32 s54, 0x00600000
    s_mov_b32 s55, 0x00020000
    s_lshr_b32 s60, s57, 2
    s_lshl_b32 s64, s56, 3
    s_add_u32 s60, s60, s64
    s_and_b32 s61, s57, 3
    v_and_b32 v1, 15, v0
    v_bfe_u32 v2, v0, 4, 2
    v_and_b32 v3, 7, v0
    v_and_b32 v4, 63, v0
    s_mul_i32 s64, s59, 24576
    v_lshl_add_u32 v5, v4, 4, s64
    v_lshrrev_b32 v6, 2, v1
    v_lshl_add_u32 v7, v2, 3, v6
    v_mul_u32_u24 v7, 96, v7
    v_and_b32 v8, 3, v1
    v_lshl_add_u32 v7, v8, 3, v7
    v_lshl_add_u32 v9, v2, 2, v6
    v_lshlrev_b32 v9, 6, v9
    v_lshl_add_u32 v9, v8, 3, v9
    v_add_u32 v9, s64, v9
    s_mul_i32 s64, s59, 15360
    v_lshl_add_u32 v10, v4, 4, s64
    v_add_u32 v6, 0, v4
    v_mul_u32_u24 v8, 10923, v6
    v_lshrrev_b32 v8, 16, v8
    v_mul_u32_u24 v11, 6, v8
    v_sub_u32 v6, v6, v11
    v_mul_u32_u24 v11, 12288, v8
    v_lshl_add_u32 v11, v6, 4, v11
    v_add_u32 v6, 64, v4
    v_mul_u32_u24 v8, 10923, v6
    v_lshrrev_b32 v8, 16, v8
    v_mul_u32_u24 v12, 6, v8
    v_sub_u32 v6, v6, v12
    v_mul_u32_u24 v12, 12288, v8
    v_lshl_add_u32 v12, v6, 4, v12
    v_add_u32 v6, 128, v4
    v_mul_u32_u24 v8, 10923, v6
    v_lshrrev_b32 v8, 16, v8
    v_mul_u32_u24 v13, 6, v8
    v_sub_u32 v6, v6, v13
    v_mul_u32_u24 v13, 12288, v8
    v_lshl_add_u32 v13, v6, 4, v13
    s_mul_i32 s65, s60, 384
    s_mul_i32 s66, s61, 96
    s_add_u32 s65, s65, s66
    s_mul_i32 s66, s59, 1966080
    s_add_u32 s65, s65, s66
    s_mov_b32 s67, s65
    buffer_load_dwordx4 v[16:19], v11, s[16:19], s67 offen
    buffer_load_dwordx4 v[20:23], v12, s[16:19], s67 offen
    buffer_load_dwordx4 v[24:27], v13, s[16:19], s67 offen
    s_add_u32 s67, s67, 393216
    buffer_load_dwordx4 v[28:31], v11, s[16:19], s67 offen
    buffer_load_dwordx4 v[32:35], v12, s[16:19], s67 offen
    buffer_load_dwordx4 v[36:39], v13, s[16:19], s67 offen
    s_add_u32 s67, s67, 393216
    buffer_load_dwordx4 v[40:43], v11, s[16:19], s67 offen
    buffer_load_dwordx4 v[44:47], v12, s[16:19], s67 offen
    buffer_load_dwordx4 v[48:51], v13, s[16:19], s67 offen
    s_add_u32 s67, s67, 393216
    buffer_load_dwordx4 v[52:55], v11, s[16:19], s67 offen
    buffer_load_dwordx4 v[56:59], v12, s[16:19], s67 offen
    buffer_load_dwordx4 v[60:63], v13, s[16:19], s67 offen
    s_add_u32 s67, s67, 393216
    buffer_load_dwordx4 v[64:67], v11, s[16:19], s67 offen
    buffer_load_dwordx4 v[68:71], v12, s[16:19], s67 offen
    buffer_load_dwordx4 v[72:75], v13, s[16:19], s67 offen
    s_add_u32 s67, s67, 393216
    s_mov_b32 s67, s65
    buffer_load_dwordx4 v[76:79], v11, s[20:23], s67 offen
    buffer_load_dwordx4 v[80:83], v12, s[20:23], s67 offen
    buffer_load_dwordx4 v[84:87], v13, s[20:23], s67 offen
    s_add_u32 s67, s67, 393216
    buffer_load_dwordx4 v[88:91], v11, s[20:23], s67 offen
    buffer_load_dwordx4 v[92:95], v12, s[20:23], s67 offen
    buffer_load_dwordx4 v[96:99], v13, s[20:23], s67 offen
    s_add_u32 s67, s67, 393216
    buffer_load_dwordx4 v[100:103], v11, s[20:23], s67 offen
    buffer_load_dwordx4 v[104:107], v12, s[20:23], s67 offen
    buffer_load_dwordx4 v[108:111], v13, s[20:23], s67 offen
    s_add_u32 s67, s67, 393216
    buffer_load_dwordx4 v[112:115], v11, s[20:23], s67 offen
    buffer_load_dwordx4 v[116:119], v12, s[20:23], s67 offen
    buffer_load_dwordx4 v[120:123], v13, s[20:23], s67 offen
    s_add_u32 s67, s67, 393216
    buffer_load_dwordx4 v[124:127], v11, s[20:23], s67 offen
    buffer_load_dwordx4 v[128:131], v12, s[20:23], s67 offen
    buffer_load_dwordx4 v[132:135], v13, s[20:23], s67 offen
    s_add_u32 s67, s67, 393216
    v_lshrrev_b32 v8, 2, v4
    v_mul_u32_u24 v8, 1280, v8
    v_and_b32 v6, 3, v4
    v_lshl_add_u32 v8, v6, 4, v8
    s_mul_i32 s66, s56, 1966080
    s_mul_i32 s67, s59, 491520
    s_add_u32 s66, s66, s67
    s_lshl_b32 s67, s57, 6
    s_add_u32 s66, s66, s67
    s_cmp_ge_u32 s57, 20
    s_cselect_b32 s66, 0x7f000000, s66
    buffer_load_dwordx4 v[160:163], v8, s[28:31], s66 offen
    s_add_u32 s66, s66, 20480
    buffer_load_dwordx4 v[164:167], v8, s[28:31], s66 offen
    s_add_u32 s66, s66, 20480
    buffer_load_dwordx4 v[168:171], v8, s[28:31], s66 offen
    s_add_u32 s66, s66, 20480
    buffer_load_dwordx4 v[172:175], v8, s[28:31], s66 offen
    s_add_u32 s66, s66, 20480
    buffer_load_dwordx4 v[176:179], v8, s[28:31], s66 offen
    s_add_u32 s66, s66, 20480
    buffer_load_dwordx4 v[180:183], v8, s[28:31], s66 offen
    s_add_u32 s66, s66, 20480
    buffer_load_dwordx4 v[184:187], v8, s[28:31], s66 offen
    s_add_u32 s66, s66, 20480
    buffer_load_dwordx4 v[188:191], v8, s[28:31], s66 offen
    s_add_u32 s66, s66, 20480
    buffer_load_dwordx4 v[192:195], v8, s[28:31], s66 offen
    s_add_u32 s66, s66, 20480
    buffer_load_dwordx4 v[196:199], v8, s[28:31], s66 offen
    s_add_u32 s66, s66, 20480
    buffer_load_dwordx4 v[200:203], v8, s[28:31], s66 offen
    s_add_u32 s66, s66, 20480
    buffer_load_dwordx4 v[204:207], v8, s[28:31], s66 offen
    s_add_u32 s66, s66, 20480
    buffer_load_dwordx4 v[208:211], v8, s[28:31], s66 offen
    s_add_u32 s66, s66, 20480
    buffer_load_dwordx4 v[212:215], v8, s[28:31], s66 offen
    s_add_u32 s66, s66, 20480
    buffer_load_dwordx4 v[216:219], v8, s[28:31], s66 offen
    s_add_u32 s66, s66, 20480
    buffer_load_dwordx4 v[220:223], v8, s[28:31], s66 offen
    s_add_u32 s66, s66, 20480
    buffer_load_dwordx4 v[224:227], v8, s[28:31], s66 offen
    s_add_u32 s66, s66, 20480
    buffer_load_dwordx4 v[228:231], v8, s[28:31], s66 offen
    s_add_u32 s66, s66, 20480
    buffer_load_dwordx4 v[232:235], v8, s[28:31], s66 offen
    s_add_u32 s66, s66, 20480
    buffer_load_dwordx4 v[236:239], v8, s[28:31], s66 offen
    s_add_u32 s66, s66, 20480
    buffer_load_dwordx4 v[240:243], v8, s[28:31], s66 offen
    s_add_u32 s66, s66, 20480
    buffer_load_dwordx4 v[244:247], v8, s[28:31], s66 offen
    s_add_u32 s66, s66, 20480
    buffer_load_dwordx4 v[248:251], v8, s[28:31], s66 offen
    s_add_u32 s66, s66, 20480
    buffer_load_dwordx4 v[252:255], v8, s[28:31], s66 offen
    s_add_u32 s66, s66, 20480
    s_lshl_b32 s64, s59, 5
    v_add_u32 v14, s64, v7
    s_mul_i32 s64, s59, 12288
    s_add_u32 s64, s64, 61440
    s_mul_i32 s66, s59, 24576
    v_subrev_u32 v9, s66, v9
    v_add_u32 v9, s64, v9
    v_lshl_add_u32 v5, v4, 4, s64
    s_waitcnt vmcnt(53)
    ds_write_b128 v10, v[16:19] offset:0
    s_waitcnt vmcnt(52)
    ds_write_b128 v10, v[20:23] offset:1024
    s_waitcnt vmcnt(51)
    ds_write_b128 v10, v[24:27] offset:2048
    s_waitcnt vmcnt(50)
    ds_write_b128 v10, v[28:31] offset:3072
    s_waitcnt vmcnt(49)
    ds_write_b128 v10, v[32:35] offset:4096
    s_waitcnt vmcnt(48)
    ds_write_b128 v10, v[36:39] offset:5120
    s_waitcnt vmcnt(47)
    ds_write_b128 v10, v[40:43] offset:6144
    s_waitcnt vmcnt(46)
    ds_write_b128 v10, v[44:47] offset:7168
    s_waitcnt vmcnt(45)
    ds_write_b128 v10, v[48:51] offset:8192
    s_waitcnt vmcnt(44)
    ds_write_b128 v10, v[52:55] offset:9216
    s_waitcnt vmcnt(43)
    ds_write_b128 v10, v[56:59] offset:10240
    s_waitcnt vmcnt(42)
    ds_write_b128 v10, v[60:63] offset:11264
    s_waitcnt vmcnt(41)
    ds_write_b128 v10, v[64:67] offset:12288
    s_waitcnt vmcnt(40)
    ds_write_b128 v10, v[68:71] offset:13312
    s_waitcnt vmcnt(39)
    ds_write_b128 v10, v[72:75] offset:14336
    s_waitcnt lgkmcnt(0)
    s_barrier
    s_mov_b32 s67, s65
    buffer_load_dwordx4 v[16:19], v11, s[24:27], s67 offen
    buffer_load_dwordx4 v[20:23], v12, s[24:27], s67 offen
    buffer_load_dwordx4 v[24:27], v13, s[24:27], s67 offen
    s_add_u32 s67, s67, 393216
    buffer_load_dwordx4 v[28:31], v11, s[24:27], s67 offen
    buffer_load_dwordx4 v[32:35], v12, s[24:27], s67 offen
    buffer_load_dwordx4 v[36:39], v13, s[24:27], s67 offen
    s_add_u32 s67, s67, 393216
    buffer_load_dwordx4 v[40:43], v11, s[24:27], s67 offen
    buffer_load_dwordx4 v[44:47], v12, s[24:27], s67 offen
    buffer_load_dwordx4 v[48:51], v13, s[24:27], s67 offen
    s_add_u32 s67, s67, 393216
    buffer_load_dwordx4 v[52:55], v11, s[24:27], s67 offen
    buffer_load_dwordx4 v[56:59], v12, s[24:27], s67 offen
    buffer_load_dwordx4 v[60:63], v13, s[24:27], s67 offen
    s_add_u32 s67, s67, 393216
    buffer_load_dwordx4 v[64:67], v11, s[24:27], s67 offen
    buffer_load_dwordx4 v[68:71], v12, s[24:27], s67 offen
    buffer_load_dwordx4 v[72:75], v13, s[24:27], s67 offen
    s_add_u32 s67, s67, 393216
    s_cmp_eq_u32 s59, 3
    s_cbranch_scc1 rc_wsk_9
    ds_read_b64_tr_b16 a[0:1], v14 offset:0
    ds_read_b64_tr_b16 a[2:3], v14 offset:384
    ds_read_b64_tr_b16 a[4:5], v14 offset:3072
    ds_read_b64_tr_b16 a[6:7], v14 offset:3456
    ds_read_b64_tr_b16 a[8:9], v14 offset:6144
    ds_read_b64_tr_b16 a[10:11], v14 offset:6528
    ds_read_b64_tr_b16 a[12:13], v14 offset:9216
    ds_read_b64_tr_b16 a[14:15], v14 offset:9600
    ds_read_b64_tr_b16 a[16:17], v14 offset:12288
    ds_read_b64_tr_b16 a[18:19], v14 offset:12672
    ds_read_b64_tr_b16 a[20:21], v14 offset:15360
    ds_read_b64_tr_b16 a[22:23], v14 offset:15744
    s_waitcnt lgkmcnt(0)
    ds_read_b64_tr_b16 a[24:25], v14 offset:18432
    ds_read_b64_tr_b16 a[26:27], v14 offset:18816
    ds_read_b64_tr_b16 a[28:29], v14 offset:21504
    ds_read_b64_tr_b16 a[30:31], v14 offset:21888
    ds_read_b64_tr_b16 a[32:33], v14 offset:24576
    ds_read_b64_tr_b16 a[34:35], v14 offset:24960
    ds_read_b64_tr_b16 a[36:37], v14 offset:27648
    ds_read_b64_tr_b16 a[38:39], v14 offset:28032
    ds_read_b64_tr_b16 a[40:41], v14 offset:30720
    ds_read_b64_tr_b16 a[42:43], v14 offset:31104
    ds_read_b64_tr_b16 a[44:45], v14 offset:33792
    ds_read_b64_tr_b16 a[46:47], v14 offset:34176
    s_waitcnt lgkmcnt(0)
    ds_read_b64_tr_b16 a[48:49], v14 offset:36864
    ds_read_b64_tr_b16 a[50:51], v14 offset:37248
    ds_read_b64_tr_b16 a[52:53], v14 offset:39936
    ds_read_b64_tr_b16 a[54:55], v14 offset:40320
    ds_read_b64_tr_b16 a[56:57], v14 offset:43008
    ds_read_b64_tr_b16 a[58:59], v14 offset:43392
    ds_read_b64_tr_b16 a[60:61], v14 offset:46080
    ds_read_b64_tr_b16 a[62:63], v14 offset:46464
    ds_read_b64_tr_b16 a[64:65], v14 offset:49152
    ds_read_b64_tr_b16 a[66:67], v14 offset:49536
    ds_read_b64_tr_b16 a[68:69], v14 offset:52224
    ds_read_b64_tr_b16 a[70:71], v14 offset:52608
    s_waitcnt lgkmcnt(0)
    ds_read_b64_tr_b16 a[72:73], v14 offset:55296
    ds_read_b64_tr_b16 a[74:75], v14 offset:55680
    ds_read_b64_tr_b16 a[76:77], v14 offset:58368
    ds_read_b64_tr_b16 a[78:79], v14 offset:58752
rc_wsk_9:
    s_waitcnt lgkmcnt(0)
    s_barrier
    s_waitcnt vmcnt(53)
    ds_write_b128 v10, v[76:79] offset:0
    s_waitcnt vmcnt(52)
    ds_write_b128 v10, v[80:83] offset:1024
    s_waitcnt vmcnt(51)
    ds_write_b128 v10, v[84:87] offset:2048
    s_waitcnt vmcnt(50)
    ds_write_b128 v10, v[88:91] offset:3072
    s_waitcnt vmcnt(49)
    ds_write_b128 v10, v[92:95] offset:4096
    s_waitcnt vmcnt(48)
    ds_write_b128 v10, v[96:99] offset:5120
    s_waitcnt vmcnt(47)
    ds_write_b128 v10, v[100:103] offset:6144
    s_waitcnt vmcnt(46)
    ds_write_b128 v10, v[104:107] offset:7168
    s_waitcnt vmcnt(45)
    ds_write_b128 v10, v[108:111] offset:8192
    s_waitcnt vmcnt(44)
    ds_write_b128 v10, v[112:115] offset:9216
    s_waitcnt vmcnt(43)
    ds_write_b128 v10, v[116:119] offset:10240
    s_waitcnt vmcnt(42)
    ds_write_b128 v10, v[120:123] offset:11264
    s_waitcnt vmcnt(41)
    ds_write_b128 v10, v[124:127] offset:12288
    s_waitcnt vmcnt(40)
    ds_write_b128 v10, v[128:131] offset:13312
    s_waitcnt vmcnt(39)
    ds_write_b128 v10, v[132:135] offset:14336
    s_waitcnt lgkmcnt(0)
    s_barrier
    s_cmp_eq_u32 s59, 3
    s_cbranch_scc1 rc_wsk_10
    ds_read_b64_tr_b16 a[80:81], v14 offset:0
    ds_read_b64_tr_b16 a[82:83], v14 offset:384
    ds_read_b64_tr_b16 a[84:85], v14 offset:3072
    ds_read_b64_tr_b16 a[86:87], v14 offset:3456
    ds_read_b64_tr_b16 a[88:89], v14 offset:6144
    ds_read_b64_tr_b16 a[90:91], v14 offset:6528
    ds_read_b64_tr_b16 a[92:93], v14 offset:9216
    ds_read_b64_tr_b16 a[94:95], v14 offset:9600
    ds_read_b64_tr_b16 a[96:97], v14 offset:12288
    ds_read_b64_tr_b16 a[98:99], v14 offset:12672
    ds_read_b64_tr_b16 a[100:101], v14 offset:15360
    ds_read_b64_tr_b16 a[102:103], v14 offset:15744
    s_waitcnt lgkmcnt(0)
    ds_read_b64_tr_b16 a[104:105], v14 offset:18432
    ds_read_b64_tr_b16 a[106:107], v14 offset:18816
    ds_read_b64_tr_b16 a[108:109], v14 offset:21504
    ds_read_b64_tr_b16 a[110:111], v14 offset:21888
    ds_read_b64_tr_b16 a[112:113], v14 offset:24576
    ds_read_b64_tr_b16 a[114:115], v14 offset:24960
    ds_read_b64_tr_b16 a[116:117], v14 offset:27648
    ds_read_b64_tr_b16 a[118:119], v14 offset:28032
    ds_read_b64_tr_b16 a[120:121], v14 offset:30720
    ds_read_b64_tr_b16 a[122:123], v14 offset:31104
    ds_read_b64_tr_b16 a[124:125], v14 offset:33792
    ds_read_b64_tr_b16 a[126:127], v14 offset:34176
    s_waitcnt lgkmcnt(0)
    ds_read_b64_tr_b16 a[128:129], v14 offset:36864
    ds_read_b64_tr_b16 a[130:131], v14 offset:37248
    ds_read_b64_tr_b16 a[132:133], v14 offset:39936
    ds_read_b64_tr_b16 a[134:135], v14 offset:40320
    ds_read_b64_tr_b16 a[136:137], v14 offset:43008
    ds_read_b64_tr_b16 a[138:139], v14 offset:43392
    ds_read_b64_tr_b16 a[140:141], v14 offset:46080
    ds_read_b64_tr_b16 a[142:143], v14 offset:46464
    ds_read_b64_tr_b16 a[144:145], v14 offset:49152
    ds_read_b64_tr_b16 a[146:147], v14 offset:49536
    ds_read_b64_tr_b16 a[148:149], v14 offset:52224
    ds_read_b64_tr_b16 a[150:151], v14 offset:52608
    s_waitcnt lgkmcnt(0)
    ds_read_b64_tr_b16 a[152:153], v14 offset:55296
    ds_read_b64_tr_b16 a[154:155], v14 offset:55680
    ds_read_b64_tr_b16 a[156:157], v14 offset:58368
    ds_read_b64_tr_b16 a[158:159], v14 offset:58752
rc_wsk_10:
    s_waitcnt lgkmcnt(0)
    s_barrier
    s_waitcnt vmcnt(38)
    ds_write_b128 v5, v[160:163] offset:0
    s_waitcnt vmcnt(37)
    ds_write_b128 v5, v[164:167] offset:1024
    s_waitcnt vmcnt(36)
    ds_write_b128 v5, v[168:171] offset:2048
    s_waitcnt vmcnt(35)
    ds_write_b128 v5, v[172:175] offset:3072
    s_waitcnt vmcnt(34)
    ds_write_b128 v5, v[176:179] offset:4096
    s_waitcnt vmcnt(33)
    ds_write_b128 v5, v[180:183] offset:5120
    s_waitcnt vmcnt(32)
    ds_write_b128 v5, v[184:187] offset:6144
    s_waitcnt vmcnt(31)
    ds_write_b128 v5, v[188:191] offset:7168
    s_waitcnt vmcnt(30)
    ds_write_b128 v5, v[192:195] offset:8192
    s_waitcnt vmcnt(29)
    ds_write_b128 v5, v[196:199] offset:9216
    s_waitcnt vmcnt(28)
    ds_write_b128 v5, v[200:203] offset:10240
    s_waitcnt vmcnt(27)
    ds_write_b128 v5, v[204:207] offset:11264
    s_waitcnt lgkmcnt(0)
    ds_read_b64_tr_b16 v[160:161], v9 offset:0
    ds_read_b64_tr_b16 v[162:163], v9 offset:1024
    ds_read_b64_tr_b16 v[164:165], v9 offset:32
    ds_read_b64_tr_b16 v[166:167], v9 offset:1056
    ds_read_b64_tr_b16 v[168:169], v9 offset:2048
    ds_read_b64_tr_b16 v[170:171], v9 offset:3072
    ds_read_b64_tr_b16 v[172:173], v9 offset:2080
    ds_read_b64_tr_b16 v[174:175], v9 offset:3104
    ds_read_b64_tr_b16 v[176:177], v9 offset:4096
    ds_read_b64_tr_b16 v[178:179], v9 offset:5120
    ds_read_b64_tr_b16 v[180:181], v9 offset:4128
    ds_read_b64_tr_b16 v[182:183], v9 offset:5152
    s_waitcnt lgkmcnt(0)
    ds_read_b64_tr_b16 v[184:185], v9 offset:6144
    ds_read_b64_tr_b16 v[186:187], v9 offset:7168
    ds_read_b64_tr_b16 v[188:189], v9 offset:6176
    ds_read_b64_tr_b16 v[190:191], v9 offset:7200
    ds_read_b64_tr_b16 v[192:193], v9 offset:8192
    ds_read_b64_tr_b16 v[194:195], v9 offset:9216
    ds_read_b64_tr_b16 v[196:197], v9 offset:8224
    ds_read_b64_tr_b16 v[198:199], v9 offset:9248
    ds_read_b64_tr_b16 v[200:201], v9 offset:10240
    ds_read_b64_tr_b16 v[202:203], v9 offset:11264
    ds_read_b64_tr_b16 v[204:205], v9 offset:10272
    ds_read_b64_tr_b16 v[206:207], v9 offset:11296
    s_waitcnt lgkmcnt(0)
    s_waitcnt lgkmcnt(0)
    s_waitcnt vmcnt(26)
    ds_write_b128 v5, v[208:211] offset:0
    s_waitcnt vmcnt(25)
    ds_write_b128 v5, v[212:215] offset:1024
    s_waitcnt vmcnt(24)
    ds_write_b128 v5, v[216:219] offset:2048
    s_waitcnt vmcnt(23)
    ds_write_b128 v5, v[220:223] offset:3072
    s_waitcnt vmcnt(22)
    ds_write_b128 v5, v[224:227] offset:4096
    s_waitcnt vmcnt(21)
    ds_write_b128 v5, v[228:231] offset:5120
    s_waitcnt vmcnt(20)
    ds_write_b128 v5, v[232:235] offset:6144
    s_waitcnt vmcnt(19)
    ds_write_b128 v5, v[236:239] offset:7168
    s_waitcnt vmcnt(18)
    ds_write_b128 v5, v[240:243] offset:8192
    s_waitcnt vmcnt(17)
    ds_write_b128 v5, v[244:247] offset:9216
    s_waitcnt vmcnt(16)
    ds_write_b128 v5, v[248:251] offset:10240
    s_waitcnt vmcnt(15)
    ds_write_b128 v5, v[252:255] offset:11264
    s_waitcnt lgkmcnt(0)
    ds_read_b64_tr_b16 v[208:209], v9 offset:0
    ds_read_b64_tr_b16 v[210:211], v9 offset:1024
    ds_read_b64_tr_b16 v[212:213], v9 offset:32
    ds_read_b64_tr_b16 v[214:215], v9 offset:1056
    ds_read_b64_tr_b16 v[216:217], v9 offset:2048
    ds_read_b64_tr_b16 v[218:219], v9 offset:3072
    ds_read_b64_tr_b16 v[220:221], v9 offset:2080
    ds_read_b64_tr_b16 v[222:223], v9 offset:3104
    ds_read_b64_tr_b16 v[224:225], v9 offset:4096
    ds_read_b64_tr_b16 v[226:227], v9 offset:5120
    ds_read_b64_tr_b16 v[228:229], v9 offset:4128
    ds_read_b64_tr_b16 v[230:231], v9 offset:5152
    s_waitcnt lgkmcnt(0)
    ds_read_b64_tr_b16 v[232:233], v9 offset:6144
    ds_read_b64_tr_b16 v[234:235], v9 offset:7168
    ds_read_b64_tr_b16 v[236:237], v9 offset:6176
    ds_read_b64_tr_b16 v[238:239], v9 offset:7200
    ds_read_b64_tr_b16 v[240:241], v9 offset:8192
    ds_read_b64_tr_b16 v[242:243], v9 offset:9216
    ds_read_b64_tr_b16 v[244:245], v9 offset:8224
    ds_read_b64_tr_b16 v[246:247], v9 offset:9248
    ds_read_b64_tr_b16 v[248:249], v9 offset:10240
    ds_read_b64_tr_b16 v[250:251], v9 offset:11264
    ds_read_b64_tr_b16 v[252:253], v9 offset:10272
    ds_read_b64_tr_b16 v[254:255], v9 offset:11296
    s_waitcnt lgkmcnt(0)
    s_waitcnt lgkmcnt(0)
    s_waitcnt vmcnt(14)
    ds_write_b128 v10, v[16:19] offset:0
    s_waitcnt vmcnt(13)
    ds_write_b128 v10, v[20:23] offset:1024
    s_waitcnt vmcnt(12)
    ds_write_b128 v10, v[24:27] offset:2048
    s_waitcnt vmcnt(11)
    ds_write_b128 v10, v[28:31] offset:3072
    s_waitcnt vmcnt(10)
    ds_write_b128 v10, v[32:35] offset:4096
    s_waitcnt vmcnt(9)
    ds_write_b128 v10, v[36:39] offset:5120
    s_waitcnt vmcnt(8)
    ds_write_b128 v10, v[40:43] offset:6144
    s_waitcnt vmcnt(7)
    ds_write_b128 v10, v[44:47] offset:7168
    s_waitcnt vmcnt(6)
    ds_write_b128 v10, v[48:51] offset:8192
    s_waitcnt vmcnt(5)
    ds_write_b128 v10, v[52:55] offset:9216
    s_waitcnt vmcnt(4)
    ds_write_b128 v10, v[56:59] offset:10240
    s_waitcnt vmcnt(3)
    ds_write_b128 v10, v[60:63] offset:11264
    s_waitcnt vmcnt(2)
    ds_write_b128 v10, v[64:67] offset:12288
    s_waitcnt vmcnt(1)
    ds_write_b128 v10, v[68:71] offset:13312
    s_waitcnt vmcnt(0)
    ds_write_b128 v10, v[72:75] offset:14336
    s_waitcnt lgkmcnt(0)
    s_barrier
    s_cmp_lg_u32 s59, 3
    s_cbranch_scc1 rc_wsk_11
    ds_read_b64_tr_b16 a[0:1], v7 offset:0
    ds_read_b64_tr_b16 a[2:3], v7 offset:384
    ds_read_b64_tr_b16 a[4:5], v7 offset:3072
    ds_read_b64_tr_b16 a[6:7], v7 offset:3456
    ds_read_b64_tr_b16 a[8:9], v7 offset:6144
    ds_read_b64_tr_b16 a[10:11], v7 offset:6528
    ds_read_b64_tr_b16 a[12:13], v7 offset:9216
    ds_read_b64_tr_b16 a[14:15], v7 offset:9600
    ds_read_b64_tr_b16 a[16:17], v7 offset:12288
    ds_read_b64_tr_b16 a[18:19], v7 offset:12672
    ds_read_b64_tr_b16 a[20:21], v7 offset:15360
    ds_read_b64_tr_b16 a[22:23], v7 offset:15744
    s_waitcnt lgkmcnt(0)
    ds_read_b64_tr_b16 a[24:25], v7 offset:18432
    ds_read_b64_tr_b16 a[26:27], v7 offset:18816
    ds_read_b64_tr_b16 a[28:29], v7 offset:21504
    ds_read_b64_tr_b16 a[30:31], v7 offset:21888
    ds_read_b64_tr_b16 a[32:33], v7 offset:24576
    ds_read_b64_tr_b16 a[34:35], v7 offset:24960
    ds_read_b64_tr_b16 a[36:37], v7 offset:27648
    ds_read_b64_tr_b16 a[38:39], v7 offset:28032
    ds_read_b64_tr_b16 a[40:41], v7 offset:30720
    ds_read_b64_tr_b16 a[42:43], v7 offset:31104
    ds_read_b64_tr_b16 a[44:45], v7 offset:33792
    ds_read_b64_tr_b16 a[46:47], v7 offset:34176
    s_waitcnt lgkmcnt(0)
    ds_read_b64_tr_b16 a[48:49], v7 offset:36864
    ds_read_b64_tr_b16 a[50:51], v7 offset:37248
    ds_read_b64_tr_b16 a[52:53], v7 offset:39936
    ds_read_b64_tr_b16 a[54:55], v7 offset:40320
    ds_read_b64_tr_b16 a[56:57], v7 offset:43008
    ds_read_b64_tr_b16 a[58:59], v7 offset:43392
    ds_read_b64_tr_b16 a[60:61], v7 offset:46080
    ds_read_b64_tr_b16 a[62:63], v7 offset:46464
    ds_read_b64_tr_b16 a[64:65], v7 offset:49152
    ds_read_b64_tr_b16 a[66:67], v7 offset:49536
    ds_read_b64_tr_b16 a[68:69], v7 offset:52224
    ds_read_b64_tr_b16 a[70:71], v7 offset:52608
    s_waitcnt lgkmcnt(0)
    ds_read_b64_tr_b16 a[72:73], v7 offset:55296
    ds_read_b64_tr_b16 a[74:75], v7 offset:55680
    ds_read_b64_tr_b16 a[76:77], v7 offset:58368
    ds_read_b64_tr_b16 a[78:79], v7 offset:58752
    ds_read_b64_tr_b16 a[80:81], v7 offset:32
    ds_read_b64_tr_b16 a[82:83], v7 offset:416
    ds_read_b64_tr_b16 a[84:85], v7 offset:3104
    ds_read_b64_tr_b16 a[86:87], v7 offset:3488
    ds_read_b64_tr_b16 a[88:89], v7 offset:6176
    ds_read_b64_tr_b16 a[90:91], v7 offset:6560
    ds_read_b64_tr_b16 a[92:93], v7 offset:9248
    ds_read_b64_tr_b16 a[94:95], v7 offset:9632
    s_waitcnt lgkmcnt(0)
    ds_read_b64_tr_b16 a[96:97], v7 offset:12320
    ds_read_b64_tr_b16 a[98:99], v7 offset:12704
    ds_read_b64_tr_b16 a[100:101], v7 offset:15392
    ds_read_b64_tr_b16 a[102:103], v7 offset:15776
    ds_read_b64_tr_b16 a[104:105], v7 offset:18464
    ds_read_b64_tr_b16 a[106:107], v7 offset:18848
    ds_read_b64_tr_b16 a[108:109], v7 offset:21536
    ds_read_b64_tr_b16 a[110:111], v7 offset:21920
    ds_read_b64_tr_b16 a[112:113], v7 offset:24608
    ds_read_b64_tr_b16 a[114:115], v7 offset:24992
    ds_read_b64_tr_b16 a[116:117], v7 offset:27680
    ds_read_b64_tr_b16 a[118:119], v7 offset:28064
    s_waitcnt lgkmcnt(0)
    ds_read_b64_tr_b16 a[120:121], v7 offset:30752
    ds_read_b64_tr_b16 a[122:123], v7 offset:31136
    ds_read_b64_tr_b16 a[124:125], v7 offset:33824
    ds_read_b64_tr_b16 a[126:127], v7 offset:34208
    ds_read_b64_tr_b16 a[128:129], v7 offset:36896
    ds_read_b64_tr_b16 a[130:131], v7 offset:37280
    ds_read_b64_tr_b16 a[132:133], v7 offset:39968
    ds_read_b64_tr_b16 a[134:135], v7 offset:40352
    ds_read_b64_tr_b16 a[136:137], v7 offset:43040
    ds_read_b64_tr_b16 a[138:139], v7 offset:43424
    ds_read_b64_tr_b16 a[140:141], v7 offset:46112
    ds_read_b64_tr_b16 a[142:143], v7 offset:46496
    s_waitcnt lgkmcnt(0)
    ds_read_b64_tr_b16 a[144:145], v7 offset:49184
    ds_read_b64_tr_b16 a[146:147], v7 offset:49568
    ds_read_b64_tr_b16 a[148:149], v7 offset:52256
    ds_read_b64_tr_b16 a[150:151], v7 offset:52640
    ds_read_b64_tr_b16 a[152:153], v7 offset:55328
    ds_read_b64_tr_b16 a[154:155], v7 offset:55712
    ds_read_b64_tr_b16 a[156:157], v7 offset:58400
    ds_read_b64_tr_b16 a[158:159], v7 offset:58784
    ds_read_b64_tr_b16 a[160:161], v7 offset:64
    ds_read_b64_tr_b16 a[162:163], v7 offset:448
    ds_read_b64_tr_b16 a[164:165], v7 offset:3136
    ds_read_b64_tr_b16 a[166:167], v7 offset:3520
    s_waitcnt lgkmcnt(0)
    ds_read_b64_tr_b16 a[168:169], v7 offset:6208
    ds_read_b64_tr_b16 a[170:171], v7 offset:6592
    ds_read_b64_tr_b16 a[172:173], v7 offset:9280
    ds_read_b64_tr_b16 a[174:175], v7 offset:9664
    ds_read_b64_tr_b16 a[176:177], v7 offset:12352
    ds_read_b64_tr_b16 a[178:179], v7 offset:12736
    ds_read_b64_tr_b16 a[180:181], v7 offset:15424
    ds_read_b64_tr_b16 a[182:183], v7 offset:15808
    ds_read_b64_tr_b16 a[184:185], v7 offset:18496
    ds_read_b64_tr_b16 a[186:187], v7 offset:18880
    ds_read_b64_tr_b16 a[188:189], v7 offset:21568
    ds_read_b64_tr_b16 a[190:191], v7 offset:21952
    s_waitcnt lgkmcnt(0)
    ds_read_b64_tr_b16 a[192:193], v7 offset:24640
    ds_read_b64_tr_b16 a[194:195], v7 offset:25024
    ds_read_b64_tr_b16 a[196:197], v7 offset:27712
    ds_read_b64_tr_b16 a[198:199], v7 offset:28096
    ds_read_b64_tr_b16 a[200:201], v7 offset:30784
    ds_read_b64_tr_b16 a[202:203], v7 offset:31168
    ds_read_b64_tr_b16 a[204:205], v7 offset:33856
    ds_read_b64_tr_b16 a[206:207], v7 offset:34240
    ds_read_b64_tr_b16 a[208:209], v7 offset:36928
    ds_read_b64_tr_b16 a[210:211], v7 offset:37312
    ds_read_b64_tr_b16 a[212:213], v7 offset:40000
    ds_read_b64_tr_b16 a[214:215], v7 offset:40384
    s_waitcnt lgkmcnt(0)
    ds_read_b64_tr_b16 a[216:217], v7 offset:43072
    ds_read_b64_tr_b16 a[218:219], v7 offset:43456
    ds_read_b64_tr_b16 a[220:221], v7 offset:46144
    ds_read_b64_tr_b16 a[222:223], v7 offset:46528
    ds_read_b64_tr_b16 a[224:225], v7 offset:49216
    ds_read_b64_tr_b16 a[226:227], v7 offset:49600
    ds_read_b64_tr_b16 a[228:229], v7 offset:52288
    ds_read_b64_tr_b16 a[230:231], v7 offset:52672
    ds_read_b64_tr_b16 a[232:233], v7 offset:55360
    ds_read_b64_tr_b16 a[234:235], v7 offset:55744
    ds_read_b64_tr_b16 a[236:237], v7 offset:58432
    ds_read_b64_tr_b16 a[238:239], v7 offset:58816
    s_waitcnt lgkmcnt(0)
rc_wsk_11:
    s_waitcnt lgkmcnt(0)
    s_barrier
rc_nowo_12:
    s_barrier
    v_lshlrev_b32 v31, 7, v2
    v_lshl_add_u32 v31, v3, 4, v31
    s_mul_i32 s64, s56, 10240
    s_add_u32 s64, s64, 1179648
    s_lshl_b32 s65, s59, 10
    s_add_u32 s66, s59, 8
    s_min_u32 s66, s66, 9
    s_lshl_b32 s66, s66, 10
    v_lshlrev_b32 v22, 4, v4
    v_add_u32 v7, s65, v22
    v_add_u32 v8, s66, v22
    v_add_u32 v5, s64, v7
    v_add_u32 v6, s64, v8
    v_mov_b32 v9, v31
    v_lshlrev_b32 v11, 3, v4
    v_add_u32 v11, 10240, v11
    v_add_u32 v10, s65, v11
    s_lshl_b32 s64, s56, 6
    s_add_u32 s64, s64, s57
    s_mul_i32 s64, s64, 2560
    s_lshl_b32 s65, s59, 9
    s_add_u32 s65, s65, s64
    s_add_u32 s65, s65, 0
    v_add_u32 v12, s65, v31
    s_lshl_b32 s64, s56, 6
    s_and_b32 s65, s57, 28
    s_add_u32 s64, s64, s65
    s_mul_i32 s64, s64, 2560
    s_add_u32 s64, s64, 0
    v_lshrrev_b32 v13, 3, v1
    v_mul_u32_u24 v13, 5120, v13
    v_add_u32 v13, v13, v31
    v_add_u32 v13, s64, v13
    s_mul_i32 s64, s56, 49152
    s_add_u32 s64, s64, 655360
    v_mov_b32 v14, v31
    s_mul_i32 s65, s57, 3
    s_add_u32 s65, s65, 0
    s_lshr_b32 s66, s65, 1
    s_lshl_b32 s66, s66, 9
    s_and_b32 s65, s65, 1
    s_lshl_b32 s65, s65, 3
    s_add_u32 s66, s66, s65
    s_add_u32 s70, s66, s64
    s_mul_i32 s65, s57, 3
    s_add_u32 s65, s65, 1
    s_lshr_b32 s66, s65, 1
    s_lshl_b32 s66, s66, 9
    s_and_b32 s65, s65, 1
    s_lshl_b32 s65, s65, 3
    s_add_u32 s66, s66, s65
    s_add_u32 s71, s66, s64
    s_mul_i32 s65, s57, 3
    s_add_u32 s65, s65, 2
    s_lshr_b32 s66, s65, 1
    s_lshl_b32 s66, s66, 9
    s_and_b32 s65, s65, 1
    s_lshl_b32 s65, s65, 3
    s_add_u32 s66, s66, s65
    s_add_u32 s72, s66, s64
    v_lshrrev_b32 v22, 3, v1
    v_lshl_add_u32 v22, v22, 9, v31
    s_mul_i32 s65, s59, 6144
    s_add_u32 s65, s65, s64
    v_add_u32 v15, s65, v22
    s_lshl_b32 s64, s57, 12
    s_add_u32 s64, s64, 851968
    v_add_u32 v17, s64, v22
    s_lshl_b32 s65, s56, 10
    v_add_u32 v16, s65, v17
    v_lshrrev_b32 v18, 3, v1
    v_lshlrev_b32 v18, 1, v18
    v_lshrrev_b32 v22, 1, v2
    v_add_u32 v18, v18, v22
    v_lshlrev_b32 v18, 7, v18
    v_lshl_add_u32 v18, v3, 4, v18
    v_and_b32 v22, 1, v2
    v_lshl_add_u32 v18, v22, 3, v18
    s_mul_i32 s64, s56, 10240
    s_lshl_b32 s65, s57, 9
    s_add_u32 s64, s64, s65
    s_add_u32 s64, s64, 1179648
    v_add_u32 v18, s64, v18
    s_sub_u32 s64, s59, 1
    s_lshl_b32 s64, s64, 4
    s_and_b32 s64, s64, 31
    v_add_u32 v19, s64, v1
    v_lshlrev_b32 v19, 5, v19
    v_lshl_add_u32 v19, v2, 3, v19
    v_add_u32 v19, 40960, v19
    v_lshlrev_b32 v21, 5, v3
    v_lshl_add_u32 v21, v2, 3, v21
    s_mul_i32 s64, s61, 768
    v_add_u32 v21, s64, v21
    s_mul_i32 s65, s61, 48
    v_add_u32 v22, s65, v1
    v_lshlrev_b32 v20, 6, v1
    v_and_b32 v23, 1, v2
    v_lshl_add_u32 v20, v23, 4, v20
    v_lshrrev_b32 v24, 1, v2
    v_lshl_add_u32 v20, v24, 3, v20
    v_lshlrev_b32 v28, 4, v22
    v_lshl_add_u32 v28, v23, 3, v28
    v_add_u32 v20, 49152, v20
    s_mul_i32 s64, s61, 768
    v_subrev_u32 v47, s64, v21
    s_lshl_b32 s65, s59, 8
    s_add_u32 s65, s65, 57344
    v_add_u32 v47, s65, v47
    v_min_u32 v38, 47, v4
    v_lshlrev_b32 v38, 4, v38
    v_add_u32 v39, 57344, v38
    v_add_u32 v38, s64, v38
    v_subrev_u32 v37, s64, v28
    v_add_u32 v37, 58112, v37
    s_mul_i32 s64, s61, 3072
    v_lshl_add_u32 v34, v4, 4, s64
    v_lshrrev_b32 v29, 3, v1
    v_lshlrev_b32 v29, 10, v29
    v_lshl_add_u32 v29, v2, 8, v29
    v_lshl_add_u32 v29, v3, 4, v29
    v_add_u32 v29, 16384, v29
    s_lshl_b32 s64, s59, 11
    s_add_u32 s64, s64, 16384
    v_lshl_add_u32 v30, v4, 4, s64
    v_cmp_gt_u32 s[74:75], 2, v2
    v_cmp_gt_u32 s[12:13], 8, v1
    s_nop 1
    s_orn2_b64 s[74:75], s[74:75], s[12:13]
    v_mov_b32 v24, -1
    v_mov_b32 v25, -1
    v_mov_b32 v26, -1
    v_mov_b32 v27, -1
    v_mov_b32 v32, 0xf149f2ca
    s_mov_b32 s76, 0x3d93cd3a
    s_mov_b32 s77, s76
    s_mov_b32 s68, 0x3fb8aa3b
    s_mov_b32 s69, s68
    s_mul_i32 s78, s60, 12288
    s_mul_i32 s79, s60, 3072
    s_mov_b32 s62, 0
    v_mov_b32 v33, 68
    s_mov_b32 s93, 0
wi_p_13:
    buffer_load_dword v22, v33, s[32:35], 0 offen sc1
    s_waitcnt vmcnt(0)
    v_cmp_le_u32 vcc, 256, v22
    s_cbranch_vccnz wi_ok_14
    s_sleep 4
    s_add_u32 s93, s93, 1
    s_cmp_lt_u32 s93, 1048576
    s_cbranch_scc1 wi_p_13
wi_ok_14:
    s_cmp_lg_u32 s58, 0
    s_cbranch_scc1 cm_ok_15
    v_and_b32 v33, 7, v0
    v_lshlrev_b32 v33, 2, v33
    buffer_load_dword v22, v33, s[32:35], 0 offen sc1
    s_waitcnt vmcnt(0)
    v_cmp_ne_u32 vcc, 32, v22
    s_cbranch_vccz cm_ok_15
    s_mov_b32 s58, 1
    s_lshr_b32 s56, s88, 5
    s_and_b32 s57, s88, 31
    s_barrier
    s_branch rc_restart_8
cm_ok_15:
    s_cmp_lg_u32 s59, 3
    s_cbranch_scc1 rc_pe_16
    s_mov_b32 s64, 1277952
    v_mov_b32 v33, s64
rc_kvp_17:
    buffer_load_dword v22, v33, s[36:39], 0 offen sc1
    s_waitcnt vmcnt(0)
    v_cmp_le_u32 vcc, 65, v22
    s_cbranch_vccnz rc_kvok_18
    s_sleep 4
    s_add_u32 s63, s63, 1
    s_cmp_lt_u32 s63, 1048576
    s_cbranch_scc1 rc_kvp_17
rc_kvok_18:
    s_add_u32 s64, s64, 256
    s_min_u32 s64, s64, 1294080
    v_mov_b32 v33, s64
    buffer_load_dword v76, v33, s[36:39], 0 offen sc1
    s_mov_b32 s64, 40960
    s_mov_b32 s65, 49152
    s_mov_b32 m0, s64
    s_nop 0
    buffer_load_dwordx4 v34, s[40:43], s78 offen offset:0 sc1 lds
    s_mov_b32 m0, s65
    s_nop 0
    buffer_load_dwordx4 v34, s[44:47], s78 offen offset:0 sc1 lds
    s_mov_b32 m0, s64
    s_nop 0
    buffer_load_dwordx4 v34, s[40:43], s78 offen offset:1024 sc1 lds
    s_mov_b32 m0, s65
    s_nop 0
    buffer_load_dwordx4 v34, s[44:47], s78 offen offset:1024 sc1 lds
    s_mov_b32 m0, s64
    s_nop 0
    buffer_load_dwordx4 v34, s[40:43], s78 offen offset:2048 sc1 lds
    s_mov_b32 m0, s65
    s_nop 0
    buffer_load_dwordx4 v34, s[44:47], s78 offen offset:2048 sc1 lds
rc_pe_16:
    s_add_u32 s78, s78, 393216
rc_loop_20:
    s_and_b32 s64, s62, 1
    s_xor_b32 s65, s64, 1
    s_mul_i32 s80, s64, 81920
    s_mul_i32 s81, s65, 81920
    s_mul_i32 s82, s64, 24576
    s_mul_i32 s83, s65, 24576
    s_mul_i32 s84, s64, 40960
    s_mul_i32 s85, s65, 40960
    s_and_b32 s64, s62, 3
    s_mul_i32 s86, s64, 81920
    s_add_u32 s64, s62, 2
    s_and_b32 s64, s64, 3
    s_mul_i32 s87, s64, 81920
rc_ld_21:
    v_add_u32 v23, 4096, v5
    buffer_load_dwordx4 v[128:131], v5, s[36:39], s85 offen sc1
    buffer_load_dwordx4 v[132:135], v23, s[36:39], s85 offen sc1
    buffer_load_dwordx4 v[136:139], v6, s[36:39], s85 offen sc1
    s_waitcnt vmcnt(0)
    v_max3_u32 v22, v128, v129, v130
    v_max3_u32 v22, v22, v131, v132
    v_max3_u32 v22, v22, v133, v134
    v_max3_u32 v22, v22, v135, v136
    v_max3_u32 v22, v22, v137, v138
    v_max_u32 v22, v22, v139
    v_cmp_eq_u32 vcc, -1, v22
    s_cbranch_vccz ok_22
    s_add_u32 s63, s63, 1
    s_cmp_lt_u32 s63, 1048576
    s_cbranch_scc1 rc_ld_21
ok_22:
    ds_write_b128 v7, v[128:131]
    ds_write_b128 v7, v[132:135] offset:4096
    ds_write_b128 v8, v[136:139]
    s_waitcnt lgkmcnt(0)
    s_barrier
    ds_read_b128 v[80:83], v9 offset:0
    ds_read_b128 v[84:87], v9 offset:512
    ds_read_b128 v[88:91], v9 offset:1024
    ds_read_b128 v[92:95], v9 offset:1536
    ds_read_b128 v[96:99], v9 offset:2048
    ds_read_b128 v[100:103], v9 offset:2560
    ds_read_b128 v[104:107], v9 offset:3072
    ds_read_b128 v[108:111], v9 offset:3584
    ds_read_b128 v[112:115], v9 offset:4096
    ds_read_b128 v[116:119], v9 offset:4608
    ds_read_b128 v[120:123], v9 offset:5120
    ds_read_b128 v[124:127], v9 offset:5632
    s_cmp_eq_u32 s59, 3
    s_cbranch_scc1 rc_w3_23
    s_sub_u32 s67, s79, 98304
    s_and_b32 s64, s62, 1
    s_mul_i32 s64, s64, 3072
    v_add_u32 v33, s64, v19
    s_waitcnt lgkmcnt(11)
    v_mfma_f32_16x16x32_bf16 v[58:61], a[0:3], v[80:83], 0
    ds_read_b128 v[128:131], v9 offset:6144
    s_waitcnt lgkmcnt(11)
    v_mfma_f32_16x16x32_bf16 v[58:61], a[4:7], v[84:87], v[58:61]
    ds_read_b128 v[132:135], v9 offset:6656
    s_waitcnt lgkmcnt(11)
    v_mfma_f32_16x16x32_bf16 v[58:61], a[8:11], v[88:91], v[58:61]
    ds_read_b128 v[136:139], v9 offset:7168
    s_waitcnt lgkmcnt(11)
    v_mfma_f32_16x16x32_bf16 v[58:61], a[12:15], v[92:95], v[58:61]
    ds_read_b128 v[140:143], v9 offset:7680
    s_waitcnt lgkmcnt(11)
    v_mfma_f32_16x16x32_bf16 v[58:61], a[16:19], v[96:99], v[58:61]
    ds_read_b128 v[144:147], v9 offset:8192
    s_waitcnt lgkmcnt(11)
    v_mfma_f32_16x16x32_bf16 v[58:61], a[20:23], v[100:103], v[58:61]
    ds_read_b128 v[148:151], v9 offset:8704
    s_waitcnt lgkmcnt(11)
    v_mfma_f32_16x16x32_bf16 v[58:61], a[24:27], v[104:107], v[58:61]
    ds_read_b128 v[152:155], v9 offset:9216
    s_waitcnt lgkmcnt(11)
    v_mfma_f32_16x16x32_bf16 v[58:61], a[28:31], v[108:111], v[58:61]
    ds_read_b128 v[156:159], v9 offset:9728
    s_waitcnt lgkmcnt(11)
    v_mfma_f32_16x16x32_bf16 v[58:61], a[32:35], v[112:115], v[58:61]
    s_waitcnt lgkmcnt(10)
    v_mfma_f32_16x16x32_bf16 v[58:61], a[36:39], v[116:119], v[58:61]
    s_waitcnt lgkmcnt(9)
    v_mfma_f32_16x16x32_bf16 v[58:61], a[40:43], v[120:123], v[58:61]
    s_waitcnt lgkmcnt(8)
    v_mfma_f32_16x16x32_bf16 v[58:61], a[44:47], v[124:127], v[58:61]
    s_waitcnt lgkmcnt(7)
    v_mfma_f32_16x16x32_bf16 v[58:61], a[48:51], v[128:131], v[58:61]
    s_waitcnt lgkmcnt(6)
    v_mfma_f32_16x16x32_bf16 v[58:61], a[52:55], v[132:135], v[58:61]
    s_waitcnt lgkmcnt(5)
    v_mfma_f32_16x16x32_bf16 v[58:61], a[56:59], v[136:139], v[58:61]
    s_waitcnt lgkmcnt(4)
    v_mfma_f32_16x16x32_bf16 v[58:61], a[60:63], v[140:143], v[58:61]
    s_waitcnt lgkmcnt(3)
    v_mfma_f32_16x16x32_bf16 v[58:61], a[64:67], v[144:147], v[58:61]
    s_waitcnt lgkmcnt(2)
    v_mfma_f32_16x16x32_bf16 v[58:61], a[68:71], v[148:151], v[58:61]
    s_waitcnt lgkmcnt(1)
    v_mfma_f32_16x16x32_bf16 v[58:61], a[72:75], v[152:155], v[58:61]
    s_waitcnt lgkmcnt(0)
    v_mfma_f32_16x16x32_bf16 v[58:61], a[76:79], v[156:159], v[58:61]
    v_mfma_f32_16x16x32_bf16 v[62:65], a[80:83], v[80:83], 0
    ds_read_b64 v[72:73], v33 offset:0
    ds_read_b64 v[74:75], v33 offset:1024
    ds_read_b64 v[76:77], v33 offset:2048
    v_mfma_f32_16x16x32_bf16 v[62:65], a[84:87], v[84:87], v[62:65]
    v_mfma_f32_16x16x32_bf16 v[62:65], a[88:91], v[88:91], v[62:65]
    v_mfma_f32_16x16x32_bf16 v[62:65], a[92:95], v[92:95], v[62:65]
    s_nop 3
    v_cvt_pk_bf16_f32 v66, v58, v59
    v_cvt_pk_bf16_f32 v67, v60, v61
    ds_write_b64 v10, v[66:67]
    v_mfma_f32_16x16x32_bf16 v[62:65], a[96:99], v[96:99], v[62:65]
    v_mfma_f32_16x16x32_bf16 v[62:65], a[100:103], v[100:103], v[62:65]
    s_waitcnt lgkmcnt(0)
    s_barrier
    ds_read_b64 v[40:41], v11 offset:0
    ds_read_b64 v[42:43], v11 offset:1024
    ds_read_b64 v[44:45], v11 offset:2048
    v_mfma_f32_16x16x32_bf16 v[62:65], a[104:107], v[104:107], v[62:65]
    v_mfma_f32_16x16x32_bf16 v[62:65], a[108:111], v[108:111], v[62:65]
    v_mfma_f32_16x16x32_bf16 v[62:65], a[112:115], v[112:115], v[62:65]
    v_mfma_f32_16x16x32_bf16 v[62:65], a[116:119], v[116:119], v[62:65]
    v_mfma_f32_16x16x32_bf16 v[62:65], a[120:123], v[120:123], v[62:65]
    s_waitcnt lgkmcnt(0)
    v_mfma_f32_16x16x16_bf16 v[48:51], v[72:73], v[40:41], 0
    v_mfma_f32_16x16x16_bf16 v[48:51], v[74:75], v[42:43], v[48:51]
    v_mfma_f32_16x16x16_bf16 v[48:51], v[76:77], v[44:45], v[48:51]
    v_mfma_f32_16x16x32_bf16 v[62:65], a[124:127], v[124:127], v[62:65]
    v_mfma_f32_16x16x32_bf16 v[62:65], a[128:131], v[128:131], v[62:65]
    v_mfma_f32_16x16x32_bf16 v[62:65], a[132:135], v[132:135], v[62:65]
    v_mfma_f32_16x16x32_bf16 v[62:65], a[136:139], v[136:139], v[62:65]
    v_mfma_f32_16x16x32_bf16 v[62:65], a[140:143], v[140:143], v[62:65]
    v_mfma_f32_16x16x32_bf16 v[62:65], a[144:147], v[144:147], v[62:65]
    s_cmp_eq_u32 s59, 0
    s_cbranch_scc1 rc_w0c_26
    s_cmp_lg_u32 s58, 0
    s_cbranch_scc1 st_sc_27
    buffer_store_dwordx4 v[48:51], v12, s[36:39], s80 offen offset:1024
    s_branch st_e_28
st_sc_27:
    buffer_store_dwordx4 v[48:51], v12, s[36:39], s80 offen offset:1024 sc1
st_e_28:
rc_w0c_26:
    v_mfma_f32_16x16x32_bf16 v[62:65], a[148:151], v[148:151], v[62:65]
    v_mfma_f32_16x16x32_bf16 v[62:65], a[152:155], v[152:155], v[62:65]
    v_mfma_f32_16x16x32_bf16 v[62:65], a[156:159], v[156:159], v[62:65]
    s_nop 7
    v_cvt_pk_bf16_f32 v68, v62, v63
    v_cvt_pk_bf16_f32 v69, v64, v65
    s_nop 1
    v_mfma_f32_16x16x16_bf16 v[52:55], v[68:69], v[66:67], 0
    v_min_u32 v70, -2, v68
    v_min_u32 v71, -2, v69
    s_nop 5
    s_cmp_lg_u32 s58, 0
    s_cbranch_scc1 st_sc_29
    buffer_store_dwordx4 v[52:55], v12, s[36:39], s80 offen
    buffer_store_dwordx4 v[24:27], v12, s[36:39], s81 offen
    s_branch st_e_30
st_sc_29:
    buffer_store_dwordx4 v[52:55], v12, s[36:39], s80 offen sc1
    buffer_store_dwordx4 v[24:27], v12, s[36:39], s81 offen sc1
st_e_30:
    s_cmp_eq_u32 s59, 0
    s_cbranch_scc1 rc_w0d_31
    s_cmp_lg_u32 s58, 0
    s_cbranch_scc1 st_sc_32
    buffer_store_dwordx4 v[24:27], v12, s[36:39], s81 offen offset:1024
    s_branch st_e_33
st_sc_32:
    buffer_store_dwordx4 v[24:27], v12, s[36:39], s81 offen offset:1024 sc1
st_e_33:
rc_w0d_31:
    ds_write_b64 v47, v[70:71]
    s_cmp_lg_u32 s62, 63
    s_cbranch_scc1 rc_nl0_34
    s_lshl_b32 s64, s59, 8
    s_add_u32 s64, s64, s79
    buffer_store_dwordx2 v[70:71], v21, s[48:51], s64 offen sc1
rc_nl0_34:
    s_waitcnt lgkmcnt(0)
    s_branch rc_red_24
rc_w3_23:
    s_sub_u32 s67, s79, 98304
    s_cmp_eq_u32 s62, 0
    s_cselect_b32 s67, 0x7f000000, s67
    s_and_b32 s64, s62, 1
    s_xor_b32 s65, s64, 1
    s_mul_i32 s64, s64, 3072
    s_mul_i32 s65, s65, 3072
    v_add_u32 v33, s64, v20
    s_add_u32 s3, s65, 40960
    s_add_u32 s73, s65, 49152
    v_mov_b32 v35, v33
    s_waitcnt lgkmcnt(11)
    v_mfma_f32_16x16x32_bf16 v[58:61], v[80:83], a[0:3], 0
    v_mfma_f32_16x16x32_bf16 v[62:65], v[80:83], a[80:83], 0
    v_mfma_f32_16x16x32_bf16 v[66:69], v[80:83], a[160:163], 0
    ds_read_b128 v[80:83], v9 offset:6144
    s_waitcnt lgkmcnt(11)
    v_mfma_f32_16x16x32_bf16 v[58:61], v[84:87], a[4:7], v[58:61]
    v_mfma_f32_16x16x32_bf16 v[62:65], v[84:87], a[84:87], v[62:65]
    v_mfma_f32_16x16x32_bf16 v[66:69], v[84:87], a[164:167], v[66:69]
    ds_read_b128 v[84:87], v9 offset:6656
    s_waitcnt lgkmcnt(11)
    v_mfma_f32_16x16x32_bf16 v[58:61], v[88:91], a[8:11], v[58:61]
    v_mfma_f32_16x16x32_bf16 v[62:65], v[88:91], a[88:91], v[62:65]
    v_mfma_f32_16x16x32_bf16 v[66:69], v[88:91], a[168:171], v[66:69]
    ds_read_b128 v[88:91], v9 offset:7168
    s_waitcnt lgkmcnt(11)
    v_mfma_f32_16x16x32_bf16 v[58:61], v[92:95], a[12:15], v[58:61]
    v_mfma_f32_16x16x32_bf16 v[62:65], v[92:95], a[92:95], v[62:65]
    v_mfma_f32_16x16x32_bf16 v[66:69], v[92:95], a[172:175], v[66:69]
    ds_read_b128 v[92:95], v9 offset:7680
    s_waitcnt lgkmcnt(11)
    v_mfma_f32_16x16x32_bf16 v[58:61], v[96:99], a[16:19], v[58:61]
    v_mfma_f32_16x16x32_bf16 v[62:65], v[96:99], a[96:99], v[62:65]
    v_mfma_f32_16x16x32_bf16 v[66:69], v[96:99], a[176:179], v[66:69]
    ds_read_b128 v[96:99], v9 offset:8192
    s_waitcnt lgkmcnt(11)
    v_mfma_f32_16x16x32_bf16 v[58:61], v[100:103], a[20:23], v[58:61]
    v_mfma_f32_16x16x32_bf16 v[62:65], v[100:103], a[100:103], v[62:65]
    v_mfma_f32_16x16x32_bf16 v[66:69], v[100:103], a[180:183], v[66:69]
    ds_read_b128 v[100:103], v9 offset:8704
    s_waitcnt lgkmcnt(11)
    v_mfma_f32_16x16x32_bf16 v[58:61], v[104:107], a[24:27], v[58:61]
    v_mfma_f32_16x16x32_bf16 v[62:65], v[104:107], a[104:107], v[62:65]
    v_mfma_f32_16x16x32_bf16 v[66:69], v[104:107], a[184:187], v[66:69]
    ds_read_b128 v[104:107], v9 offset:9216
    s_waitcnt lgkmcnt(11)
    v_mfma_f32_16x16x32_bf16 v[58:61], v[108:111], a[28:31], v[58:61]
    v_mfma_f32_16x16x32_bf16 v[62:65], v[108:111], a[108:111], v[62:65]
    v_mfma_f32_16x16x32_bf16 v[66:69], v[108:111], a[188:191], v[66:69]
    ds_read_b128 v[108:111], v9 offset:9728
    s_waitcnt lgkmcnt(11)
    v_mfma_f32_16x16x32_bf16 v[58:61], v[112:115], a[32:35], v[58:61]
    v_mfma_f32_16x16x32_bf16 v[62:65], v[112:115], a[112:115], v[62:65]
    v_mfma_f32_16x16x32_bf16 v[66:69], v[112:115], a[192:195], v[66:69]
    s_barrier
    s_waitcnt lgkmcnt(10)
    v_mfma_f32_16x16x32_bf16 v[58:61], v[116:119], a[36:39], v[58:61]
    v_mfma_f32_16x16x32_bf16 v[62:65], v[116:119], a[116:119], v[62:65]
    v_mfma_f32_16x16x32_bf16 v[66:69], v[116:119], a[196:199], v[66:69]
    s_waitcnt lgkmcnt(9)
    v_mfma_f32_16x16x32_bf16 v[58:61], v[120:123], a[40:43], v[58:61]
    v_mfma_f32_16x16x32_bf16 v[62:65], v[120:123], a[120:123], v[62:65]
    v_mfma_f32_16x16x32_bf16 v[66:69], v[120:123], a[200:203], v[66:69]
    s_waitcnt lgkmcnt(8)
    v_mfma_f32_16x16x32_bf16 v[58:61], v[124:127], a[44:47], v[58:61]
    v_mfma_f32_16x16x32_bf16 v[62:65], v[124:127], a[124:127], v[62:65]
    v_mfma_f32_16x16x32_bf16 v[66:69], v[124:127], a[204:207], v[66:69]
    s_waitcnt lgkmcnt(7)
    v_mfma_f32_16x16x32_bf16 v[58:61], v[80:83], a[48:51], v[58:61]
    v_mfma_f32_16x16x32_bf16 v[62:65], v[80:83], a[128:131], v[62:65]
    v_mfma_f32_16x16x32_bf16 v[66:69], v[80:83], a[208:211], v[66:69]
    s_waitcnt lgkmcnt(6)
    v_mfma_f32_16x16x32_bf16 v[58:61], v[84:87], a[52:55], v[58:61]
    v_mfma_f32_16x16x32_bf16 v[62:65], v[84:87], a[132:135], v[62:65]
    v_mfma_f32_16x16x32_bf16 v[66:69], v[84:87], a[212:215], v[66:69]
    s_waitcnt lgkmcnt(5)
    v_mfma_f32_16x16x32_bf16 v[58:61], v[88:91], a[56:59], v[58:61]
    v_mfma_f32_16x16x32_bf16 v[62:65], v[88:91], a[136:139], v[62:65]
    v_mfma_f32_16x16x32_bf16 v[66:69], v[88:91], a[216:219], v[66:69]
    ds_read_b64 v[46:47], v35 offset:0
    ds_read_b64 v[48:49], v35 offset:32
    ds_read_b64 v[50:51], v35 offset:1024
    ds_read_b64 v[52:53], v35 offset:1056
    ds_read_b64 v[54:55], v35 offset:2048
    ds_read_b64 v[56:57], v35 offset:2080
    s_waitcnt lgkmcnt(10)
    v_mfma_f32_16x16x32_bf16 v[58:61], v[92:95], a[60:63], v[58:61]
    v_mfma_f32_16x16x32_bf16 v[62:65], v[92:95], a[140:143], v[62:65]
    v_mfma_f32_16x16x32_bf16 v[66:69], v[92:95], a[220:223], v[66:69]
    s_waitcnt lgkmcnt(9)
    v_mfma_f32_16x16x32_bf16 v[58:61], v[96:99], a[64:67], v[58:61]
    v_mfma_f32_16x16x32_bf16 v[62:65], v[96:99], a[144:147], v[62:65]
    v_mfma_f32_16x16x32_bf16 v[66:69], v[96:99], a[224:227], v[66:69]
    s_waitcnt lgkmcnt(8)
    v_mfma_f32_16x16x32_bf16 v[58:61], v[100:103], a[68:71], v[58:61]
    v_mfma_f32_16x16x32_bf16 v[62:65], v[100:103], a[148:151], v[62:65]
    v_mfma_f32_16x16x32_bf16 v[66:69], v[100:103], a[228:231], v[66:69]
    s_waitcnt lgkmcnt(7)
    v_mfma_f32_16x16x32_bf16 v[58:61], v[104:107], a[72:75], v[58:61]
    v_mfma_f32_16x16x32_bf16 v[62:65], v[104:107], a[152:155], v[62:65]
    v_mfma_f32_16x16x32_bf16 v[66:69], v[104:107], a[232:235], v[66:69]
    s_waitcnt lgkmcnt(6)
    v_mfma_f32_16x16x32_bf16 v[58:61], v[108:111], a[76:79], v[58:61]
    v_mfma_f32_16x16x32_bf16 v[62:65], v[108:111], a[156:159], v[62:65]
    v_mfma_f32_16x16x32_bf16 v[66:69], v[108:111], a[236:239], v[66:69]
    s_waitcnt lgkmcnt(0)
    s_nop 6
    v_cvt_pk_bf16_f32 v40, v58, v59
    v_cvt_pk_bf16_f32 v41, v60, v61
    v_cvt_pk_bf16_f32 v42, v62, v63
    v_cvt_pk_bf16_f32 v43, v64, v65
    v_cvt_pk_bf16_f32 v44, v66, v67
    v_cvt_pk_bf16_f32 v45, v68, v69
    v_min_u32 v40, -2, v40
    v_min_u32 v41, -2, v41
    v_min_u32 v42, -2, v42
    v_min_u32 v43, -2, v43
    v_min_u32 v44, -2, v44
    v_min_u32 v45, -2, v45
    ds_write_b64 v37, v[40:41] offset:0
    ds_write_b64 v37, v[42:43] offset:256
    ds_write_b64 v37, v[44:45] offset:512
    s_cmp_lg_u32 s62, 63
    s_cbranch_scc1 rc_notlast_35
    buffer_store_dwordx2 v[40:41], v28, s[52:55], s79 offen offset:0 sc1
    buffer_store_dwordx2 v[42:43], v28, s[52:55], s79 offen offset:256 sc1
    buffer_store_dwordx2 v[44:45], v28, s[52:55], s79 offen offset:512 sc1
    s_branch rc_done_1
rc_notlast_35:
rc_la_36:
    v_add_u32 v33, 2560, v13
    buffer_load_dwordx4 v[80:83], v13, s[36:39], s80 offen offset:0 sc1
    buffer_load_dwordx4 v[84:87], v13, s[36:39], s80 offen offset:512 sc1
    buffer_load_dwordx4 v[88:91], v13, s[36:39], s80 offen offset:1024 sc1
    buffer_load_dwordx4 v[92:95], v13, s[36:39], s80 offen offset:1536 sc1
    buffer_load_dwordx4 v[96:99], v13, s[36:39], s80 offen offset:2048 sc1
    buffer_load_dwordx4 v[100:103], v33, s[36:39], s80 offen offset:0 sc1
    buffer_load_dwordx4 v[104:107], v33, s[36:39], s80 offen offset:512 sc1
    buffer_load_dwordx4 v[108:111], v33, s[36:39], s80 offen offset:1024 sc1
    buffer_load_dwordx4 v[112:115], v33, s[36:39], s80 offen offset:1536 sc1
    buffer_load_dwordx4 v[116:119], v33, s[36:39], s80 offen offset:2048 sc1
    s_sleep 3
pp_l_37:
    buffer_load_dwordx4 v[120:123], v13, s[36:39], s80 offen offset:0 sc1
    buffer_load_dwordx4 v[124:127], v13, s[36:39], s80 offen offset:512 sc1
    buffer_load_dwordx4 v[128:131], v13, s[36:39], s80 offen offset:1024 sc1
    buffer_load_dwordx4 v[132:135], v13, s[36:39], s80 offen offset:1536 sc1
    buffer_load_dwordx4 v[136:139], v13, s[36:39], s80 offen offset:2048 sc1
    buffer_load_dwordx4 v[140:143], v33, s[36:39], s80 offen offset:0 sc1
    buffer_load_dwordx4 v[144:147], v33, s[36:39], s80 offen offset:512 sc1
    buffer_load_dwordx4 v[148:151], v33, s[36:39], s80 offen offset:1024 sc1
    buffer_load_dwordx4 v[152:155], v33, s[36:39], s80 offen offset:1536 sc1
    buffer_load_dwordx4 v[156:159], v33, s[36:39], s80 offen offset:2048 sc1
    s_waitcnt vmcnt(10)
    v_max3_u32 v22, v80, v84, v88
    v_max3_u32 v22, v22, v92, v96
    v_max3_u32 v22, v22, v100, v104
    v_max3_u32 v22, v22, v108, v112
    v_max_u32 v22, v22, v116
    v_cmp_eq_u32 vcc, -1, v22
    s_cbranch_vccz pp_u1_38
    buffer_load_dwordx4 v[80:83], v13, s[36:39], s80 offen offset:0 sc1
    buffer_load_dwordx4 v[84:87], v13, s[36:39], s80 offen offset:512 sc1
    buffer_load_dwordx4 v[88:91], v13, s[36:39], s80 offen offset:1024 sc1
    buffer_load_dwordx4 v[92:95], v13, s[36:39], s80 offen offset:1536 sc1
    buffer_load_dwordx4 v[96:99], v13, s[36:39], s80 offen offset:2048 sc1
    buffer_load_dwordx4 v[100:103], v33, s[36:39], s80 offen offset:0 sc1
    buffer_load_dwordx4 v[104:107], v33, s[36:39], s80 offen offset:512 sc1
    buffer_load_dwordx4 v[108:111], v33, s[36:39], s80 offen offset:1024 sc1
    buffer_load_dwordx4 v[112:115], v33, s[36:39], s80 offen offset:1536 sc1
    buffer_load_dwordx4 v[116:119], v33, s[36:39], s80 offen offset:2048 sc1
    s_waitcnt vmcnt(10)
    v_max3_u32 v22, v120, v124, v128
    v_max3_u32 v22, v22, v132, v136
    v_max3_u32 v22, v22, v140, v144
    v_max3_u32 v22, v22, v148, v152
    v_max_u32 v22, v22, v156
    v_cmp_eq_u32 vcc, -1, v22
    s_cbranch_vccz pp_u2_39
    s_add_u32 s63, s63, 1
    s_cmp_lt_u32 s63, 1048576
    s_cbranch_scc1 pp_l_37
pp_u2_39:
    v_pk_add_f32 v[120:121], v[120:121], v[140:141]
    v_pk_add_f32 v[122:123], v[122:123], v[142:143]
    v_pk_add_f32 v[124:125], v[124:125], v[144:145]
    v_pk_add_f32 v[126:127], v[126:127], v[146:147]
    v_pk_add_f32 v[128:129], v[128:129], v[148:149]
    v_pk_add_f32 v[130:131], v[130:131], v[150:151]
    v_pk_add_f32 v[132:133], v[132:133], v[152:153]
    v_pk_add_f32 v[134:135], v[134:135], v[154:155]
    v_pk_add_f32 v[136:137], v[136:137], v[156:157]
    v_pk_add_f32 v[138:139], v[138:139], v[158:159]
    v_pk_add_f32 v[120:121], v[120:121], v[124:125]
    v_pk_add_f32 v[122:123], v[122:123], v[126:127]
    v_pk_add_f32 v[120:121], v[120:121], v[128:129]
    v_pk_add_f32 v[122:123], v[122:123], v[130:131]
    v_pk_mov_b32 v[124:125], v[132:133], v[132:133] op_sel:[0,1]
    v_pk_mov_b32 v[126:127], v[134:135], v[134:135] op_sel:[0,1]
    v_pk_mov_b32 v[128:129], v[136:137], v[136:137] op_sel:[0,1]
    v_pk_mov_b32 v[130:131], v[138:139], v[138:139] op_sel:[0,1]
    v_cndmask_b32 v58, v126, v120, s[12:13]
    v_cndmask_b32 v132, v120, v126, s[12:13]
    v_cndmask_b32 v59, v127, v121, s[12:13]
    v_cndmask_b32 v133, v121, v127, s[12:13]
    v_cndmask_b32 v60, v128, v122, s[12:13]
    v_cndmask_b32 v134, v122, v128, s[12:13]
    v_cndmask_b32 v61, v129, v123, s[12:13]
    v_cndmask_b32 v135, v123, v129, s[12:13]
    v_cndmask_b32 v62, v130, v124, s[12:13]
    v_cndmask_b32 v136, v124, v130, s[12:13]
    v_cndmask_b32 v63, v131, v125, s[12:13]
    v_cndmask_b32 v137, v125, v131, s[12:13]
    v_add_f32_dpp v58, v132, v58 row_ror:8 row_mask:0xf bank_mask:0xf
    v_add_f32_dpp v59, v133, v59 row_ror:8 row_mask:0xf bank_mask:0xf
    v_add_f32_dpp v60, v134, v60 row_ror:8 row_mask:0xf bank_mask:0xf
    v_add_f32_dpp v61, v135, v61 row_ror:8 row_mask:0xf bank_mask:0xf
    v_add_f32_dpp v62, v136, v62 row_ror:8 row_mask:0xf bank_mask:0xf
    v_add_f32_dpp v63, v137, v63 row_ror:8 row_mask:0xf bank_mask:0xf
    v_cvt_pk_bf16_f32 v120, v58, v59
    v_cvt_pk_bf16_f32 v121, v60, v61
    v_cvt_pk_bf16_f32 v122, v62, v63
    v_and_b32 v59, 0xffff0000, v120
    v_lshlrev_b32 v58, 16, v120
    v_and_b32 v61, 0xffff0000, v121
    v_lshlrev_b32 v60, 16, v121
    v_and_b32 v63, 0xffff0000, v122
    v_lshlrev_b32 v62, 16, v122
    v_pk_mul_f32 v[58:59], v[58:59], s[76:77]
    v_pk_mul_f32 v[60:61], v[60:61], s[76:77]
    v_pk_mul_f32 v[62:63], v[62:63], s[76:77]
    v_cvt_pk_bf16_f32 v120, v58, v59
    v_cvt_pk_bf16_f32 v121, v60, v61
    v_cvt_pk_bf16_f32 v122, v62, v63
    v_and_b32 v59, 0xffff0000, v120
    v_lshlrev_b32 v58, 16, v120
    v_and_b32 v61, 0xffff0000, v121
    v_lshlrev_b32 v60, 16, v121
    v_and_b32 v63, 0xffff0000, v122
    v_lshlrev_b32 v62, 16, v122
    v_cndmask_b32 v58, v32, v58, s[74:75]
    v_cndmask_b32 v59, v32, v59, s[74:75]
    v_cndmask_b32 v60, v32, v60, s[74:75]
    v_cndmask_b32 v61, v32, v61, s[74:75]
    v_max3_f32 v22, v62, v63, v58
    v_max3_f32 v23, v59, v60, v61
    v_max_f32 v22, v22, v23
    s_nop 1
    v_max_f32_dpp v22, v22, v22 row_ror:8 row_mask:0xf bank_mask:0xf
    v_mov_b32 v23, v22
    s_nop 1
    v_permlane16_swap_b32 v22, v23
    v_max_f32 v22, v22, v23
    v_mov_b32 v23, v22
    s_nop 1
    v_permlane32_swap_b32 v22, v23
    v_max_f32 v22, v22, v23
    v_mul_f32 v22, 0xbfb8aa3b, v22
    v_mov_b32 v23, v22
    v_pk_fma_f32 v[58:59], v[58:59], s[68:69], v[22:23]
    v_pk_fma_f32 v[60:61], v[60:61], s[68:69], v[22:23]
    v_pk_fma_f32 v[62:63], v[62:63], s[68:69], v[22:23]
    v_exp_f32 v58, v58
    v_exp_f32 v59, v59
    v_exp_f32 v60, v60
    v_exp_f32 v61, v61
    v_exp_f32 v62, v62
    v_exp_f32 v63, v63
    s_nop 0
    v_pk_add_f32 v[22:23], v[58:59], v[60:61]
    v_pk_add_f32 v[22:23], v[22:23], v[62:63]
    v_add_f32 v22, v22, v23
    s_nop 1
    v_add_f32_dpp v22, v22, v22 row_ror:8 row_mask:0xf bank_mask:0xf
    v_mov_b32 v23, v22
    s_nop 1
    v_permlane16_swap_b32 v22, v23
    v_add_f32 v22, v22, v23
    v_mov_b32 v23, v22
    s_nop 1
    v_permlane32_swap_b32 v22, v23
    v_add_f32 v22, v22, v23
    v_cmp_u_f32 vcc, v22, v22
    v_rcp_f32 v22, v22
    s_cbranch_vccz ok_41
    s_add_u32 s63, s63, 1
    s_cmp_lt_u32 s63, 1048576
    s_cbranch_scc1 rc_la_36
ok_41:
    v_mov_b32 v23, v22
    v_pk_mul_f32 v[58:59], v[58:59], v[22:23]
    v_pk_mul_f32 v[60:61], v[60:61], v[22:23]
    v_pk_mul_f32 v[62:63], v[62:63], v[22:23]
    v_cvt_pk_bf16_f32 v120, v58, v59
    v_cvt_pk_bf16_f32 v121, v60, v61
    v_cvt_pk_bf16_f32 v124, v62, v63
    s_nop 0
    v_mov_b32_dpp v125, v120 row_ror:8 row_mask:0xf bank_mask:0xf
    v_mov_b32_dpp v126, v121 row_ror:8 row_mask:0xf bank_mask:0xf
    v_mov_b32_dpp v127, v124 row_ror:8 row_mask:0xf bank_mask:0xf
    s_nop 1
    v_mfma_f32_16x16x32_bf16 v[128:131], v[46:49], v[124:127], 0
    v_mfma_f32_16x16x32_bf16 v[132:135], v[50:53], v[124:127], 0
    v_mfma_f32_16x16x32_bf16 v[136:139], v[54:57], v[124:127], 0
    v_mfma_f32_16x16x16_bf16 v[140:143], v[40:41], v[120:121], 0
    v_mfma_f32_16x16x16_bf16 v[144:147], v[42:43], v[120:121], 0
    v_mfma_f32_16x16x16_bf16 v[148:151], v[44:45], v[120:121], 0
    s_add_u32 s64, s70, s82
    s_add_u32 s65, s71, s82
    s_add_u32 s66, s72, s82
    s_nop 5
    v_pk_add_f32 v[128:129], v[128:129], v[140:141]
    v_pk_add_f32 v[130:131], v[130:131], v[142:143]
    v_pk_add_f32 v[132:133], v[132:133], v[144:145]
    v_pk_add_f32 v[134:135], v[134:135], v[146:147]
    v_pk_add_f32 v[136:137], v[136:137], v[148:149]
    v_pk_add_f32 v[138:139], v[138:139], v[150:151]
    v_cvt_pk_bf16_f32 v64, v128, v129
    v_cvt_pk_bf16_f32 v65, v130, v131
    v_min_u32 v64, -2, v64
    v_min_u32 v65, -2, v65
    v_cvt_pk_bf16_f32 v66, v132, v133
    v_cvt_pk_bf16_f32 v67, v134, v135
    v_min_u32 v66, -2, v66
    v_min_u32 v67, -2, v67
    v_cvt_pk_bf16_f32 v68, v136, v137
    v_cvt_pk_bf16_f32 v69, v138, v139
    v_min_u32 v68, -2, v68
    v_min_u32 v69, -2, v69
    s_mov_b64 exec, s[12:13]
    s_cmp_lg_u32 s58, 0
    s_cbranch_scc1 st_sc_42
    buffer_store_dwordx2 v[64:65], v14, s[36:39], s64 offen
    buffer_store_dwordx2 v[66:67], v14, s[36:39], s65 offen
    buffer_store_dwordx2 v[68:69], v14, s[36:39], s66 offen
    s_branch st_e_43
st_sc_42:
    buffer_store_dwordx2 v[64:65], v14, s[36:39], s64 offen sc1
    buffer_store_dwordx2 v[66:67], v14, s[36:39], s65 offen sc1
    buffer_store_dwordx2 v[68:69], v14, s[36:39], s66 offen sc1
st_e_43:
    s_mov_b64 exec, -1
    s_add_u32 s64, s70, s83
    s_add_u32 s65, s71, s83
    s_add_u32 s66, s72, s83
    s_cmp_lg_u32 s58, 0
    s_cbranch_scc1 st_sc_44
    buffer_store_dwordx2 v[24:25], v14, s[36:39], s64 offen
    buffer_store_dwordx2 v[24:25], v14, s[36:39], s65 offen
    buffer_store_dwordx2 v[24:25], v14, s[36:39], s66 offen
    s_branch st_e_45
st_sc_44:
    buffer_store_dwordx2 v[24:25], v14, s[36:39], s64 offen sc1
    buffer_store_dwordx2 v[24:25], v14, s[36:39], s65 offen sc1
    buffer_store_dwordx2 v[24:25], v14, s[36:39], s66 offen sc1
st_e_45:
    s_branch pp_e_40
pp_u1_38:
    v_pk_add_f32 v[80:81], v[80:81], v[100:101]
    v_pk_add_f32 v[82:83], v[82:83], v[102:103]
    v_pk_add_f32 v[84:85], v[84:85], v[104:105]
    v_pk_add_f32 v[86:87], v[86:87], v[106:107]
    v_pk_add_f32 v[88:89], v[88:89], v[108:109]
    v_pk_add_f32 v[90:91], v[90:91], v[110:111]
    v_pk_add_f32 v[92:93], v[92:93], v[112:113]
    v_pk_add_f32 v[94:95], v[94:95], v[114:115]
    v_pk_add_f32 v[96:97], v[96:97], v[116:117]
    v_pk_add_f32 v[98:99], v[98:99], v[118:119]
    v_pk_add_f32 v[80:81], v[80:81], v[84:85]
    v_pk_add_f32 v[82:83], v[82:83], v[86:87]
    v_pk_add_f32 v[80:81], v[80:81], v[88:89]
    v_pk_add_f32 v[82:83], v[82:83], v[90:91]
    v_pk_mov_b32 v[84:85], v[92:93], v[92:93] op_sel:[0,1]
    v_pk_mov_b32 v[86:87], v[94:95], v[94:95] op_sel:[0,1]
    v_pk_mov_b32 v[88:89], v[96:97], v[96:97] op_sel:[0,1]
    v_pk_mov_b32 v[90:91], v[98:99], v[98:99] op_sel:[0,1]
    v_cndmask_b32 v58, v86, v80, s[12:13]
    v_cndmask_b32 v92, v80, v86, s[12:13]
    v_cndmask_b32 v59, v87, v81, s[12:13]
    v_cndmask_b32 v93, v81, v87, s[12:13]
    v_cndmask_b32 v60, v88, v82, s[12:13]
    v_cndmask_b32 v94, v82, v88, s[12:13]
    v_cndmask_b32 v61, v89, v83, s[12:13]
    v_cndmask_b32 v95, v83, v89, s[12:13]
    v_cndmask_b32 v62, v90, v84, s[12:13]
    v_cndmask_b32 v96, v84, v90, s[12:13]
    v_cndmask_b32 v63, v91, v85, s[12:13]
    v_cndmask_b32 v97, v85, v91, s[12:13]
    v_add_f32_dpp v58, v92, v58 row_ror:8 row_mask:0xf bank_mask:0xf
    v_add_f32_dpp v59, v93, v59 row_ror:8 row_mask:0xf bank_mask:0xf
    v_add_f32_dpp v60, v94, v60 row_ror:8 row_mask:0xf bank_mask:0xf
    v_add_f32_dpp v61, v95, v61 row_ror:8 row_mask:0xf bank_mask:0xf
    v_add_f32_dpp v62, v96, v62 row_ror:8 row_mask:0xf bank_mask:0xf
    v_add_f32_dpp v63, v97, v63 row_ror:8 row_mask:0xf bank_mask:0xf
    v_cvt_pk_bf16_f32 v80, v58, v59
    v_cvt_pk_bf16_f32 v81, v60, v61
    v_cvt_pk_bf16_f32 v82, v62, v63
    v_and_b32 v59, 0xffff0000, v80
    v_lshlrev_b32 v58, 16, v80
    v_and_b32 v61, 0xffff0000, v81
    v_lshlrev_b32 v60, 16, v81
    v_and_b32 v63, 0xffff0000, v82
    v_lshlrev_b32 v62, 16, v82
    v_pk_mul_f32 v[58:59], v[58:59], s[76:77]
    v_pk_mul_f32 v[60:61], v[60:61], s[76:77]
    v_pk_mul_f32 v[62:63], v[62:63], s[76:77]
    v_cvt_pk_bf16_f32 v80, v58, v59
    v_cvt_pk_bf16_f32 v81, v60, v61
    v_cvt_pk_bf16_f32 v82, v62, v63
    v_and_b32 v59, 0xffff0000, v80
    v_lshlrev_b32 v58, 16, v80
    v_and_b32 v61, 0xffff0000, v81
    v_lshlrev_b32 v60, 16, v81
    v_and_b32 v63, 0xffff0000, v82
    v_lshlrev_b32 v62, 16, v82
    v_cndmask_b32 v58, v32, v58, s[74:75]
    v_cndmask_b32 v59, v32, v59, s[74:75]
    v_cndmask_b32 v60, v32, v60, s[74:75]
    v_cndmask_b32 v61, v32, v61, s[74:75]
    v_max3_f32 v22, v62, v63, v58
    v_max3_f32 v23, v59, v60, v61
    v_max_f32 v22, v22, v23
    s_nop 1
    v_max_f32_dpp v22, v22, v22 row_ror:8 row_mask:0xf bank_mask:0xf
    v_mov_b32 v23, v22
    s_nop 1
    v_permlane16_swap_b32 v22, v23
    v_max_f32 v22, v22, v23
    v_mov_b32 v23, v22
    s_nop 1
    v_permlane32_swap_b32 v22, v23
    v_max_f32 v22, v22, v23
    v_mul_f32 v22, 0xbfb8aa3b, v22
    v_mov_b32 v23, v22
    v_pk_fma_f32 v[58:59], v[58:59], s[68:69], v[22:23]
    v_pk_fma_f32 v[60:61], v[60:61], s[68:69], v[22:23]
    v_pk_fma_f32 v[62:63], v[62:63], s[68:69], v[22:23]
    v_exp_f32 v58, v58
    v_exp_f32 v59, v59
    v_exp_f32 v60, v60
    v_exp_f32 v61, v61
    v_exp_f32 v62, v62
    v_exp_f32 v63, v63
    s_nop 0
    v_pk_add_f32 v[22:23], v[58:59], v[60:61]
    v_pk_add_f32 v[22:23], v[22:23], v[62:63]
    v_add_f32 v22, v22, v23
    s_nop 1
    v_add_f32_dpp v22, v22, v22 row_ror:8 row_mask:0xf bank_mask:0xf
    v_mov_b32 v23, v22
    s_nop 1
    v_permlane16_swap_b32 v22, v23
    v_add_f32 v22, v22, v23
    v_mov_b32 v23, v22
    s_nop 1
    v_permlane32_swap_b32 v22, v23
    v_add_f32 v22, v22, v23
    v_cmp_u_f32 vcc, v22, v22
    v_rcp_f32 v22, v22
    s_cbranch_vccz ok_46
    s_add_u32 s63, s63, 1
    s_cmp_lt_u32 s63, 1048576
    s_cbranch_scc1 rc_la_36
ok_46:
    v_mov_b32 v23, v22
    v_pk_mul_f32 v[58:59], v[58:59], v[22:23]
    v_pk_mul_f32 v[60:61], v[60:61], v[22:23]
    v_pk_mul_f32 v[62:63], v[62:63], v[22:23]
    v_cvt_pk_bf16_f32 v80, v58, v59
    v_cvt_pk_bf16_f32 v81, v60, v61
    v_cvt_pk_bf16_f32 v84, v62, v63
    s_nop 0
    v_mov_b32_dpp v85, v80 row_ror:8 row_mask:0xf bank_mask:0xf
    v_mov_b32_dpp v86, v81 row_ror:8 row_mask:0xf bank_mask:0xf
    v_mov_b32_dpp v87, v84 row_ror:8 row_mask:0xf bank_mask:0xf
    s_nop 1
    v_mfma_f32_16x16x32_bf16 v[88:91], v[46:49], v[84:87], 0
    v_mfma_f32_16x16x32_bf16 v[92:95], v[50:53], v[84:87], 0
    v_mfma_f32_16x16x32_bf16 v[96:99], v[54:57], v[84:87], 0
    v_mfma_f32_16x16x16_bf16 v[100:103], v[40:41], v[80:81], 0
    v_mfma_f32_16x16x16_bf16 v[104:107], v[42:43], v[80:81], 0
    v_mfma_f32_16x16x16_bf16 v[108:111], v[44:45], v[80:81], 0
    s_add_u32 s64, s70, s82
    s_add_u32 s65, s71, s82
    s_add_u32 s66, s72, s82
    s_nop 5
    v_pk_add_f32 v[88:89], v[88:89], v[100:101]
    v_pk_add_f32 v[90:91], v[90:91], v[102:103]
    v_pk_add_f32 v[92:93], v[92:93], v[104:105]
    v_pk_add_f32 v[94:95], v[94:95], v[106:107]
    v_pk_add_f32 v[96:97], v[96:97], v[108:109]
    v_pk_add_f32 v[98:99], v[98:99], v[110:111]
    v_cvt_pk_bf16_f32 v64, v88, v89
    v_cvt_pk_bf16_f32 v65, v90, v91
    v_min_u32 v64, -2, v64
    v_min_u32 v65, -2, v65
    v_cvt_pk_bf16_f32 v66, v92, v93
    v_cvt_pk_bf16_f32 v67, v94, v95
    v_min_u32 v66, -2, v66
    v_min_u32 v67, -2, v67
    v_cvt_pk_bf16_f32 v68, v96, v97
    v_cvt_pk_bf16_f32 v69, v98, v99
    v_min_u32 v68, -2, v68
    v_min_u32 v69, -2, v69
    s_mov_b64 exec, s[12:13]
    s_cmp_lg_u32 s58, 0
    s_cbranch_scc1 st_sc_47
    buffer_store_dwordx2 v[64:65], v14, s[36:39], s64 offen
    buffer_store_dwordx2 v[66:67], v14, s[36:39], s65 offen
    buffer_store_dwordx2 v[68:69], v14, s[36:39], s66 offen
    s_branch st_e_48
st_sc_47:
    buffer_store_dwordx2 v[64:65], v14, s[36:39], s64 offen sc1
    buffer_store_dwordx2 v[66:67], v14, s[36:39], s65 offen sc1
    buffer_store_dwordx2 v[68:69], v14, s[36:39], s66 offen sc1
st_e_48:
    s_mov_b64 exec, -1
    s_add_u32 s64, s70, s83
    s_add_u32 s65, s71, s83
    s_add_u32 s66, s72, s83
    s_cmp_lg_u32 s58, 0
    s_cbranch_scc1 st_sc_49
    buffer_store_dwordx2 v[24:25], v14, s[36:39], s64 offen
    buffer_store_dwordx2 v[24:25], v14, s[36:39], s65 offen
    buffer_store_dwordx2 v[24:25], v14, s[36:39], s66 offen
    s_branch st_e_50
st_sc_49:
    buffer_store_dwordx2 v[24:25], v14, s[36:39], s64 offen sc1
    buffer_store_dwordx2 v[24:25], v14, s[36:39], s65 offen sc1
    buffer_store_dwordx2 v[24:25], v14, s[36:39], s66 offen sc1
st_e_50:
pp_e_40:
rc_red_24:
    s_cmp_eq_u32 s62, 63
    s_cbranch_scc1 rc_done_1
    s_barrier
    s_cmp_lt_u32 s57, 20
    s_cbranch_scc1 rc_isred_53
    s_cmp_lg_u32 s59, 3
    s_cbranch_scc1 rc_so_54
    s_waitcnt vmcnt(0)
    ds_read_b128 v[128:131], v39 offset:0
    ds_read_b128 v[132:135], v39 offset:768
    s_add_u32 s64, s62, 1
    s_min_u32 s64, s64, 63
    s_lshl_b32 s64, s64, 8
    s_add_u32 s64, s64, 1277952
    v_cmp_le_u32 vcc, 65, v76
    s_cbranch_vccnz rc_kvok_56
    v_mov_b32 v33, s64
rc_kvp_55:
    buffer_load_dword v22, v33, s[36:39], 0 offen sc1
    s_waitcnt vmcnt(0)
    v_cmp_le_u32 vcc, 65, v22
    s_cbranch_vccnz rc_kvok_56
    s_sleep 4
    s_add_u32 s63, s63, 1
    s_cmp_lt_u32 s63, 1048576
    s_cbranch_scc1 rc_kvp_55
rc_kvok_56:
    s_add_u32 s64, s64, 256
    s_min_u32 s64, s64, 1294080
    v_mov_b32 v33, s64
    buffer_load_dword v76, v33, s[36:39], 0 offen sc1
    s_mov_b32 m0, s3
    s_nop 0
    buffer_load_dwordx4 v34, s[40:43], s78 offen offset:0 sc1 lds
    s_mov_b32 m0, s73
    s_nop 0
    buffer_load_dwordx4 v34, s[44:47], s78 offen offset:0 sc1 lds
    s_mov_b32 m0, s3
    s_nop 0
    buffer_load_dwordx4 v34, s[40:43], s78 offen offset:1024 sc1 lds
    s_mov_b32 m0, s73
    s_nop 0
    buffer_load_dwordx4 v34, s[44:47], s78 offen offset:1024 sc1 lds
    s_mov_b32 m0, s3
    s_nop 0
    buffer_load_dwordx4 v34, s[40:43], s78 offen offset:2048 sc1 lds
    s_mov_b32 m0, s73
    s_nop 0
    buffer_load_dwordx4 v34, s[44:47], s78 offen offset:2048 sc1 lds
    s_waitcnt lgkmcnt(0)
    buffer_store_dwordx4 v[128:131], v38, s[48:51], s79 offen sc1
    buffer_store_dwordx4 v[132:135], v38, s[52:55], s79 offen sc1
rc_so_54:
    s_sleep 30
    s_branch rc_next2_52
rc_isred_53:
    v_add_u32 v23, 4096, v15
rc_lb_57:
    buffer_load_dwordx4 v[80:83], v15, s[36:39], s82 offen offset:0 sc1
    buffer_load_dwordx4 v[84:87], v15, s[36:39], s82 offen offset:1024 sc1
    buffer_load_dwordx4 v[88:91], v15, s[36:39], s82 offen offset:2048 sc1
    buffer_load_dwordx4 v[92:95], v15, s[36:39], s82 offen offset:3072 sc1
    buffer_load_dwordx4 v[96:99], v23, s[36:39], s82 offen offset:0 sc1
    buffer_load_dwordx4 v[100:103], v23, s[36:39], s82 offen offset:1024 sc1
    s_sleep 2
pp_l_58:
    buffer_load_dwordx4 v[104:107], v15, s[36:39], s82 offen offset:0 sc1
    buffer_load_dwordx4 v[108:111], v15, s[36:39], s82 offen offset:1024 sc1
    buffer_load_dwordx4 v[112:115], v15, s[36:39], s82 offen offset:2048 sc1
    buffer_load_dwordx4 v[116:119], v15, s[36:39], s82 offen offset:3072 sc1
    buffer_load_dwordx4 v[120:123], v23, s[36:39], s82 offen offset:0 sc1
    buffer_load_dwordx4 v[124:127], v23, s[36:39], s82 offen offset:1024 sc1
    s_waitcnt vmcnt(6)
    v_max3_u32 v22, v80, v81, v82
    v_max3_u32 v22, v22, v83, v84
    v_max3_u32 v22, v22, v85, v86
    v_max3_u32 v22, v22, v87, v88
    v_max3_u32 v22, v22, v89, v90
    v_max3_u32 v22, v22, v91, v92
    v_max3_u32 v22, v22, v93, v94
    v_max3_u32 v22, v22, v95, v96
    v_max3_u32 v22, v22, v97, v98
    v_max3_u32 v22, v22, v99, v100
    v_max3_u32 v22, v22, v101, v102
    v_max_u32 v22, v22, v103
    v_cmp_eq_u32 vcc, -1, v22
    s_cbranch_vccz pp_u1_59
    buffer_load_dwordx4 v[80:83], v15, s[36:39], s82 offen offset:0 sc1
    buffer_load_dwordx4 v[84:87], v15, s[36:39], s82 offen offset:1024 sc1
    buffer_load_dwordx4 v[88:91], v15, s[36:39], s82 offen offset:2048 sc1
    buffer_load_dwordx4 v[92:95], v15, s[36:39], s82 offen offset:3072 sc1
    buffer_load_dwordx4 v[96:99], v23, s[36:39], s82 offen offset:0 sc1
    buffer_load_dwordx4 v[100:103], v23, s[36:39], s82 offen offset:1024 sc1
    s_waitcnt vmcnt(6)
    v_max3_u32 v22, v104, v105, v106
    v_max3_u32 v22, v22, v107, v108
    v_max3_u32 v22, v22, v109, v110
    v_max3_u32 v22, v22, v111, v112
    v_max3_u32 v22, v22, v113, v114
    v_max3_u32 v22, v22, v115, v116
    v_max3_u32 v22, v22, v117, v118
    v_max3_u32 v22, v22, v119, v120
    v_max3_u32 v22, v22, v121, v122
    v_max3_u32 v22, v22, v123, v124
    v_max3_u32 v22, v22, v125, v126
    v_max_u32 v22, v22, v127
    v_cmp_eq_u32 vcc, -1, v22
    s_cbranch_vccz pp_u2_60
    s_add_u32 s63, s63, 1
    s_cmp_lt_u32 s63, 1048576
    s_cbranch_scc1 pp_l_58
pp_u2_60:
    v_mov_b32_dpp v128, v104 row_ror:8 row_mask:0xf bank_mask:0xf
    v_mov_b32_dpp v129, v105 row_ror:8 row_mask:0xf bank_mask:0xf
    v_mov_b32_dpp v130, v106 row_ror:8 row_mask:0xf bank_mask:0xf
    v_mov_b32_dpp v131, v107 row_ror:8 row_mask:0xf bank_mask:0xf
    v_mfma_f32_16x16x32_bf16 v[58:61], v[160:163], v[104:107], 0
    v_mfma_f32_16x16x32_bf16 v[62:65], v[164:167], v[104:107], 0
    v_mov_b32_dpp v132, v108 row_ror:8 row_mask:0xf bank_mask:0xf
    v_mov_b32_dpp v133, v109 row_ror:8 row_mask:0xf bank_mask:0xf
    v_mov_b32_dpp v134, v110 row_ror:8 row_mask:0xf bank_mask:0xf
    v_mov_b32_dpp v135, v111 row_ror:8 row_mask:0xf bank_mask:0xf
    v_mfma_f32_16x16x32_bf16 v[58:61], v[176:179], v[108:111], v[58:61]
    v_mfma_f32_16x16x32_bf16 v[62:65], v[180:183], v[108:111], v[62:65]
    v_mov_b32_dpp v136, v112 row_ror:8 row_mask:0xf bank_mask:0xf
    v_mov_b32_dpp v137, v113 row_ror:8 row_mask:0xf bank_mask:0xf
    v_mov_b32_dpp v138, v114 row_ror:8 row_mask:0xf bank_mask:0xf
    v_mov_b32_dpp v139, v115 row_ror:8 row_mask:0xf bank_mask:0xf
    v_mfma_f32_16x16x32_bf16 v[58:61], v[192:195], v[112:115], v[58:61]
    v_mfma_f32_16x16x32_bf16 v[62:65], v[196:199], v[112:115], v[62:65]
    v_mov_b32_dpp v140, v116 row_ror:8 row_mask:0xf bank_mask:0xf
    v_mov_b32_dpp v141, v117 row_ror:8 row_mask:0xf bank_mask:0xf
    v_mov_b32_dpp v142, v118 row_ror:8 row_mask:0xf bank_mask:0xf
    v_mov_b32_dpp v143, v119 row_ror:8 row_mask:0xf bank_mask:0xf
    v_mfma_f32_16x16x32_bf16 v[58:61], v[208:211], v[116:119], v[58:61]
    v_mfma_f32_16x16x32_bf16 v[62:65], v[212:215], v[116:119], v[62:65]
    v_mov_b32_dpp v144, v120 row_ror:8 row_mask:0xf bank_mask:0xf
    v_mov_b32_dpp v145, v121 row_ror:8 row_mask:0xf bank_mask:0xf
    v_mov_b32_dpp v146, v122 row_ror:8 row_mask:0xf bank_mask:0xf
    v_mov_b32_dpp v147, v123 row_ror:8 row_mask:0xf bank_mask:0xf
    v_mfma_f32_16x16x32_bf16 v[58:61], v[224:227], v[120:123], v[58:61]
    v_mfma_f32_16x16x32_bf16 v[62:65], v[228:231], v[120:123], v[62:65]
    v_mov_b32_dpp v148, v124 row_ror:8 row_mask:0xf bank_mask:0xf
    v_mov_b32_dpp v149, v125 row_ror:8 row_mask:0xf bank_mask:0xf
    v_mov_b32_dpp v150, v126 row_ror:8 row_mask:0xf bank_mask:0xf
    v_mov_b32_dpp v151, v127 row_ror:8 row_mask:0xf bank_mask:0xf
    v_mfma_f32_16x16x32_bf16 v[58:61], v[240:243], v[124:127], v[58:61]
    v_mfma_f32_16x16x32_bf16 v[62:65], v[244:247], v[124:127], v[62:65]
    s_branch pp_e_61
pp_u1_59:
    v_mov_b32_dpp v128, v80 row_ror:8 row_mask:0xf bank_mask:0xf
    v_mov_b32_dpp v129, v81 row_ror:8 row_mask:0xf bank_mask:0xf
    v_mov_b32_dpp v130, v82 row_ror:8 row_mask:0xf bank_mask:0xf
    v_mov_b32_dpp v131, v83 row_ror:8 row_mask:0xf bank_mask:0xf
    v_mfma_f32_16x16x32_bf16 v[58:61], v[160:163], v[80:83], 0
    v_mfma_f32_16x16x32_bf16 v[62:65], v[164:167], v[80:83], 0
    v_mov_b32_dpp v132, v84 row_ror:8 row_mask:0xf bank_mask:0xf
    v_mov_b32_dpp v133, v85 row_ror:8 row_mask:0xf bank_mask:0xf
    v_mov_b32_dpp v134, v86 row_ror:8 row_mask:0xf bank_mask:0xf
    v_mov_b32_dpp v135, v87 row_ror:8 row_mask:0xf bank_mask:0xf
    v_mfma_f32_16x16x32_bf16 v[58:61], v[176:179], v[84:87], v[58:61]
    v_mfma_f32_16x16x32_bf16 v[62:65], v[180:183], v[84:87], v[62:65]
    v_mov_b32_dpp v136, v88 row_ror:8 row_mask:0xf bank_mask:0xf
    v_mov_b32_dpp v137, v89 row_ror:8 row_mask:0xf bank_mask:0xf
    v_mov_b32_dpp v138, v90 row_ror:8 row_mask:0xf bank_mask:0xf
    v_mov_b32_dpp v139, v91 row_ror:8 row_mask:0xf bank_mask:0xf
    v_mfma_f32_16x16x32_bf16 v[58:61], v[192:195], v[88:91], v[58:61]
    v_mfma_f32_16x16x32_bf16 v[62:65], v[196:199], v[88:91], v[62:65]
    v_mov_b32_dpp v140, v92 row_ror:8 row_mask:0xf bank_mask:0xf
    v_mov_b32_dpp v141, v93 row_ror:8 row_mask:0xf bank_mask:0xf
    v_mov_b32_dpp v142, v94 row_ror:8 row_mask:0xf bank_mask:0xf
    v_mov_b32_dpp v143, v95 row_ror:8 row_mask:0xf bank_mask:0xf
    v_mfma_f32_16x16x32_bf16 v[58:61], v[208:211], v[92:95], v[58:61]
    v_mfma_f32_16x16x32_bf16 v[62:65], v[212:215], v[92:95], v[62:65]
    v_mov_b32_dpp v144, v96 row_ror:8 row_mask:0xf bank_mask:0xf
    v_mov_b32_dpp v145, v97 row_ror:8 row_mask:0xf bank_mask:0xf
    v_mov_b32_dpp v146, v98 row_ror:8 row_mask:0xf bank_mask:0xf
    v_mov_b32_dpp v147, v99 row_ror:8 row_mask:0xf bank_mask:0xf
    v_mfma_f32_16x16x32_bf16 v[58:61], v[224:227], v[96:99], v[58:61]
    v_mfma_f32_16x16x32_bf16 v[62:65], v[228:231], v[96:99], v[62:65]
    v_mov_b32_dpp v148, v100 row_ror:8 row_mask:0xf bank_mask:0xf
    v_mov_b32_dpp v149, v101 row_ror:8 row_mask:0xf bank_mask:0xf
    v_mov_b32_dpp v150, v102 row_ror:8 row_mask:0xf bank_mask:0xf
    v_mov_b32_dpp v151, v103 row_ror:8 row_mask:0xf bank_mask:0xf
    v_mfma_f32_16x16x32_bf16 v[58:61], v[240:243], v[100:103], v[58:61]
    v_mfma_f32_16x16x32_bf16 v[62:65], v[244:247], v[100:103], v[62:65]
pp_e_61:
    v_mfma_f32_16x16x32_bf16 v[58:61], v[168:171], v[128:131], v[58:61]
    v_mfma_f32_16x16x32_bf16 v[62:65], v[172:175], v[128:131], v[62:65]
    v_mfma_f32_16x16x32_bf16 v[58:61], v[184:187], v[132:135], v[58:61]
    v_mfma_f32_16x16x32_bf16 v[62:65], v[188:191], v[132:135], v[62:65]
    v_mfma_f32_16x16x32_bf16 v[58:61], v[200:203], v[136:139], v[58:61]
    v_mfma_f32_16x16x32_bf16 v[62:65], v[204:207], v[136:139], v[62:65]
    v_mfma_f32_16x16x32_bf16 v[58:61], v[216:219], v[140:143], v[58:61]
    v_mfma_f32_16x16x32_bf16 v[62:65], v[220:223], v[140:143], v[62:65]
    v_mfma_f32_16x16x32_bf16 v[58:61], v[232:235], v[144:147], v[58:61]
    v_mfma_f32_16x16x32_bf16 v[62:65], v[236:239], v[144:147], v[62:65]
    v_mfma_f32_16x16x32_bf16 v[58:61], v[248:251], v[148:151], v[58:61]
    v_mfma_f32_16x16x32_bf16 v[62:65], v[252:255], v[148:151], v[62:65]
    s_waitcnt vmcnt(0)
    s_nop 7
    ds_write_b128 v30, v[58:61] offset:0
    ds_write_b128 v30, v[62:65] offset:1024
    s_waitcnt lgkmcnt(0)
    s_barrier
    s_cmp_lg_u32 s59, 3
    s_cbranch_scc1 rc_so2_62
    s_waitcnt vmcnt(0)
    ds_read_b128 v[128:131], v39 offset:0
    ds_read_b128 v[132:135], v39 offset:768
    s_add_u32 s64, s62, 1
    s_min_u32 s64, s64, 63
    s_lshl_b32 s64, s64, 8
    s_add_u32 s64, s64, 1277952
    v_cmp_le_u32 vcc, 65, v76
    s_cbranch_vccnz rc_kvok_64
    v_mov_b32 v33, s64
rc_kvp_63:
    buffer_load_dword v22, v33, s[36:39], 0 offen sc1
    s_waitcnt vmcnt(0)
    v_cmp_le_u32 vcc, 65, v22
    s_cbranch_vccnz rc_kvok_64
    s_sleep 4
    s_add_u32 s63, s63, 1
    s_cmp_lt_u32 s63, 1048576
    s_cbranch_scc1 rc_kvp_63
rc_kvok_64:
    s_add_u32 s64, s64, 256
    s_min_u32 s64, s64, 1294080
    v_mov_b32 v33, s64
    buffer_load_dword v76, v33, s[36:39], 0 offen sc1
    s_mov_b32 m0, s3
    s_nop 0
    buffer_load_dwordx4 v34, s[40:43], s78 offen offset:0 sc1 lds
    s_mov_b32 m0, s73
    s_nop 0
    buffer_load_dwordx4 v34, s[44:47], s78 offen offset:0 sc1 lds
    s_mov_b32 m0, s3
    s_nop 0
    buffer_load_dwordx4 v34, s[40:43], s78 offen offset:1024 sc1 lds
    s_mov_b32 m0, s73
    s_nop 0
    buffer_load_dwordx4 v34, s[44:47], s78 offen offset:1024 sc1 lds
    s_mov_b32 m0, s3
    s_nop 0
    buffer_load_dwordx4 v34, s[40:43], s78 offen offset:2048 sc1 lds
    s_mov_b32 m0, s73
    s_nop 0
    buffer_load_dwordx4 v34, s[44:47], s78 offen offset:2048 sc1 lds
    s_waitcnt lgkmcnt(0)
    buffer_store_dwordx4 v[128:131], v38, s[48:51], s79 offen sc1
    buffer_store_dwordx4 v[132:135], v38, s[52:55], s79 offen sc1
rc_so2_62:
    s_cmp_ge_u32 s59, 2
    s_cbranch_scc1 rc_next_51
    ds_read_b128 v[80:83], v29 offset:0
    ds_read_b128 v[84:87], v29 offset:2048
    ds_read_b128 v[88:91], v29 offset:4096
    ds_read_b128 v[92:95], v29 offset:6144
    s_waitcnt lgkmcnt(0)
    v_pk_add_f32 v[80:81], v[80:81], v[84:85]
    v_pk_add_f32 v[88:89], v[88:89], v[92:93]
    v_pk_add_f32 v[82:83], v[82:83], v[86:87]
    v_pk_add_f32 v[90:91], v[90:91], v[94:95]
    v_pk_add_f32 v[80:81], v[80:81], v[88:89]
    v_pk_add_f32 v[82:83], v[82:83], v[90:91]
    s_cmp_eq_u32 s59, 0
    s_cbranch_scc1 rc_cw0_65
    buffer_store_dwordx4 v[80:83], v16, s[36:39], s86 offen sc1
    buffer_store_dwordx4 v[24:27], v16, s[36:39], s87 offen sc1
    s_branch rc_next_51
rc_cw0_65:
    s_sleep 12
rc_lc_66:
    s_cmp_eq_u32 s56, 0
    s_cbranch_scc1 rc_own_67
    buffer_load_dwordx4 v[96:99], v17, s[36:39], s86 offen offset:0 sc1
    s_branch rc_owne_68
rc_own_67:
    v_pk_mov_b32 v[96:97], v[80:81], v[80:81] op_sel:[0,1]
    v_pk_mov_b32 v[98:99], v[82:83], v[82:83] op_sel:[0,1]
rc_owne_68:
    s_cmp_eq_u32 s56, 1
    s_cbranch_scc1 rc_own_69
    buffer_load_dwordx4 v[100:103], v17, s[36:39], s86 offen offset:1024 sc1
    s_branch rc_owne_70
rc_own_69:
    v_pk_mov_b32 v[100:101], v[80:81], v[80:81] op_sel:[0,1]
    v_pk_mov_b32 v[102:103], v[82:83], v[82:83] op_sel:[0,1]
rc_owne_70:
    s_cmp_eq_u32 s56, 2
    s_cbranch_scc1 rc_own_71
    buffer_load_dwordx4 v[104:107], v17, s[36:39], s86 offen offset:2048 sc1
    s_branch rc_owne_72
rc_own_71:
    v_pk_mov_b32 v[104:105], v[80:81], v[80:81] op_sel:[0,1]
    v_pk_mov_b32 v[106:107], v[82:83], v[82:83] op_sel:[0,1]
rc_owne_72:
    s_cmp_eq_u32 s56, 3
    s_cbranch_scc1 rc_own_73
    buffer_load_dwordx4 v[108:111], v17, s[36:39], s86 offen offset:3072 sc1
    s_branch rc_owne_74
rc_own_73:
    v_pk_mov_b32 v[108:109], v[80:81], v[80:81] op_sel:[0,1]
    v_pk_mov_b32 v[110:111], v[82:83], v[82:83] op_sel:[0,1]
rc_owne_74:
    s_waitcnt vmcnt(0)
    v_pk_add_f32 v[96:97], v[96:97], v[100:101]
    v_pk_add_f32 v[104:105], v[104:105], v[108:109]
    v_pk_add_f32 v[98:99], v[98:99], v[102:103]
    v_pk_add_f32 v[106:107], v[106:107], v[110:111]
    v_pk_add_f32 v[96:97], v[96:97], v[104:105]
    v_pk_add_f32 v[98:99], v[98:99], v[106:107]
    v_pk_add_f32 v[22:23], v[96:97], v[98:99]
    v_cmp_u_f32 vcc, v22, v23
    s_cbranch_vccz ok_75
    s_add_u32 s63, s63, 1
    s_cmp_lt_u32 s63, 1048576
    s_cbranch_scc1 rc_lc_66
ok_75:
    v_cvt_pk_bf16_f32 v80, v96, v97
    v_cvt_pk_bf16_f32 v81, v98, v99
    v_min_u32 v80, -2, v80
    v_min_u32 v81, -2, v81
    s_cmp_lg_u32 s58, 0
    s_cbranch_scc1 st_sc_76
    buffer_store_dwordx2 v[80:81], v18, s[36:39], s84 offen
    buffer_store_dwordx2 v[24:25], v18, s[36:39], s85 offen
    s_branch st_e_77
st_sc_76:
    buffer_store_dwordx2 v[80:81], v18, s[36:39], s84 offen sc1
    buffer_store_dwordx2 v[24:25], v18, s[36:39], s85 offen sc1
st_e_77:
rc_next_51:
    s_barrier
rc_next2_52:
    s_add_u32 s62, s62, 1
    s_add_u32 s78, s78, 393216
    s_add_u32 s79, s79, 98304
    s_branch rc_loop_20
rc_done_1:
    s_branch rc_kend_3
wk_entry_2:
    s_sub_u32 s90, s56, 4
    s_lshl_b32 s90, s90, 5
    s_add_u32 s90, s90, s57
    s_mov_b32 s91, s59
    s_mov_b32 s92, 0
    s_load_dwordx2 s[20:21], s[0:1], 64
    s_load_dwordx2 s[22:23], s[0:1], 72
    s_load_dwordx2 s[24:25], s[0:1], 80
    s_load_dwordx2 s[26:27], s[0:1], 88
    s_waitcnt lgkmcnt(0)
    s_add_u32 s28, s14, 0x07b34000
    s_addc_u32 s29, s15, 0
    s_mov_b32 s30, 0x00018400
    s_mov_b32 s31, 0x00020000
    v_and_b32 v1, 15, v0
    v_bfe_u32 v2, v0, 4, 2
    v_and_b32 v3, 63, v0
    s_cmp_ge_u32 s90, 104
    s_cbranch_scc1 wk_att0_81
    s_lshr_b32 s18, s90, 5
    s_and_b32 s19, s90, 31
    s_add_u32 s18, s18, 1
    s_cmp_eq_u32 s18, 3
    s_cselect_b32 s18, 0, s18
    s_cmp_eq_u32 s18, 4
    s_cselect_b32 s18, 3, s18
    s_mov_b32 s40, s14
    s_mov_b32 s41, s15
    s_mov_b32 s42, 0x00280000
    s_mov_b32 s43, 0x00020000
    s_cmp_eq_u32 s18, 1
    s_cselect_b32 s44, s6, s4
    s_cselect_b32 s45, s7, s5
    s_cmp_eq_u32 s18, 2
    s_cselect_b32 s44, s8, s44
    s_cselect_b32 s45, s9, s45
    s_cmp_eq_u32 s18, 3
    s_cselect_b32 s44, s20, s44
    s_cselect_b32 s45, s21, s45
    s_mov_b32 s46, 0x00780000
    s_mov_b32 s51, 12288
    s_cselect_b32 s46, 0x001e0000, s46
    s_mov_b32 s47, 0x00020000
    s_cselect_b32 s51, 3072, s51
    s_add_u32 s60, s14, 0x00400000
    s_addc_u32 s61, s15, 0
    s_mov_b32 s62, 0x04e00000
    s_mov_b32 s63, 0x00020000
    s_mov_b32 s68, s22
    s_mov_b32 s69, s23
    s_mov_b32 s70, 0x00000c00
    s_mov_b32 s71, 0x00020000
    s_mul_i32 s65, s19, 384
    s_mul_i32 s66, s91, 96
    s_add_u32 s65, s65, s66
    v_lshlrev_b32 v4, 4, v0
    s_mov_b32 s48, 0
    s_cmp_lt_u32 s90, 64
    s_cbranch_scc1 wk_urgent_82
    v_mov_b32 v254, 68
    s_mov_b32 s93, 0
wi_p_84:
    buffer_load_dword v255, v254, s[32:35], 0 offen sc1
    s_waitcnt vmcnt(0)
    v_cmp_le_u32 vcc, 256, v255
    s_cbranch_vccnz wi_ok_85
    s_sleep 4
    s_add_u32 s93, s93, 1
    s_cmp_lt_u32 s93, 1048576
    s_cbranch_scc1 wi_p_84
wi_ok_85:
    s_cmp_lg_u32 s58, 0
    s_cbranch_scc1 cm_ok_86
    v_and_b32 v254, 7, v0
    v_lshlrev_b32 v254, 2, v254
    buffer_load_dword v255, v254, s[32:35], 0 offen sc1
    s_waitcnt vmcnt(0)
    v_cmp_ne_u32 vcc, 32, v255
    s_cbranch_vccz cm_ok_86
    s_mov_b32 s58, 1
    s_lshr_b32 s56, s88, 5
    s_and_b32 s57, s88, 31
    s_barrier
    s_branch rc_restart_8
cm_ok_86:
    s_mov_b32 s64, 0
    s_add_u32 s93, s64, 64
    s_lshl_b32 s93, s93, 8
    v_mov_b32 v254, s93
wk_poll_87:
    buffer_load_dword v255, v254, s[28:31], 0 offen sc1
    s_waitcnt vmcnt(0)
    v_cmp_le_u32 vcc, 64, v255
    s_cbranch_vccnz wk_ok_88
    s_sleep 16
    s_add_u32 s92, s92, 1
    s_cmp_lt_u32 s92, 1048576
    s_cbranch_scc1 wk_poll_87
wk_ok_88:
    s_mul_i32 s64, s91, 20480
    v_lshl_add_u32 v5, v3, 4, s64
    v_lshrrev_b32 v6, 2, v1
    v_lshl_add_u32 v7, v2, 3, v6
    v_mul_u32_u24 v7, 96, v7
    v_and_b32 v8, 3, v1
    v_lshl_add_u32 v7, v8, 3, v7
    v_add_u32 v7, s64, v7
    s_lshl_b32 s66, s51, 5
    v_add_u32 v6, 0, v3
    v_mul_u32_u24 v8, 10923, v6
    v_lshrrev_b32 v8, 16, v8
    v_mul_u32_u24 v9, 6, v8
    v_sub_u32 v6, v6, v9
    v_mul_lo_u32 v9, v8, s51
    v_lshl_add_u32 v9, v6, 4, v9
    v_add_u32 v6, 64, v3
    v_mul_u32_u24 v8, 10923, v6
    v_lshrrev_b32 v8, 16, v8
    v_mul_u32_u24 v10, 6, v8
    v_sub_u32 v6, v6, v10
    v_mul_lo_u32 v10, v8, s51
    v_lshl_add_u32 v10, v6, 4, v10
    v_add_u32 v6, 128, v3
    v_mul_u32_u24 v8, 10923, v6
    v_lshrrev_b32 v8, 16, v8
    v_mul_u32_u24 v11, 6, v8
    v_sub_u32 v6, v6, v11
    v_mul_lo_u32 v11, v8, s51
    v_lshl_add_u32 v11, v6, 4, v11
    s_mov_b32 s67, s65
    buffer_load_dwordx4 v[12:15], v9, s[44:47], s67 offen
    buffer_load_dwordx4 v[16:19], v10, s[44:47], s67 offen
    buffer_load_dwordx4 v[20:23], v11, s[44:47], s67 offen
    s_add_u32 s67, s67, s66
    buffer_load_dwordx4 v[24:27], v9, s[44:47], s67 offen
    buffer_load_dwordx4 v[28:31], v10, s[44:47], s67 offen
    buffer_load_dwordx4 v[32:35], v11, s[44:47], s67 offen
    s_add_u32 s67, s67, s66
    buffer_load_dwordx4 v[36:39], v9, s[44:47], s67 offen
    buffer_load_dwordx4 v[40:43], v10, s[44:47], s67 offen
    buffer_load_dwordx4 v[44:47], v11, s[44:47], s67 offen
    s_add_u32 s67, s67, s66
    buffer_load_dwordx4 v[48:51], v9, s[44:47], s67 offen
    buffer_load_dwordx4 v[52:55], v10, s[44:47], s67 offen
    buffer_load_dwordx4 v[56:59], v11, s[44:47], s67 offen
    s_add_u32 s67, s67, s66
    buffer_load_dwordx4 v[60:63], v9, s[44:47], s67 offen
    buffer_load_dwordx4 v[64:67], v10, s[44:47], s67 offen
    buffer_load_dwordx4 v[68:71], v11, s[44:47], s67 offen
    s_add_u32 s67, s67, s66
    buffer_load_dwordx4 v[72:75], v9, s[44:47], s67 offen
    buffer_load_dwordx4 v[76:79], v10, s[44:47], s67 offen
    buffer_load_dwordx4 v[80:83], v11, s[44:47], s67 offen
    s_add_u32 s67, s67, s66
    buffer_load_dwordx4 v[84:87], v9, s[44:47], s67 offen
    buffer_load_dwordx4 v[88:91], v10, s[44:47], s67 offen
    buffer_load_dwordx4 v[92:95], v11, s[44:47], s67 offen
    s_add_u32 s67, s67, s66
    buffer_load_dwordx4 v[96:99], v9, s[44:47], s67 offen
    buffer_load_dwordx4 v[100:103], v10, s[44:47], s67 offen
    buffer_load_dwordx4 v[104:107], v11, s[44:47], s67 offen
    s_add_u32 s67, s67, s66
    buffer_load_dwordx4 v[108:111], v9, s[44:47], s67 offen
    buffer_load_dwordx4 v[112:115], v10, s[44:47], s67 offen
    buffer_load_dwordx4 v[116:119], v11, s[44:47], s67 offen
    s_add_u32 s67, s67, s66
    buffer_load_dwordx4 v[120:123], v9, s[44:47], s67 offen
    buffer_load_dwordx4 v[124:127], v10, s[44:47], s67 offen
    buffer_load_dwordx4 v[128:131], v11, s[44:47], s67 offen
    s_add_u32 s67, s67, s66
    buffer_load_dwordx4 v[132:135], v9, s[44:47], s67 offen
    buffer_load_dwordx4 v[136:139], v10, s[44:47], s67 offen
    buffer_load_dwordx4 v[140:143], v11, s[44:47], s67 offen
    s_add_u32 s67, s67, s66
    buffer_load_dwordx4 v[144:147], v9, s[44:47], s67 offen
    buffer_load_dwordx4 v[148:151], v10, s[44:47], s67 offen
    buffer_load_dwordx4 v[152:155], v11, s[44:47], s67 offen
    s_add_u32 s67, s67, s66
    buffer_load_dwordx4 v[156:159], v9, s[44:47], s67 offen
    buffer_load_dwordx4 v[160:163], v10, s[44:47], s67 offen
    buffer_load_dwordx4 v[164:167], v11, s[44:47], s67 offen
    s_add_u32 s67, s67, s66
    buffer_load_dwordx4 v[168:171], v9, s[44:47], s67 offen
    buffer_load_dwordx4 v[172:175], v10, s[44:47], s67 offen
    buffer_load_dwordx4 v[176:179], v11, s[44:47], s67 offen
    s_add_u32 s67, s67, s66
    buffer_load_dwordx4 v[180:183], v9, s[44:47], s67 offen
    buffer_load_dwordx4 v[184:187], v10, s[44:47], s67 offen
    buffer_load_dwordx4 v[188:191], v11, s[44:47], s67 offen
    s_add_u32 s67, s67, s66
    buffer_load_dwordx4 v[192:195], v9, s[44:47], s67 offen
    buffer_load_dwordx4 v[196:199], v10, s[44:47], s67 offen
    buffer_load_dwordx4 v[200:203], v11, s[44:47], s67 offen
    s_add_u32 s67, s67, s66
    buffer_load_dwordx4 v[204:207], v9, s[44:47], s67 offen
    buffer_load_dwordx4 v[208:211], v10, s[44:47], s67 offen
    buffer_load_dwordx4 v[212:215], v11, s[44:47], s67 offen
    s_add_u32 s67, s67, s66
    buffer_load_dwordx4 v[216:219], v9, s[44:47], s67 offen
    buffer_load_dwordx4 v[220:223], v10, s[44:47], s67 offen
    buffer_load_dwordx4 v[224:227], v11, s[44:47], s67 offen
    s_add_u32 s67, s67, s66
    buffer_load_dwordx4 v[228:231], v9, s[44:47], s67 offen
    buffer_load_dwordx4 v[232:235], v10, s[44:47], s67 offen
    buffer_load_dwordx4 v[236:239], v11, s[44:47], s67 offen
    s_add_u32 s67, s67, s66
    buffer_load_dwordx4 v[240:243], v9, s[44:47], s67 offen
    buffer_load_dwordx4 v[244:247], v10, s[44:47], s67 offen
    buffer_load_dwordx4 v[248:251], v11, s[44:47], s67 offen
    s_add_u32 s67, s67, s66
    s_waitcnt vmcnt(59)
    ds_write_b128 v5, v[12:15] offset:0
    s_waitcnt vmcnt(58)
    ds_write_b128 v5, v[16:19] offset:1024
    s_waitcnt vmcnt(57)
    ds_write_b128 v5, v[20:23] offset:2048
    s_waitcnt vmcnt(56)
    ds_write_b128 v5, v[24:27] offset:3072
    s_waitcnt vmcnt(55)
    ds_write_b128 v5, v[28:31] offset:4096
    s_waitcnt vmcnt(54)
    ds_write_b128 v5, v[32:35] offset:5120
    s_waitcnt vmcnt(53)
    ds_write_b128 v5, v[36:39] offset:6144
    s_waitcnt vmcnt(52)
    ds_write_b128 v5, v[40:43] offset:7168
    s_waitcnt vmcnt(51)
    ds_write_b128 v5, v[44:47] offset:8192
    s_waitcnt vmcnt(50)
    ds_write_b128 v5, v[48:51] offset:9216
    s_waitcnt vmcnt(49)
    ds_write_b128 v5, v[52:55] offset:10240
    s_waitcnt vmcnt(48)
    ds_write_b128 v5, v[56:59] offset:11264
    s_waitcnt vmcnt(47)
    ds_write_b128 v5, v[60:63] offset:12288
    s_waitcnt vmcnt(46)
    ds_write_b128 v5, v[64:67] offset:13312
    s_waitcnt vmcnt(45)
    ds_write_b128 v5, v[68:71] offset:14336
    s_waitcnt lgkmcnt(0)
    ds_read_b64_tr_b16 a[0:1], v7 offset:0
    ds_read_b64_tr_b16 a[2:3], v7 offset:384
    ds_read_b64_tr_b16 a[4:5], v7 offset:3072
    ds_read_b64_tr_b16 a[6:7], v7 offset:3456
    ds_read_b64_tr_b16 a[8:9], v7 offset:6144
    ds_read_b64_tr_b16 a[10:11], v7 offset:6528
    ds_read_b64_tr_b16 a[12:13], v7 offset:9216
    ds_read_b64_tr_b16 a[14:15], v7 offset:9600
    ds_read_b64_tr_b16 a[16:17], v7 offset:12288
    ds_read_b64_tr_b16 a[18:19], v7 offset:12672
    ds_read_b64_tr_b16 a[80:81], v7 offset:32
    ds_read_b64_tr_b16 a[82:83], v7 offset:416
    s_waitcnt lgkmcnt(0)
    ds_read_b64_tr_b16 a[84:85], v7 offset:3104
    ds_read_b64_tr_b16 a[86:87], v7 offset:3488
    ds_read_b64_tr_b16 a[88:89], v7 offset:6176
    ds_read_b64_tr_b16 a[90:91], v7 offset:6560
    ds_read_b64_tr_b16 a[92:93], v7 offset:9248
    ds_read_b64_tr_b16 a[94:95], v7 offset:9632
    ds_read_b64_tr_b16 a[96:97], v7 offset:12320
    ds_read_b64_tr_b16 a[98:99], v7 offset:12704
    ds_read_b64_tr_b16 a[160:161], v7 offset:64
    ds_read_b64_tr_b16 a[162:163], v7 offset:448
    ds_read_b64_tr_b16 a[164:165], v7 offset:3136
    ds_read_b64_tr_b16 a[166:167], v7 offset:3520
    s_waitcnt lgkmcnt(0)
    ds_read_b64_tr_b16 a[168:169], v7 offset:6208
    ds_read_b64_tr_b16 a[170:171], v7 offset:6592
    ds_read_b64_tr_b16 a[172:173], v7 offset:9280
    ds_read_b64_tr_b16 a[174:175], v7 offset:9664
    ds_read_b64_tr_b16 a[176:177], v7 offset:12352
    ds_read_b64_tr_b16 a[178:179], v7 offset:12736
    s_waitcnt lgkmcnt(0)
    s_waitcnt vmcnt(44)
    ds_write_b128 v5, v[72:75] offset:0
    s_waitcnt vmcnt(43)
    ds_write_b128 v5, v[76:79] offset:1024
    s_waitcnt vmcnt(42)
    ds_write_b128 v5, v[80:83] offset:2048
    s_waitcnt vmcnt(41)
    ds_write_b128 v5, v[84:87] offset:3072
    s_waitcnt vmcnt(40)
    ds_write_b128 v5, v[88:91] offset:4096
    s_waitcnt vmcnt(39)
    ds_write_b128 v5, v[92:95] offset:5120
    s_waitcnt vmcnt(38)
    ds_write_b128 v5, v[96:99] offset:6144
    s_waitcnt vmcnt(37)
    ds_write_b128 v5, v[100:103] offset:7168
    s_waitcnt vmcnt(36)
    ds_write_b128 v5, v[104:107] offset:8192
    s_waitcnt vmcnt(35)
    ds_write_b128 v5, v[108:111] offset:9216
    s_waitcnt vmcnt(34)
    ds_write_b128 v5, v[112:115] offset:10240
    s_waitcnt vmcnt(33)
    ds_write_b128 v5, v[116:119] offset:11264
    s_waitcnt vmcnt(32)
    ds_write_b128 v5, v[120:123] offset:12288
    s_waitcnt vmcnt(31)
    ds_write_b128 v5, v[124:127] offset:13312
    s_waitcnt vmcnt(30)
    ds_write_b128 v5, v[128:131] offset:14336
    s_waitcnt lgkmcnt(0)
    ds_read_b64_tr_b16 a[20:21], v7 offset:0
    ds_read_b64_tr_b16 a[22:23], v7 offset:384
    ds_read_b64_tr_b16 a[24:25], v7 offset:3072
    ds_read_b64_tr_b16 a[26:27], v7 offset:3456
    ds_read_b64_tr_b16 a[28:29], v7 offset:6144
    ds_read_b64_tr_b16 a[30:31], v7 offset:6528
    ds_read_b64_tr_b16 a[32:33], v7 offset:9216
    ds_read_b64_tr_b16 a[34:35], v7 offset:9600
    ds_read_b64_tr_b16 a[36:37], v7 offset:12288
    ds_read_b64_tr_b16 a[38:39], v7 offset:12672
    ds_read_b64_tr_b16 a[100:101], v7 offset:32
    ds_read_b64_tr_b16 a[102:103], v7 offset:416
    s_waitcnt lgkmcnt(0)
    ds_read_b64_tr_b16 a[104:105], v7 offset:3104
    ds_read_b64_tr_b16 a[106:107], v7 offset:3488
    ds_read_b64_tr_b16 a[108:109], v7 offset:6176
    ds_read_b64_tr_b16 a[110:111], v7 offset:6560
    ds_read_b64_tr_b16 a[112:113], v7 offset:9248
    ds_read_b64_tr_b16 a[114:115], v7 offset:9632
    ds_read_b64_tr_b16 a[116:117], v7 offset:12320
    ds_read_b64_tr_b16 a[118:119], v7 offset:12704
    ds_read_b64_tr_b16 a[180:181], v7 offset:64
    ds_read_b64_tr_b16 a[182:183], v7 offset:448
    ds_read_b64_tr_b16 a[184:185], v7 offset:3136
    ds_read_b64_tr_b16 a[186:187], v7 offset:3520
    s_waitcnt lgkmcnt(0)
    ds_read_b64_tr_b16 a[188:189], v7 offset:6208
    ds_read_b64_tr_b16 a[190:191], v7 offset:6592
    ds_read_b64_tr_b16 a[192:193], v7 offset:9280
    ds_read_b64_tr_b16 a[194:195], v7 offset:9664
    ds_read_b64_tr_b16 a[196:197], v7 offset:12352
    ds_read_b64_tr_b16 a[198:199], v7 offset:12736
    s_waitcnt lgkmcnt(0)
    s_waitcnt vmcnt(29)
    ds_write_b128 v5, v[132:135] offset:0
    s_waitcnt vmcnt(28)
    ds_write_b128 v5, v[136:139] offset:1024
    s_waitcnt vmcnt(27)
    ds_write_b128 v5, v[140:143] offset:2048
    s_waitcnt vmcnt(26)
    ds_write_b128 v5, v[144:147] offset:3072
    s_waitcnt vmcnt(25)
    ds_write_b128 v5, v[148:151] offset:4096
    s_waitcnt vmcnt(24)
    ds_write_b128 v5, v[152:155] offset:5120
    s_waitcnt vmcnt(23)
    ds_write_b128 v5, v[156:159] offset:6144
    s_waitcnt vmcnt(22)
    ds_write_b128 v5, v[160:163] offset:7168
    s_waitcnt vmcnt(21)
    ds_write_b128 v5, v[164:167] offset:8192
    s_waitcnt vmcnt(20)
    ds_write_b128 v5, v[168:171] offset:9216
    s_waitcnt vmcnt(19)
    ds_write_b128 v5, v[172:175] offset:10240
    s_waitcnt vmcnt(18)
    ds_write_b128 v5, v[176:179] offset:11264
    s_waitcnt vmcnt(17)
    ds_write_b128 v5, v[180:183] offset:12288
    s_waitcnt vmcnt(16)
    ds_write_b128 v5, v[184:187] offset:13312
    s_waitcnt vmcnt(15)
    ds_write_b128 v5, v[188:191] offset:14336
    s_waitcnt lgkmcnt(0)
    ds_read_b64_tr_b16 a[40:41], v7 offset:0
    ds_read_b64_tr_b16 a[42:43], v7 offset:384
    ds_read_b64_tr_b16 a[44:45], v7 offset:3072
    ds_read_b64_tr_b16 a[46:47], v7 offset:3456
    ds_read_b64_tr_b16 a[48:49], v7 offset:6144
    ds_read_b64_tr_b16 a[50:51], v7 offset:6528
    ds_read_b64_tr_b16 a[52:53], v7 offset:9216
    ds_read_b64_tr_b16 a[54:55], v7 offset:9600
    ds_read_b64_tr_b16 a[56:57], v7 offset:12288
    ds_read_b64_tr_b16 a[58:59], v7 offset:12672
    ds_read_b64_tr_b16 a[120:121], v7 offset:32
    ds_read_b64_tr_b16 a[122:123], v7 offset:416
    s_waitcnt lgkmcnt(0)
    ds_read_b64_tr_b16 a[124:125], v7 offset:3104
    ds_read_b64_tr_b16 a[126:127], v7 offset:3488
    ds_read_b64_tr_b16 a[128:129], v7 offset:6176
    ds_read_b64_tr_b16 a[130:131], v7 offset:6560
    ds_read_b64_tr_b16 a[132:133], v7 offset:9248
    ds_read_b64_tr_b16 a[134:135], v7 offset:9632
    ds_read_b64_tr_b16 a[136:137], v7 offset:12320
    ds_read_b64_tr_b16 a[138:139], v7 offset:12704
    ds_read_b64_tr_b16 a[200:201], v7 offset:64
    ds_read_b64_tr_b16 a[202:203], v7 offset:448
    ds_read_b64_tr_b16 a[204:205], v7 offset:3136
    ds_read_b64_tr_b16 a[206:207], v7 offset:3520
    s_waitcnt lgkmcnt(0)
    ds_read_b64_tr_b16 a[208:209], v7 offset:6208
    ds_read_b64_tr_b16 a[210:211], v7 offset:6592
    ds_read_b64_tr_b16 a[212:213], v7 offset:9280
    ds_read_b64_tr_b16 a[214:215], v7 offset:9664
    ds_read_b64_tr_b16 a[216:217], v7 offset:12352
    ds_read_b64_tr_b16 a[218:219], v7 offset:12736
    s_waitcnt lgkmcnt(0)
    s_waitcnt vmcnt(14)
    ds_write_b128 v5, v[192:195] offset:0
    s_waitcnt vmcnt(13)
    ds_write_b128 v5, v[196:199] offset:1024
    s_waitcnt vmcnt(12)
    ds_write_b128 v5, v[200:203] offset:2048
    s_waitcnt vmcnt(11)
    ds_write_b128 v5, v[204:207] offset:3072
    s_waitcnt vmcnt(10)
    ds_write_b128 v5, v[208:211] offset:4096
    s_waitcnt vmcnt(9)
    ds_write_b128 v5, v[212:215] offset:5120
    s_waitcnt vmcnt(8)
    ds_write_b128 v5, v[216:219] offset:6144
    s_waitcnt vmcnt(7)
    ds_write_b128 v5, v[220:223] offset:7168
    s_waitcnt vmcnt(6)
    ds_write_b128 v5, v[224:227] offset:8192
    s_waitcnt vmcnt(5)
    ds_write_b128 v5, v[228:231] offset:9216
    s_waitcnt vmcnt(4)
    ds_write_b128 v5, v[232:235] offset:10240
    s_waitcnt vmcnt(3)
    ds_write_b128 v5, v[236:239] offset:11264
    s_waitcnt vmcnt(2)
    ds_write_b128 v5, v[240:243] offset:12288
    s_waitcnt vmcnt(1)
    ds_write_b128 v5, v[244:247] offset:13312
    s_waitcnt vmcnt(0)
    ds_write_b128 v5, v[248:251] offset:14336
    s_waitcnt lgkmcnt(0)
    ds_read_b64_tr_b16 a[60:61], v7 offset:0
    ds_read_b64_tr_b16 a[62:63], v7 offset:384
    ds_read_b64_tr_b16 a[64:65], v7 offset:3072
    ds_read_b64_tr_b16 a[66:67], v7 offset:3456
    ds_read_b64_tr_b16 a[68:69], v7 offset:6144
    ds_read_b64_tr_b16 a[70:71], v7 offset:6528
    ds_read_b64_tr_b16 a[72:73], v7 offset:9216
    ds_read_b64_tr_b16 a[74:75], v7 offset:9600
    ds_read_b64_tr_b16 a[76:77], v7 offset:12288
    ds_read_b64_tr_b16 a[78:79], v7 offset:12672
    ds_read_b64_tr_b16 a[140:141], v7 offset:32
    ds_read_b64_tr_b16 a[142:143], v7 offset:416
    s_waitcnt lgkmcnt(0)
    ds_read_b64_tr_b16 a[144:145], v7 offset:3104
    ds_read_b64_tr_b16 a[146:147], v7 offset:3488
    ds_read_b64_tr_b16 a[148:149], v7 offset:6176
    ds_read_b64_tr_b16 a[150:151], v7 offset:6560
    ds_read_b64_tr_b16 a[152:153], v7 offset:9248
    ds_read_b64_tr_b16 a[154:155], v7 offset:9632
    ds_read_b64_tr_b16 a[156:157], v7 offset:12320
    ds_read_b64_tr_b16 a[158:159], v7 offset:12704
    ds_read_b64_tr_b16 a[220:221], v7 offset:64
    ds_read_b64_tr_b16 a[222:223], v7 offset:448
    ds_read_b64_tr_b16 a[224:225], v7 offset:3136
    ds_read_b64_tr_b16 a[226:227], v7 offset:3520
    s_waitcnt lgkmcnt(0)
    ds_read_b64_tr_b16 a[228:229], v7 offset:6208
    ds_read_b64_tr_b16 a[230:231], v7 offset:6592
    ds_read_b64_tr_b16 a[232:233], v7 offset:9280
    ds_read_b64_tr_b16 a[234:235], v7 offset:9664
    ds_read_b64_tr_b16 a[236:237], v7 offset:12352
    ds_read_b64_tr_b16 a[238:239], v7 offset:12736
    s_waitcnt lgkmcnt(0)
    s_branch wk_urgd_83
wk_urgent_82:
    s_mul_i32 s64, s91, 20480
    v_lshl_add_u32 v5, v3, 4, s64
    v_lshrrev_b32 v6, 2, v1
    v_lshl_add_u32 v7, v2, 3, v6
    v_mul_u32_u24 v7, 96, v7
    v_and_b32 v8, 3, v1
    v_lshl_add_u32 v7, v8, 3, v7
    v_add_u32 v7, s64, v7
    s_lshl_b32 s66, s51, 5
    v_add_u32 v6, 0, v3
    v_mul_u32_u24 v8, 10923, v6
    v_lshrrev_b32 v8, 16, v8
    v_mul_u32_u24 v9, 6, v8
    v_sub_u32 v6, v6, v9
    v_mul_lo_u32 v9, v8, s51
    v_lshl_add_u32 v9, v6, 4, v9
    v_add_u32 v6, 64, v3
    v_mul_u32_u24 v8, 10923, v6
    v_lshrrev_b32 v8, 16, v8
    v_mul_u32_u24 v10, 6, v8
    v_sub_u32 v6, v6, v10
    v_mul_lo_u32 v10, v8, s51
    v_lshl_add_u32 v10, v6, 4, v10
    v_add_u32 v6, 128, v3
    v_mul_u32_u24 v8, 10923, v6
    v_lshrrev_b32 v8, 16, v8
    v_mul_u32_u24 v11, 6, v8
    v_sub_u32 v6, v6, v11
    v_mul_lo_u32 v11, v8, s51
    v_lshl_add_u32 v11, v6, 4, v11
    s_mov_b32 s67, s65
    buffer_load_dwordx4 v[12:15], v9, s[44:47], s67 offen
    buffer_load_dwordx4 v[16:19], v10, s[44:47], s67 offen
    buffer_load_dwordx4 v[20:23], v11, s[44:47], s67 offen
    s_add_u32 s67, s67, s66
    buffer_load_dwordx4 v[24:27], v9, s[44:47], s67 offen
    buffer_load_dwordx4 v[28:31], v10, s[44:47], s67 offen
    buffer_load_dwordx4 v[32:35], v11, s[44:47], s67 offen
    s_add_u32 s67, s67, s66
    buffer_load_dwordx4 v[36:39], v9, s[44:47], s67 offen
    buffer_load_dwordx4 v[40:43], v10, s[44:47], s67 offen
    buffer_load_dwordx4 v[44:47], v11, s[44:47], s67 offen
    s_add_u32 s67, s67, s66
    buffer_load_dwordx4 v[48:51], v9, s[44:47], s67 offen
    buffer_load_dwordx4 v[52:55], v10, s[44:47], s67 offen
    buffer_load_dwordx4 v[56:59], v11, s[44:47], s67 offen
    s_add_u32 s67, s67, s66
    buffer_load_dwordx4 v[60:63], v9, s[44:47], s67 offen
    buffer_load_dwordx4 v[64:67], v10, s[44:47], s67 offen
    buffer_load_dwordx4 v[68:71], v11, s[44:47], s67 offen
    s_add_u32 s67, s67, s66
    buffer_load_dwordx4 v[72:75], v9, s[44:47], s67 offen
    buffer_load_dwordx4 v[76:79], v10, s[44:47], s67 offen
    buffer_load_dwordx4 v[80:83], v11, s[44:47], s67 offen
    s_add_u32 s67, s67, s66
    buffer_load_dwordx4 v[84:87], v9, s[44:47], s67 offen
    buffer_load_dwordx4 v[88:91], v10, s[44:47], s67 offen
    buffer_load_dwordx4 v[92:95], v11, s[44:47], s67 offen
    s_add_u32 s67, s67, s66
    buffer_load_dwordx4 v[96:99], v9, s[44:47], s67 offen
    buffer_load_dwordx4 v[100:103], v10, s[44:47], s67 offen
    buffer_load_dwordx4 v[104:107], v11, s[44:47], s67 offen
    s_add_u32 s67, s67, s66
    buffer_load_dwordx4 v[108:111], v9, s[44:47], s67 offen
    buffer_load_dwordx4 v[112:115], v10, s[44:47], s67 offen
    buffer_load_dwordx4 v[116:119], v11, s[44:47], s67 offen
    s_add_u32 s67, s67, s66
    buffer_load_dwordx4 v[120:123], v9, s[44:47], s67 offen
    buffer_load_dwordx4 v[124:127], v10, s[44:47], s67 offen
    buffer_load_dwordx4 v[128:131], v11, s[44:47], s67 offen
    s_add_u32 s67, s67, s66
    buffer_load_dwordx4 v[132:135], v9, s[44:47], s67 offen
    buffer_load_dwordx4 v[136:139], v10, s[44:47], s67 offen
    buffer_load_dwordx4 v[140:143], v11, s[44:47], s67 offen
    s_add_u32 s67, s67, s66
    buffer_load_dwordx4 v[144:147], v9, s[44:47], s67 offen
    buffer_load_dwordx4 v[148:151], v10, s[44:47], s67 offen
    buffer_load_dwordx4 v[152:155], v11, s[44:47], s67 offen
    s_add_u32 s67, s67, s66
    buffer_load_dwordx4 v[156:159], v9, s[44:47], s67 offen
    buffer_load_dwordx4 v[160:163], v10, s[44:47], s67 offen
    buffer_load_dwordx4 v[164:167], v11, s[44:47], s67 offen
    s_add_u32 s67, s67, s66
    buffer_load_dwordx4 v[168:171], v9, s[44:47], s67 offen
    buffer_load_dwordx4 v[172:175], v10, s[44:47], s67 offen
    buffer_load_dwordx4 v[176:179], v11, s[44:47], s67 offen
    s_add_u32 s67, s67, s66
    buffer_load_dwordx4 v[180:183], v9, s[44:47], s67 offen
    buffer_load_dwordx4 v[184:187], v10, s[44:47], s67 offen
    buffer_load_dwordx4 v[188:191], v11, s[44:47], s67 offen
    s_add_u32 s67, s67, s66
    buffer_load_dwordx4 v[192:195], v9, s[44:47], s67 offen
    buffer_load_dwordx4 v[196:199], v10, s[44:47], s67 offen
    buffer_load_dwordx4 v[200:203], v11, s[44:47], s67 offen
    s_add_u32 s67, s67, s66
    buffer_load_dwordx4 v[204:207], v9, s[44:47], s67 offen
    buffer_load_dwordx4 v[208:211], v10, s[44:47], s67 offen
    buffer_load_dwordx4 v[212:215], v11, s[44:47], s67 offen
    s_add_u32 s67, s67, s66
    buffer_load_dwordx4 v[216:219], v9, s[44:47], s67 offen
    buffer_load_dwordx4 v[220:223], v10, s[44:47], s67 offen
    buffer_load_dwordx4 v[224:227], v11, s[44:47], s67 offen
    s_add_u32 s67, s67, s66
    buffer_load_dwordx4 v[228:231], v9, s[44:47], s67 offen
    buffer_load_dwordx4 v[232:235], v10, s[44:47], s67 offen
    buffer_load_dwordx4 v[236:239], v11, s[44:47], s67 offen
    s_add_u32 s67, s67, s66
    buffer_load_dwordx4 v[240:243], v9, s[44:47], s67 offen
    buffer_load_dwordx4 v[244:247], v10, s[44:47], s67 offen
    buffer_load_dwordx4 v[248:251], v11, s[44:47], s67 offen
    s_add_u32 s67, s67, s66
    s_waitcnt vmcnt(59)
    ds_write_b128 v5, v[12:15] offset:0
    s_waitcnt vmcnt(58)
    ds_write_b128 v5, v[16:19] offset:1024
    s_waitcnt vmcnt(57)
    ds_write_b128 v5, v[20:23] offset:2048
    s_waitcnt vmcnt(56)
    ds_write_b128 v5, v[24:27] offset:3072
    s_waitcnt vmcnt(55)
    ds_write_b128 v5, v[28:31] offset:4096
    s_waitcnt vmcnt(54)
    ds_write_b128 v5, v[32:35] offset:5120
    s_waitcnt vmcnt(53)
    ds_write_b128 v5, v[36:39] offset:6144
    s_waitcnt vmcnt(52)
    ds_write_b128 v5, v[40:43] offset:7168
    s_waitcnt vmcnt(51)
    ds_write_b128 v5, v[44:47] offset:8192
    s_waitcnt vmcnt(50)
    ds_write_b128 v5, v[48:51] offset:9216
    s_waitcnt vmcnt(49)
    ds_write_b128 v5, v[52:55] offset:10240
    s_waitcnt vmcnt(48)
    ds_write_b128 v5, v[56:59] offset:11264
    s_waitcnt vmcnt(47)
    ds_write_b128 v5, v[60:63] offset:12288
    s_waitcnt vmcnt(46)
    ds_write_b128 v5, v[64:67] offset:13312
    s_waitcnt vmcnt(45)
    ds_write_b128 v5, v[68:71] offset:14336
    s_waitcnt lgkmcnt(0)
    ds_read_b64_tr_b16 a[0:1], v7 offset:0
    ds_read_b64_tr_b16 a[2:3], v7 offset:384
    ds_read_b64_tr_b16 a[4:5], v7 offset:3072
    ds_read_b64_tr_b16 a[6:7], v7 offset:3456
    ds_read_b64_tr_b16 a[8:9], v7 offset:6144
    ds_read_b64_tr_b16 a[10:11], v7 offset:6528
    ds_read_b64_tr_b16 a[12:13], v7 offset:9216
    ds_read_b64_tr_b16 a[14:15], v7 offset:9600
    ds_read_b64_tr_b16 a[16:17], v7 offset:12288
    ds_read_b64_tr_b16 a[18:19], v7 offset:12672
    ds_read_b64_tr_b16 a[80:81], v7 offset:32
    ds_read_b64_tr_b16 a[82:83], v7 offset:416
    s_waitcnt lgkmcnt(0)
    ds_read_b64_tr_b16 a[84:85], v7 offset:3104
    ds_read_b64_tr_b16 a[86:87], v7 offset:3488
    ds_read_b64_tr_b16 a[88:89], v7 offset:6176
    ds_read_b64_tr_b16 a[90:91], v7 offset:6560
    ds_read_b64_tr_b16 a[92:93], v7 offset:9248
    ds_read_b64_tr_b16 a[94:95], v7 offset:9632
    ds_read_b64_tr_b16 a[96:97], v7 offset:12320
    ds_read_b64_tr_b16 a[98:99], v7 offset:12704
    ds_read_b64_tr_b16 a[160:161], v7 offset:64
    ds_read_b64_tr_b16 a[162:163], v7 offset:448
    ds_read_b64_tr_b16 a[164:165], v7 offset:3136
    ds_read_b64_tr_b16 a[166:167], v7 offset:3520
    s_waitcnt lgkmcnt(0)
    ds_read_b64_tr_b16 a[168:169], v7 offset:6208
    ds_read_b64_tr_b16 a[170:171], v7 offset:6592
    ds_read_b64_tr_b16 a[172:173], v7 offset:9280
    ds_read_b64_tr_b16 a[174:175], v7 offset:9664
    ds_read_b64_tr_b16 a[176:177], v7 offset:12352
    ds_read_b64_tr_b16 a[178:179], v7 offset:12736
    s_waitcnt lgkmcnt(0)
    s_waitcnt vmcnt(44)
    ds_write_b128 v5, v[72:75] offset:0
    s_waitcnt vmcnt(43)
    ds_write_b128 v5, v[76:79] offset:1024
    s_waitcnt vmcnt(42)
    ds_write_b128 v5, v[80:83] offset:2048
    s_waitcnt vmcnt(41)
    ds_write_b128 v5, v[84:87] offset:3072
    s_waitcnt vmcnt(40)
    ds_write_b128 v5, v[88:91] offset:4096
    s_waitcnt vmcnt(39)
    ds_write_b128 v5, v[92:95] offset:5120
    s_waitcnt vmcnt(38)
    ds_write_b128 v5, v[96:99] offset:6144
    s_waitcnt vmcnt(37)
    ds_write_b128 v5, v[100:103] offset:7168
    s_waitcnt vmcnt(36)
    ds_write_b128 v5, v[104:107] offset:8192
    s_waitcnt vmcnt(35)
    ds_write_b128 v5, v[108:111] offset:9216
    s_waitcnt vmcnt(34)
    ds_write_b128 v5, v[112:115] offset:10240
    s_waitcnt vmcnt(33)
    ds_write_b128 v5, v[116:119] offset:11264
    s_waitcnt vmcnt(32)
    ds_write_b128 v5, v[120:123] offset:12288
    s_waitcnt vmcnt(31)
    ds_write_b128 v5, v[124:127] offset:13312
    s_waitcnt vmcnt(30)
    ds_write_b128 v5, v[128:131] offset:14336
    s_waitcnt lgkmcnt(0)
    ds_read_b64_tr_b16 a[20:21], v7 offset:0
    ds_read_b64_tr_b16 a[22:23], v7 offset:384
    ds_read_b64_tr_b16 a[24:25], v7 offset:3072
    ds_read_b64_tr_b16 a[26:27], v7 offset:3456
    ds_read_b64_tr_b16 a[28:29], v7 offset:6144
    ds_read_b64_tr_b16 a[30:31], v7 offset:6528
    ds_read_b64_tr_b16 a[32:33], v7 offset:9216
    ds_read_b64_tr_b16 a[34:35], v7 offset:9600
    ds_read_b64_tr_b16 a[36:37], v7 offset:12288
    ds_read_b64_tr_b16 a[38:39], v7 offset:12672
    ds_read_b64_tr_b16 a[100:101], v7 offset:32
    ds_read_b64_tr_b16 a[102:103], v7 offset:416
    s_waitcnt lgkmcnt(0)
    ds_read_b64_tr_b16 a[104:105], v7 offset:3104
    ds_read_b64_tr_b16 a[106:107], v7 offset:3488
    ds_read_b64_tr_b16 a[108:109], v7 offset:6176
    ds_read_b64_tr_b16 a[110:111], v7 offset:6560
    ds_read_b64_tr_b16 a[112:113], v7 offset:9248
    ds_read_b64_tr_b16 a[114:115], v7 offset:9632
    ds_read_b64_tr_b16 a[116:117], v7 offset:12320
    ds_read_b64_tr_b16 a[118:119], v7 offset:12704
    ds_read_b64_tr_b16 a[180:181], v7 offset:64
    ds_read_b64_tr_b16 a[182:183], v7 offset:448
    ds_read_b64_tr_b16 a[184:185], v7 offset:3136
    ds_read_b64_tr_b16 a[186:187], v7 offset:3520
    s_waitcnt lgkmcnt(0)
    ds_read_b64_tr_b16 a[188:189], v7 offset:6208
    ds_read_b64_tr_b16 a[190:191], v7 offset:6592
    ds_read_b64_tr_b16 a[192:193], v7 offset:9280
    ds_read_b64_tr_b16 a[194:195], v7 offset:9664
    ds_read_b64_tr_b16 a[196:197], v7 offset:12352
    ds_read_b64_tr_b16 a[198:199], v7 offset:12736
    s_waitcnt lgkmcnt(0)
    s_waitcnt vmcnt(29)
    ds_write_b128 v5, v[132:135] offset:0
    s_waitcnt vmcnt(28)
    ds_write_b128 v5, v[136:139] offset:1024
    s_waitcnt vmcnt(27)
    ds_write_b128 v5, v[140:143] offset:2048
    s_waitcnt vmcnt(26)
    ds_write_b128 v5, v[144:147] offset:3072
    s_waitcnt vmcnt(25)
    ds_write_b128 v5, v[148:151] offset:4096
    s_waitcnt vmcnt(24)
    ds_write_b128 v5, v[152:155] offset:5120
    s_waitcnt vmcnt(23)
    ds_write_b128 v5, v[156:159] offset:6144
    s_waitcnt vmcnt(22)
    ds_write_b128 v5, v[160:163] offset:7168
    s_waitcnt vmcnt(21)
    ds_write_b128 v5, v[164:167] offset:8192
    s_waitcnt vmcnt(20)
    ds_write_b128 v5, v[168:171] offset:9216
    s_waitcnt vmcnt(19)
    ds_write_b128 v5, v[172:175] offset:10240
    s_waitcnt vmcnt(18)
    ds_write_b128 v5, v[176:179] offset:11264
    s_waitcnt vmcnt(17)
    ds_write_b128 v5, v[180:183] offset:12288
    s_waitcnt vmcnt(16)
    ds_write_b128 v5, v[184:187] offset:13312
    s_waitcnt vmcnt(15)
    ds_write_b128 v5, v[188:191] offset:14336
    s_waitcnt lgkmcnt(0)
    ds_read_b64_tr_b16 a[40:41], v7 offset:0
    ds_read_b64_tr_b16 a[42:43], v7 offset:384
    ds_read_b64_tr_b16 a[44:45], v7 offset:3072
    ds_read_b64_tr_b16 a[46:47], v7 offset:3456
    ds_read_b64_tr_b16 a[48:49], v7 offset:6144
    ds_read_b64_tr_b16 a[50:51], v7 offset:6528
    ds_read_b64_tr_b16 a[52:53], v7 offset:9216
    ds_read_b64_tr_b16 a[54:55], v7 offset:9600
    ds_read_b64_tr_b16 a[56:57], v7 offset:12288
    ds_read_b64_tr_b16 a[58:59], v7 offset:12672
    ds_read_b64_tr_b16 a[120:121], v7 offset:32
    ds_read_b64_tr_b16 a[122:123], v7 offset:416
    s_waitcnt lgkmcnt(0)
    ds_read_b64_tr_b16 a[124:125], v7 offset:3104
    ds_read_b64_tr_b16 a[126:127], v7 offset:3488
    ds_read_b64_tr_b16 a[128:129], v7 offset:6176
    ds_read_b64_tr_b16 a[130:131], v7 offset:6560
    ds_read_b64_tr_b16 a[132:133], v7 offset:9248
    ds_read_b64_tr_b16 a[134:135], v7 offset:9632
    ds_read_b64_tr_b16 a[136:137], v7 offset:12320
    ds_read_b64_tr_b16 a[138:139], v7 offset:12704
    ds_read_b64_tr_b16 a[200:201], v7 offset:64
    ds_read_b64_tr_b16 a[202:203], v7 offset:448
    ds_read_b64_tr_b16 a[204:205], v7 offset:3136
    ds_read_b64_tr_b16 a[206:207], v7 offset:3520
    s_waitcnt lgkmcnt(0)
    ds_read_b64_tr_b16 a[208:209], v7 offset:6208
    ds_read_b64_tr_b16 a[210:211], v7 offset:6592
    ds_read_b64_tr_b16 a[212:213], v7 offset:9280
    ds_read_b64_tr_b16 a[214:215], v7 offset:9664
    ds_read_b64_tr_b16 a[216:217], v7 offset:12352
    ds_read_b64_tr_b16 a[218:219], v7 offset:12736
    s_waitcnt lgkmcnt(0)
    s_waitcnt vmcnt(14)
    ds_write_b128 v5, v[192:195] offset:0
    s_waitcnt vmcnt(13)
    ds_write_b128 v5, v[196:199] offset:1024
    s_waitcnt vmcnt(12)
    ds_write_b128 v5, v[200:203] offset:2048
    s_waitcnt vmcnt(11)
    ds_write_b128 v5, v[204:207] offset:3072
    s_waitcnt vmcnt(10)
    ds_write_b128 v5, v[208:211] offset:4096
    s_waitcnt vmcnt(9)
    ds_write_b128 v5, v[212:215] offset:5120
    s_waitcnt vmcnt(8)
    ds_write_b128 v5, v[216:219] offset:6144
    s_waitcnt vmcnt(7)
    ds_write_b128 v5, v[220:223] offset:7168
    s_waitcnt vmcnt(6)
    ds_write_b128 v5, v[224:227] offset:8192
    s_waitcnt vmcnt(5)
    ds_write_b128 v5, v[228:231] offset:9216
    s_waitcnt vmcnt(4)
    ds_write_b128 v5, v[232:235] offset:10240
    s_waitcnt vmcnt(3)
    ds_write_b128 v5, v[236:239] offset:11264
    s_waitcnt vmcnt(2)
    ds_write_b128 v5, v[240:243] offset:12288
    s_waitcnt vmcnt(1)
    ds_write_b128 v5, v[244:247] offset:13312
    s_waitcnt vmcnt(0)
    ds_write_b128 v5, v[248:251] offset:14336
    s_waitcnt lgkmcnt(0)
    ds_read_b64_tr_b16 a[60:61], v7 offset:0
    ds_read_b64_tr_b16 a[62:63], v7 offset:384
    ds_read_b64_tr_b16 a[64:65], v7 offset:3072
    ds_read_b64_tr_b16 a[66:67], v7 offset:3456
    ds_read_b64_tr_b16 a[68:69], v7 offset:6144
    ds_read_b64_tr_b16 a[70:71], v7 offset:6528
    ds_read_b64_tr_b16 a[72:73], v7 offset:9216
    ds_read_b64_tr_b16 a[74:75], v7 offset:9600
    ds_read_b64_tr_b16 a[76:77], v7 offset:12288
    ds_read_b64_tr_b16 a[78:79], v7 offset:12672
    ds_read_b64_tr_b16 a[140:141], v7 offset:32
    ds_read_b64_tr_b16 a[142:143], v7 offset:416
    s_waitcnt lgkmcnt(0)
    ds_read_b64_tr_b16 a[144:145], v7 offset:3104
    ds_read_b64_tr_b16 a[146:147], v7 offset:3488
    ds_read_b64_tr_b16 a[148:149], v7 offset:6176
    ds_read_b64_tr_b16 a[150:151], v7 offset:6560
    ds_read_b64_tr_b16 a[152:153], v7 offset:9248
    ds_read_b64_tr_b16 a[154:155], v7 offset:9632
    ds_read_b64_tr_b16 a[156:157], v7 offset:12320
    ds_read_b64_tr_b16 a[158:159], v7 offset:12704
    ds_read_b64_tr_b16 a[220:221], v7 offset:64
    ds_read_b64_tr_b16 a[222:223], v7 offset:448
    ds_read_b64_tr_b16 a[224:225], v7 offset:3136
    ds_read_b64_tr_b16 a[226:227], v7 offset:3520
    s_waitcnt lgkmcnt(0)
    ds_read_b64_tr_b16 a[228:229], v7 offset:6208
    ds_read_b64_tr_b16 a[230:231], v7 offset:6592
    ds_read_b64_tr_b16 a[232:233], v7 offset:9280
    ds_read_b64_tr_b16 a[234:235], v7 offset:9664
    ds_read_b64_tr_b16 a[236:237], v7 offset:12352
    ds_read_b64_tr_b16 a[238:239], v7 offset:12736
    s_waitcnt lgkmcnt(0)
    v_mov_b32 v254, 68
    s_mov_b32 s93, 0
wi_p_89:
    buffer_load_dword v255, v254, s[32:35], 0 offen sc1
    s_waitcnt vmcnt(0)
    v_cmp_le_u32 vcc, 256, v255
    s_cbranch_vccnz wi_ok_90
    s_sleep 4
    s_add_u32 s93, s93, 1
    s_cmp_lt_u32 s93, 1048576
    s_cbranch_scc1 wi_p_89
wi_ok_90:
    s_cmp_lg_u32 s58, 0
    s_cbranch_scc1 cm_ok_91
    v_and_b32 v254, 7, v0
    v_lshlrev_b32 v254, 2, v254
    buffer_load_dword v255, v254, s[32:35], 0 offen sc1
    s_waitcnt vmcnt(0)
    v_cmp_ne_u32 vcc, 32, v255
    s_cbranch_vccz cm_ok_91
    s_mov_b32 s58, 1
    s_lshr_b32 s56, s88, 5
    s_and_b32 s57, s88, 31
    s_barrier
    s_branch rc_restart_8
cm_ok_91:
wk_urgd_83:
    buffer_load_dwordx4 v[16:19], v4, s[40:43], s48 offen
    s_add_u32 s48, s48, 4096
    buffer_load_dwordx4 v[20:23], v4, s[40:43], s48 offen
    s_add_u32 s48, s48, 4096
    buffer_load_dwordx4 v[24:27], v4, s[40:43], s48 offen
    s_add_u32 s48, s48, 4096
    buffer_load_dwordx4 v[28:31], v4, s[40:43], s48 offen
    s_add_u32 s48, s48, 4096
    buffer_load_dwordx4 v[32:35], v4, s[40:43], s48 offen
    s_add_u32 s48, s48, 4096
    buffer_load_dwordx4 v[36:39], v4, s[40:43], s48 offen
    s_add_u32 s48, s48, 4096
    buffer_load_dwordx4 v[40:43], v4, s[40:43], s48 offen
    s_add_u32 s48, s48, 4096
    buffer_load_dwordx4 v[44:47], v4, s[40:43], s48 offen
    s_add_u32 s48, s48, 4096
    buffer_load_dwordx4 v[48:51], v4, s[40:43], s48 offen
    s_add_u32 s48, s48, 4096
    buffer_load_dwordx4 v[52:55], v4, s[40:43], s48 offen
    s_add_u32 s48, s48, 4096
    v_add_u32 v5, 0, v0
    v_mul_u32_u24 v6, 3277, v5
    v_lshrrev_b32 v6, 18, v6
    v_mul_u32_u24 v7, 80, v6
    v_sub_u32 v7, v5, v7
    v_and_b32 v8, 15, v6
    v_xor_b32 v7, v7, v8
    v_mul_u32_u24 v56, 1280, v6
    v_lshl_add_u32 v56, v7, 4, v56
    v_add_u32 v5, 256, v0
    v_mul_u32_u24 v6, 3277, v5
    v_lshrrev_b32 v6, 18, v6
    v_mul_u32_u24 v7, 80, v6
    v_sub_u32 v7, v5, v7
    v_and_b32 v8, 15, v6
    v_xor_b32 v7, v7, v8
    v_mul_u32_u24 v57, 1280, v6
    v_lshl_add_u32 v57, v7, 4, v57
    v_add_u32 v5, 512, v0
    v_mul_u32_u24 v6, 3277, v5
    v_lshrrev_b32 v6, 18, v6
    v_mul_u32_u24 v7, 80, v6
    v_sub_u32 v7, v5, v7
    v_and_b32 v8, 15, v6
    v_xor_b32 v7, v7, v8
    v_mul_u32_u24 v58, 1280, v6
    v_lshl_add_u32 v58, v7, 4, v58
    v_add_u32 v5, 768, v0
    v_mul_u32_u24 v6, 3277, v5
    v_lshrrev_b32 v6, 18, v6
    v_mul_u32_u24 v7, 80, v6
    v_sub_u32 v7, v5, v7
    v_and_b32 v8, 15, v6
    v_xor_b32 v7, v7, v8
    v_mul_u32_u24 v59, 1280, v6
    v_lshl_add_u32 v59, v7, 4, v59
    v_add_u32 v5, 1024, v0
    v_mul_u32_u24 v6, 3277, v5
    v_lshrrev_b32 v6, 18, v6
    v_mul_u32_u24 v7, 80, v6
    v_sub_u32 v7, v5, v7
    v_and_b32 v8, 15, v6
    v_xor_b32 v7, v7, v8
    v_mul_u32_u24 v60, 1280, v6
    v_lshl_add_u32 v60, v7, 4, v60
    v_add_u32 v5, 1280, v0
    v_mul_u32_u24 v6, 3277, v5
    v_lshrrev_b32 v6, 18, v6
    v_mul_u32_u24 v7, 80, v6
    v_sub_u32 v7, v5, v7
    v_and_b32 v8, 15, v6
    v_xor_b32 v7, v7, v8
    v_mul_u32_u24 v61, 1280, v6
    v_lshl_add_u32 v61, v7, 4, v61
    v_add_u32 v5, 1536, v0
    v_mul_u32_u24 v6, 3277, v5
    v_lshrrev_b32 v6, 18, v6
    v_mul_u32_u24 v7, 80, v6
    v_sub_u32 v7, v5, v7
    v_and_b32 v8, 15, v6
    v_xor_b32 v7, v7, v8
    v_mul_u32_u24 v62, 1280, v6
    v_lshl_add_u32 v62, v7, 4, v62
    v_add_u32 v5, 1792, v0
    v_mul_u32_u24 v6, 3277, v5
    v_lshrrev_b32 v6, 18, v6
    v_mul_u32_u24 v7, 80, v6
    v_sub_u32 v7, v5, v7
    v_and_b32 v8, 15, v6
    v_xor_b32 v7, v7, v8
    v_mul_u32_u24 v63, 1280, v6
    v_lshl_add_u32 v63, v7, 4, v63
    v_add_u32 v5, 2048, v0
    v_mul_u32_u24 v6, 3277, v5
    v_lshrrev_b32 v6, 18, v6
    v_mul_u32_u24 v7, 80, v6
    v_sub_u32 v7, v5, v7
    v_and_b32 v8, 15, v6
    v_xor_b32 v7, v7, v8
    v_mul_u32_u24 v64, 1280, v6
    v_lshl_add_u32 v64, v7, 4, v64
    v_add_u32 v5, 2304, v0
    v_mul_u32_u24 v6, 3277, v5
    v_lshrrev_b32 v6, 18, v6
    v_mul_u32_u24 v7, 80, v6
    v_sub_u32 v7, v5, v7
    v_and_b32 v8, 15, v6
    v_xor_b32 v7, v7, v8
    v_mul_u32_u24 v65, 1280, v6
    v_lshl_add_u32 v65, v7, 4, v65
    v_add_u32 v5, 0, v2
    v_xor_b32 v5, v5, v1
    v_mul_u32_u24 v66, 1280, v1
    v_lshl_add_u32 v66, v5, 4, v66
    v_add_u32 v5, 4, v2
    v_xor_b32 v5, v5, v1
    v_mul_u32_u24 v67, 1280, v1
    v_lshl_add_u32 v67, v5, 4, v67
    v_add_u32 v5, 8, v2
    v_xor_b32 v5, v5, v1
    v_mul_u32_u24 v68, 1280, v1
    v_lshl_add_u32 v68, v5, 4, v68
    v_add_u32 v5, 12, v2
    v_xor_b32 v5, v5, v1
    v_mul_u32_u24 v69, 1280, v1
    v_lshl_add_u32 v69, v5, 4, v69
    s_cmp_eq_u32 s18, 2
    s_cbranch_scc1 ga_av_92
    v_mul_u32_u24 v70, 400, v1
    s_mul_i32 s64, s91, 96
    v_lshl_add_u32 v5, v2, 3, s64
    v_add_u32 v70, v70, v5
    v_add_u32 v70, 81920, v70
    s_cmp_eq_u32 s18, 3
    s_cbranch_scc1 ga_ah_93
    v_add_u32 v5, 0, v0
    v_lshrrev_b32 v6, 6, v5
    v_bfe_u32 v7, v5, 1, 5
    v_and_b32 v8, 1, v5
    v_lshl_add_u32 v6, v6, 1, v8
    v_mul_u32_u24 v71, 400, v7
    v_lshl_add_u32 v71, v6, 4, v71
    v_add_u32 v71, 81920, v71
    v_add_u32 v5, 256, v0
    v_lshrrev_b32 v6, 6, v5
    v_bfe_u32 v7, v5, 1, 5
    v_and_b32 v8, 1, v5
    v_lshl_add_u32 v6, v6, 1, v8
    v_mul_u32_u24 v72, 400, v7
    v_lshl_add_u32 v72, v6, 4, v72
    v_add_u32 v72, 81920, v72
    v_add_u32 v5, 512, v0
    v_lshrrev_b32 v6, 6, v5
    v_bfe_u32 v7, v5, 1, 5
    v_and_b32 v8, 1, v5
    v_lshl_add_u32 v6, v6, 1, v8
    v_mul_u32_u24 v73, 400, v7
    v_lshl_add_u32 v73, v6, 4, v73
    v_add_u32 v73, 81920, v73
    s_branch ga_ad_94
ga_ah_93:
    v_add_u32 v5, 0, v0
    v_lshrrev_b32 v6, 7, v5
    v_bfe_u32 v7, v5, 2, 5
    v_and_b32 v8, 3, v5
    v_lshl_add_u32 v6, v6, 2, v8
    v_mul_u32_u24 v71, 400, v7
    v_lshl_add_u32 v71, v6, 4, v71
    v_add_u32 v71, 81920, v71
    v_add_u32 v5, 256, v0
    v_lshrrev_b32 v6, 7, v5
    v_bfe_u32 v7, v5, 2, 5
    v_and_b32 v8, 3, v5
    v_lshl_add_u32 v6, v6, 2, v8
    v_mul_u32_u24 v72, 400, v7
    v_lshl_add_u32 v72, v6, 4, v72
    v_add_u32 v72, 81920, v72
    v_add_u32 v5, 512, v0
    v_lshrrev_b32 v6, 7, v5
    v_bfe_u32 v7, v5, 2, 5
    v_and_b32 v8, 3, v5
    v_lshl_add_u32 v6, v6, 2, v8
    v_mul_u32_u24 v73, 400, v7
    v_lshl_add_u32 v73, v6, 4, v73
    v_add_u32 v73, 81920, v73
    s_mul_i32 s64, s19, 384
    s_mul_i32 s66, s91, 96
    s_add_u32 s64, s64, s66
    v_lshlrev_b32 v5, 3, v2
    buffer_load_dwordx2 v[144:145], v5, s[68:71], s64 offen offset:0
    buffer_load_dwordx2 v[146:147], v5, s[68:71], s64 offen offset:32
    buffer_load_dwordx2 v[148:149], v5, s[68:71], s64 offen offset:64
    s_waitcnt vmcnt(0)
    v_and_b32 v77, 0xffff0000, v144
    v_lshlrev_b32 v76, 16, v144
    v_and_b32 v79, 0xffff0000, v145
    v_lshlrev_b32 v78, 16, v145
    v_and_b32 v81, 0xffff0000, v146
    v_lshlrev_b32 v80, 16, v146
    v_and_b32 v83, 0xffff0000, v147
    v_lshlrev_b32 v82, 16, v147
    v_and_b32 v85, 0xffff0000, v148
    v_lshlrev_b32 v84, 16, v148
    v_and_b32 v87, 0xffff0000, v149
    v_lshlrev_b32 v86, 16, v149
    s_branch ga_ad_94
ga_av_92:
    s_mul_i32 s64, s91, 48
    v_add_u32 v5, s64, v1
    v_mul_u32_u24 v70, 80, v5
    v_and_b32 v6, 1, v2
    v_lshl_add_u32 v70, v6, 4, v70
    v_lshrrev_b32 v6, 1, v2
    v_lshl_add_u32 v70, v6, 3, v70
    v_add_u32 v70, 81920, v70
    v_add_u32 v5, 0, v0
    v_lshrrev_b32 v6, 2, v5
    v_and_b32 v7, 3, v5
    v_mul_u32_u24 v71, 80, v6
    v_lshl_add_u32 v71, v7, 4, v71
    v_add_u32 v71, 81920, v71
    v_add_u32 v5, 256, v0
    v_lshrrev_b32 v6, 2, v5
    v_and_b32 v7, 3, v5
    v_mul_u32_u24 v72, 80, v6
    v_lshl_add_u32 v72, v7, 4, v72
    v_add_u32 v72, 81920, v72
    v_add_u32 v5, 512, v0
    v_lshrrev_b32 v6, 2, v5
    v_and_b32 v7, 3, v5
    v_mul_u32_u24 v73, 80, v6
    v_lshl_add_u32 v73, v7, 4, v73
    v_add_u32 v73, 81920, v73
ga_ad_94:
    s_mul_i32 s55, s18, 0x01800000
    s_mul_i32 s64, s19, 12288
    s_add_u32 s55, s55, s64
    s_mov_b32 s56, 393216
    s_cmp_eq_u32 s18, 3
    s_cselect_b32 s56, 98304, s56
    v_lshlrev_b32 v74, 4, v0
    v_add_u32 v75, 4096, v74
    v_add_u32 v15, 8192, v74
    s_mov_b32 s57, 0x3dd2d3e8
    v_mov_b32 v147, 0x40135761
    v_mov_b32 v151, 0x40135761
    s_mov_b32 s58, 64
    s_cmp_eq_u32 s18, 0
    s_cselect_b32 s58, 0, s58
    s_cmp_eq_u32 s18, 3
    s_cselect_b32 s58, 128, s58
    s_barrier
    s_waitcnt vmcnt(0)
    ds_write_b128 v56, v[16:19]
    ds_write_b128 v57, v[20:23]
    ds_write_b128 v58, v[24:27]
    ds_write_b128 v59, v[28:31]
    ds_write_b128 v60, v[32:35]
    ds_write_b128 v61, v[36:39]
    ds_write_b128 v62, v[40:43]
    ds_write_b128 v63, v[44:47]
    ds_write_b128 v64, v[48:51]
    ds_write_b128 v65, v[52:55]
    buffer_load_dwordx4 v[16:19], v4, s[40:43], s48 offen
    s_add_u32 s48, s48, 4096
    buffer_load_dwordx4 v[20:23], v4, s[40:43], s48 offen
    s_add_u32 s48, s48, 4096
    buffer_load_dwordx4 v[24:27], v4, s[40:43], s48 offen
    s_add_u32 s48, s48, 4096
    buffer_load_dwordx4 v[28:31], v4, s[40:43], s48 offen
    s_add_u32 s48, s48, 4096
    buffer_load_dwordx4 v[32:35], v4, s[40:43], s48 offen
    s_add_u32 s48, s48, 4096
    buffer_load_dwordx4 v[36:39], v4, s[40:43], s48 offen
    s_add_u32 s48, s48, 4096
    buffer_load_dwordx4 v[40:43], v4, s[40:43], s48 offen
    s_add_u32 s48, s48, 4096
    buffer_load_dwordx4 v[44:47], v4, s[40:43], s48 offen
    s_add_u32 s48, s48, 4096
    buffer_load_dwordx4 v[48:51], v4, s[40:43], s48 offen
    s_add_u32 s48, s48, 4096
    buffer_load_dwordx4 v[52:55], v4, s[40:43], s48 offen
    s_add_u32 s48, s48, 4096
    s_mov_b32 s64, 0x7f000000
    buffer_store_dwordx4 v[176:179], v74, s[60:63], s64 offen sc1
    buffer_store_dwordx4 v[180:183], v75, s[60:63], s64 offen sc1
    buffer_store_dwordx4 v[184:187], v15, s[60:63], s64 offen sc1
    s_mov_b32 s54, 0
    s_cmp_eq_u32 s18, 2
    s_cbranch_scc1 ga_loop_v_96
    s_cmp_eq_u32 s18, 3
    s_cbranch_scc1 ga_loop_h_97
ga_loop_q_95:
    s_waitcnt vmcnt(3) lgkmcnt(0)
    s_barrier
    s_cmp_lt_u32 s54, 6
    s_cbranch_scc1 ga_ns_99
    s_cmp_lg_u32 s91, 0
    s_cbranch_scc1 ga_ns_99
    s_sub_u32 s64, s54, 3
    s_add_u32 s64, s64, s58
    s_add_u32 s93, s64, 0
    s_lshl_b32 s93, s93, 8
    v_mov_b32 v254, s93
    v_mov_b32 v255, 1
    s_mov_b64 s[94:95], exec
    s_mov_b64 exec, 1
    buffer_atomic_add v255, v254, s[28:31], 0 offen
    s_mov_b64 exec, s[94:95]
ga_ns_99:
    s_cmp_lt_u32 s54, 4
    s_cselect_b32 s64, 0x7f000000, s55
    s_cselect_b32 s65, 0, s56
    s_add_u32 s55, s55, s65
    ds_read_b128 v[112:115], v66 offset:0
    ds_read_b128 v[116:119], v67 offset:0
    ds_read_b128 v[120:123], v68 offset:0
    ds_read_b128 v[124:127], v69 offset:0
    ds_read_b128 v[128:131], v66 offset:256
    ds_read_b128 v[132:135], v67 offset:256
    ds_read_b128 v[176:179], v71 offset:15360
    ds_read_b128 v[180:183], v72 offset:15360
    ds_read_b128 v[184:187], v73 offset:15360
    s_waitcnt lgkmcnt(8)
    v_mfma_f32_16x16x32_bf16 v[88:91], a[0:3], v[112:115], 0
    v_mfma_f32_16x16x32_bf16 v[92:95], a[80:83], v[112:115], 0
    v_mfma_f32_16x16x32_bf16 v[96:99], a[160:163], v[112:115], 0
    ds_read_b128 v[136:139], v68 offset:256
    s_waitcnt lgkmcnt(8)
    v_mfma_f32_16x16x32_bf16 v[88:91], a[4:7], v[116:119], v[88:91]
    v_mfma_f32_16x16x32_bf16 v[92:95], a[84:87], v[116:119], v[92:95]
    v_mfma_f32_16x16x32_bf16 v[96:99], a[164:167], v[116:119], v[96:99]
    ds_read_b128 v[140:143], v69 offset:256
    ds_write_b128 v56, v[16:19] offset:40960
    s_waitcnt lgkmcnt(9)
    v_mfma_f32_16x16x32_bf16 v[88:91], a[8:11], v[120:123], v[88:91]
    v_mfma_f32_16x16x32_bf16 v[92:95], a[88:91], v[120:123], v[92:95]
    v_mfma_f32_16x16x32_bf16 v[96:99], a[168:171], v[120:123], v[96:99]
    ds_read_b128 v[112:115], v66 offset:512
    buffer_load_dwordx4 v[16:19], v4, s[40:43], s48 offen
    s_add_u32 s48, s48, 4096
    s_waitcnt lgkmcnt(9)
    v_mfma_f32_16x16x32_bf16 v[88:91], a[12:15], v[124:127], v[88:91]
    v_mfma_f32_16x16x32_bf16 v[92:95], a[92:95], v[124:127], v[92:95]
    v_mfma_f32_16x16x32_bf16 v[96:99], a[172:175], v[124:127], v[96:99]
    ds_read_b128 v[116:119], v67 offset:512
    ds_write_b128 v57, v[20:23] offset:40960
    s_waitcnt lgkmcnt(10)
    v_mfma_f32_16x16x32_bf16 v[88:91], a[16:19], v[128:131], v[88:91]
    v_mfma_f32_16x16x32_bf16 v[92:95], a[96:99], v[128:131], v[92:95]
    v_mfma_f32_16x16x32_bf16 v[96:99], a[176:179], v[128:131], v[96:99]
    ds_read_b128 v[120:123], v68 offset:512
    buffer_load_dwordx4 v[20:23], v4, s[40:43], s48 offen
    s_add_u32 s48, s48, 4096
    s_waitcnt lgkmcnt(10)
    v_mfma_f32_16x16x32_bf16 v[88:91], a[20:23], v[132:135], v[88:91]
    v_mfma_f32_16x16x32_bf16 v[92:95], a[100:103], v[132:135], v[92:95]
    v_mfma_f32_16x16x32_bf16 v[96:99], a[180:183], v[132:135], v[96:99]
    ds_read_b128 v[124:127], v69 offset:512
    ds_write_b128 v58, v[24:27] offset:40960
    s_waitcnt lgkmcnt(8)
    v_mfma_f32_16x16x32_bf16 v[88:91], a[24:27], v[136:139], v[88:91]
    v_mfma_f32_16x16x32_bf16 v[92:95], a[104:107], v[136:139], v[92:95]
    v_mfma_f32_16x16x32_bf16 v[96:99], a[184:187], v[136:139], v[96:99]
    ds_read_b128 v[128:131], v66 offset:768
    buffer_load_dwordx4 v[24:27], v4, s[40:43], s48 offen
    s_add_u32 s48, s48, 4096
    s_waitcnt lgkmcnt(8)
    v_mfma_f32_16x16x32_bf16 v[88:91], a[28:31], v[140:143], v[88:91]
    v_mfma_f32_16x16x32_bf16 v[92:95], a[108:111], v[140:143], v[92:95]
    v_mfma_f32_16x16x32_bf16 v[96:99], a[188:191], v[140:143], v[96:99]
    ds_read_b128 v[132:135], v67 offset:768
    ds_write_b128 v59, v[28:31] offset:40960
    s_waitcnt lgkmcnt(8)
    v_mfma_f32_16x16x32_bf16 v[88:91], a[32:35], v[112:115], v[88:91]
    v_mfma_f32_16x16x32_bf16 v[92:95], a[112:115], v[112:115], v[92:95]
    v_mfma_f32_16x16x32_bf16 v[96:99], a[192:195], v[112:115], v[96:99]
    ds_read_b128 v[136:139], v68 offset:768
    buffer_load_dwordx4 v[28:31], v4, s[40:43], s48 offen
    s_add_u32 s48, s48, 4096
    s_waitcnt lgkmcnt(8)
    v_mfma_f32_16x16x32_bf16 v[88:91], a[36:39], v[116:119], v[88:91]
    v_mfma_f32_16x16x32_bf16 v[92:95], a[116:119], v[116:119], v[92:95]
    v_mfma_f32_16x16x32_bf16 v[96:99], a[196:199], v[116:119], v[96:99]
    ds_read_b128 v[140:143], v69 offset:768
    ds_write_b128 v60, v[32:35] offset:40960
    s_waitcnt lgkmcnt(8)
    v_mfma_f32_16x16x32_bf16 v[88:91], a[40:43], v[120:123], v[88:91]
    v_mfma_f32_16x16x32_bf16 v[92:95], a[120:123], v[120:123], v[92:95]
    v_mfma_f32_16x16x32_bf16 v[96:99], a[200:203], v[120:123], v[96:99]
    ds_read_b128 v[112:115], v66 offset:1024
    buffer_load_dwordx4 v[32:35], v4, s[40:43], s48 offen
    s_add_u32 s48, s48, 4096
    s_waitcnt lgkmcnt(8)
    v_mfma_f32_16x16x32_bf16 v[88:91], a[44:47], v[124:127], v[88:91]
    v_mfma_f32_16x16x32_bf16 v[92:95], a[124:127], v[124:127], v[92:95]
    v_mfma_f32_16x16x32_bf16 v[96:99], a[204:207], v[124:127], v[96:99]
    ds_read_b128 v[116:119], v67 offset:1024
    ds_write_b128 v61, v[36:39] offset:40960
    s_waitcnt lgkmcnt(8)
    v_mfma_f32_16x16x32_bf16 v[88:91], a[48:51], v[128:131], v[88:91]
    v_mfma_f32_16x16x32_bf16 v[92:95], a[128:131], v[128:131], v[92:95]
    v_mfma_f32_16x16x32_bf16 v[96:99], a[208:211], v[128:131], v[96:99]
    ds_read_b128 v[120:123], v68 offset:1024
    buffer_load_dwordx4 v[36:39], v4, s[40:43], s48 offen
    s_add_u32 s48, s48, 4096
    s_waitcnt lgkmcnt(8)
    v_mfma_f32_16x16x32_bf16 v[88:91], a[52:55], v[132:135], v[88:91]
    v_mfma_f32_16x16x32_bf16 v[92:95], a[132:135], v[132:135], v[92:95]
    v_mfma_f32_16x16x32_bf16 v[96:99], a[212:215], v[132:135], v[96:99]
    ds_read_b128 v[124:127], v69 offset:1024
    ds_write_b128 v62, v[40:43] offset:40960
    s_waitcnt lgkmcnt(8)
    v_mfma_f32_16x16x32_bf16 v[88:91], a[56:59], v[136:139], v[88:91]
    v_mfma_f32_16x16x32_bf16 v[92:95], a[136:139], v[136:139], v[92:95]
    v_mfma_f32_16x16x32_bf16 v[96:99], a[216:219], v[136:139], v[96:99]
    ds_read_b128 v[128:131], v66 offset:20480
    buffer_load_dwordx4 v[40:43], v4, s[40:43], s48 offen
    s_add_u32 s48, s48, 4096
    s_waitcnt lgkmcnt(8)
    v_mfma_f32_16x16x32_bf16 v[88:91], a[60:63], v[140:143], v[88:91]
    v_mfma_f32_16x16x32_bf16 v[92:95], a[140:143], v[140:143], v[92:95]
    v_mfma_f32_16x16x32_bf16 v[96:99], a[220:223], v[140:143], v[96:99]
    ds_read_b128 v[132:135], v67 offset:20480
    ds_write_b128 v63, v[44:47] offset:40960
    s_waitcnt lgkmcnt(8)
    v_mfma_f32_16x16x32_bf16 v[88:91], a[64:67], v[112:115], v[88:91]
    v_mfma_f32_16x16x32_bf16 v[92:95], a[144:147], v[112:115], v[92:95]
    v_mfma_f32_16x16x32_bf16 v[96:99], a[224:227], v[112:115], v[96:99]
    ds_read_b128 v[136:139], v68 offset:20480
    buffer_load_dwordx4 v[44:47], v4, s[40:43], s48 offen
    s_add_u32 s48, s48, 4096
    s_waitcnt lgkmcnt(8)
    v_mfma_f32_16x16x32_bf16 v[88:91], a[68:71], v[116:119], v[88:91]
    v_mfma_f32_16x16x32_bf16 v[92:95], a[148:151], v[116:119], v[92:95]
    v_mfma_f32_16x16x32_bf16 v[96:99], a[228:231], v[116:119], v[96:99]
    ds_read_b128 v[140:143], v69 offset:20480
    ds_write_b128 v64, v[48:51] offset:40960
    s_waitcnt lgkmcnt(8)
    v_mfma_f32_16x16x32_bf16 v[88:91], a[72:75], v[120:123], v[88:91]
    v_mfma_f32_16x16x32_bf16 v[92:95], a[152:155], v[120:123], v[92:95]
    v_mfma_f32_16x16x32_bf16 v[96:99], a[232:235], v[120:123], v[96:99]
    ds_read_b128 v[112:115], v66 offset:20736
    buffer_load_dwordx4 v[48:51], v4, s[40:43], s48 offen
    s_add_u32 s48, s48, 4096
    s_waitcnt lgkmcnt(8)
    v_mfma_f32_16x16x32_bf16 v[88:91], a[76:79], v[124:127], v[88:91]
    v_mfma_f32_16x16x32_bf16 v[92:95], a[156:159], v[124:127], v[92:95]
    v_mfma_f32_16x16x32_bf16 v[96:99], a[236:239], v[124:127], v[96:99]
    ds_read_b128 v[116:119], v67 offset:20736
    ds_write_b128 v65, v[52:55] offset:40960
    s_waitcnt lgkmcnt(8)
    v_mfma_f32_16x16x32_bf16 v[100:103], a[0:3], v[128:131], 0
    v_mfma_f32_16x16x32_bf16 v[104:107], a[80:83], v[128:131], 0
    v_mfma_f32_16x16x32_bf16 v[108:111], a[160:163], v[128:131], 0
    ds_read_b128 v[120:123], v68 offset:20736
    buffer_load_dwordx4 v[52:55], v4, s[40:43], s48 offen
    s_add_u32 s48, s48, 4096
    s_waitcnt lgkmcnt(8)
    v_mfma_f32_16x16x32_bf16 v[100:103], a[4:7], v[132:135], v[100:103]
    v_mfma_f32_16x16x32_bf16 v[104:107], a[84:87], v[132:135], v[104:107]
    v_mfma_f32_16x16x32_bf16 v[108:111], a[164:167], v[132:135], v[108:111]
    ds_read_b128 v[124:127], v69 offset:20736
    s_waitcnt lgkmcnt(7)
    v_mfma_f32_16x16x32_bf16 v[100:103], a[8:11], v[136:139], v[100:103]
    v_mfma_f32_16x16x32_bf16 v[104:107], a[88:91], v[136:139], v[104:107]
    v_mfma_f32_16x16x32_bf16 v[108:111], a[168:171], v[136:139], v[108:111]
    ds_read_b128 v[128:131], v66 offset:20992
    buffer_store_dwordx4 v[176:179], v74, s[60:63], s64 offen sc1
    s_waitcnt lgkmcnt(7)
    v_mfma_f32_16x16x32_bf16 v[100:103], a[12:15], v[140:143], v[100:103]
    v_mfma_f32_16x16x32_bf16 v[104:107], a[92:95], v[140:143], v[104:107]
    v_mfma_f32_16x16x32_bf16 v[108:111], a[172:175], v[140:143], v[108:111]
    ds_read_b128 v[132:135], v67 offset:20992
    s_waitcnt lgkmcnt(6)
    v_mfma_f32_16x16x32_bf16 v[100:103], a[16:19], v[112:115], v[100:103]
    v_mfma_f32_16x16x32_bf16 v[104:107], a[96:99], v[112:115], v[104:107]
    v_mfma_f32_16x16x32_bf16 v[108:111], a[176:179], v[112:115], v[108:111]
    ds_read_b128 v[136:139], v68 offset:20992
    buffer_store_dwordx4 v[180:183], v75, s[60:63], s64 offen sc1
    s_waitcnt lgkmcnt(6)
    v_mfma_f32_16x16x32_bf16 v[100:103], a[20:23], v[116:119], v[100:103]
    v_mfma_f32_16x16x32_bf16 v[104:107], a[100:103], v[116:119], v[104:107]
    v_mfma_f32_16x16x32_bf16 v[108:111], a[180:183], v[116:119], v[108:111]
    ds_read_b128 v[140:143], v69 offset:20992
    s_waitcnt lgkmcnt(5)
    v_mfma_f32_16x16x32_bf16 v[100:103], a[24:27], v[120:123], v[100:103]
    v_mfma_f32_16x16x32_bf16 v[104:107], a[104:107], v[120:123], v[104:107]
    v_mfma_f32_16x16x32_bf16 v[108:111], a[184:187], v[120:123], v[108:111]
    ds_read_b128 v[112:115], v66 offset:21248
    buffer_store_dwordx4 v[184:187], v15, s[60:63], s64 offen sc1
    s_waitcnt lgkmcnt(5)
    v_mfma_f32_16x16x32_bf16 v[100:103], a[28:31], v[124:127], v[100:103]
    v_mfma_f32_16x16x32_bf16 v[104:107], a[108:111], v[124:127], v[104:107]
    v_mfma_f32_16x16x32_bf16 v[108:111], a[188:191], v[124:127], v[108:111]
    ds_read_b128 v[116:119], v67 offset:21248
    s_waitcnt lgkmcnt(5)
    v_mfma_f32_16x16x32_bf16 v[100:103], a[32:35], v[128:131], v[100:103]
    v_mfma_f32_16x16x32_bf16 v[104:107], a[112:115], v[128:131], v[104:107]
    v_mfma_f32_16x16x32_bf16 v[108:111], a[192:195], v[128:131], v[108:111]
    ds_read_b128 v[120:123], v68 offset:21248
    s_waitcnt lgkmcnt(5)
    v_mfma_f32_16x16x32_bf16 v[100:103], a[36:39], v[132:135], v[100:103]
    v_mfma_f32_16x16x32_bf16 v[104:107], a[116:119], v[132:135], v[104:107]
    v_mfma_f32_16x16x32_bf16 v[108:111], a[196:199], v[132:135], v[108:111]
    ds_read_b128 v[124:127], v69 offset:21248
    s_waitcnt lgkmcnt(5)
    v_mfma_f32_16x16x32_bf16 v[100:103], a[40:43], v[136:139], v[100:103]
    v_mfma_f32_16x16x32_bf16 v[104:107], a[120:123], v[136:139], v[104:107]
    v_mfma_f32_16x16x32_bf16 v[108:111], a[200:203], v[136:139], v[108:111]
    ds_read_b128 v[128:131], v66 offset:21504
    s_waitcnt lgkmcnt(5)
    v_mfma_f32_16x16x32_bf16 v[100:103], a[44:47], v[140:143], v[100:103]
    v_mfma_f32_16x16x32_bf16 v[104:107], a[124:127], v[140:143], v[104:107]
    v_mfma_f32_16x16x32_bf16 v[108:111], a[204:207], v[140:143], v[108:111]
    ds_read_b128 v[132:135], v67 offset:21504
    s_waitcnt lgkmcnt(5)
    v_mfma_f32_16x16x32_bf16 v[100:103], a[48:51], v[112:115], v[100:103]
    v_mfma_f32_16x16x32_bf16 v[104:107], a[128:131], v[112:115], v[104:107]
    v_mfma_f32_16x16x32_bf16 v[108:111], a[208:211], v[112:115], v[108:111]
    ds_read_b128 v[136:139], v68 offset:21504
    s_waitcnt lgkmcnt(5)
    v_mfma_f32_16x16x32_bf16 v[100:103], a[52:55], v[116:119], v[100:103]
    v_mfma_f32_16x16x32_bf16 v[104:107], a[132:135], v[116:119], v[104:107]
    v_mfma_f32_16x16x32_bf16 v[108:111], a[212:215], v[116:119], v[108:111]
    ds_read_b128 v[140:143], v69 offset:21504
    s_waitcnt lgkmcnt(5)
    v_mfma_f32_16x16x32_bf16 v[100:103], a[56:59], v[120:123], v[100:103]
    v_mfma_f32_16x16x32_bf16 v[104:107], a[136:139], v[120:123], v[104:107]
    v_mfma_f32_16x16x32_bf16 v[108:111], a[216:219], v[120:123], v[108:111]
    s_waitcnt lgkmcnt(4)
    v_mfma_f32_16x16x32_bf16 v[100:103], a[60:63], v[124:127], v[100:103]
    v_mfma_f32_16x16x32_bf16 v[104:107], a[140:143], v[124:127], v[104:107]
    v_mfma_f32_16x16x32_bf16 v[108:111], a[220:223], v[124:127], v[108:111]
    s_waitcnt lgkmcnt(3)
    v_mfma_f32_16x16x32_bf16 v[100:103], a[64:67], v[128:131], v[100:103]
    v_mfma_f32_16x16x32_bf16 v[104:107], a[144:147], v[128:131], v[104:107]
    v_mfma_f32_16x16x32_bf16 v[108:111], a[224:227], v[128:131], v[108:111]
    s_waitcnt lgkmcnt(2)
    v_mfma_f32_16x16x32_bf16 v[100:103], a[68:71], v[132:135], v[100:103]
    v_mfma_f32_16x16x32_bf16 v[104:107], a[148:151], v[132:135], v[104:107]
    v_mfma_f32_16x16x32_bf16 v[108:111], a[228:231], v[132:135], v[108:111]
    s_waitcnt lgkmcnt(1)
    v_mfma_f32_16x16x32_bf16 v[100:103], a[72:75], v[136:139], v[100:103]
    v_mfma_f32_16x16x32_bf16 v[104:107], a[152:155], v[136:139], v[104:107]
    v_mfma_f32_16x16x32_bf16 v[108:111], a[232:235], v[136:139], v[108:111]
    s_waitcnt lgkmcnt(0)
    v_mfma_f32_16x16x32_bf16 v[100:103], a[76:79], v[140:143], v[100:103]
    v_mfma_f32_16x16x32_bf16 v[104:107], a[156:159], v[140:143], v[104:107]
    v_mfma_f32_16x16x32_bf16 v[108:111], a[236:239], v[140:143], v[108:111]
    s_nop 7
    v_cvt_pk_bf16_f32 v152, v88, v89
    v_cvt_pk_bf16_f32 v153, v90, v91
    ds_write_b64 v70, v[152:153] offset:0
    v_cvt_pk_bf16_f32 v154, v92, v93
    v_cvt_pk_bf16_f32 v155, v94, v95
    ds_write_b64 v70, v[154:155] offset:32
    v_cvt_pk_bf16_f32 v156, v96, v97
    v_cvt_pk_bf16_f32 v157, v98, v99
    ds_write_b64 v70, v[156:157] offset:64
    v_cvt_pk_bf16_f32 v158, v100, v101
    v_cvt_pk_bf16_f32 v159, v102, v103
    ds_write_b64 v70, v[158:159] offset:6400
    v_cvt_pk_bf16_f32 v152, v104, v105
    v_cvt_pk_bf16_f32 v153, v106, v107
    ds_write_b64 v70, v[152:153] offset:6432
    v_cvt_pk_bf16_f32 v154, v108, v109
    v_cvt_pk_bf16_f32 v155, v110, v111
    ds_write_b64 v70, v[154:155] offset:6464
    s_cmp_ge_u32 s54, 3
    s_cbranch_scc1 ga_nf_100
    s_waitcnt lgkmcnt(0)
    s_barrier
    ds_read_b128 v[176:179], v71 offset:0
    ds_read_b128 v[180:183], v72 offset:0
    ds_read_b128 v[184:187], v73 offset:0
    s_waitcnt lgkmcnt(0)
    buffer_store_dwordx4 v[176:179], v74, s[60:63], s55 offen sc1
    buffer_store_dwordx4 v[180:183], v75, s[60:63], s55 offen sc1
    buffer_store_dwordx4 v[184:187], v15, s[60:63], s55 offen sc1
    s_add_u32 s55, s55, s56
    s_waitcnt vmcnt(0)
    s_barrier
    s_cmp_lg_u32 s91, 0
    s_cbranch_scc1 ga_nf2_101
    s_add_u32 s64, s58, s54
    s_add_u32 s93, s64, 0
    s_lshl_b32 s93, s93, 8
    v_mov_b32 v254, s93
    v_mov_b32 v255, 1
    s_mov_b64 s[94:95], exec
    s_mov_b64 exec, 1
    buffer_atomic_add v255, v254, s[28:31], 0 offen
    s_mov_b64 exec, s[94:95]
ga_nf2_101:
ga_nf_100:
    s_add_u32 s54, s54, 1
    s_waitcnt vmcnt(3) lgkmcnt(0)
    s_barrier
    s_cmp_lt_u32 s54, 6
    s_cbranch_scc1 ga_ns_102
    s_cmp_lg_u32 s91, 0
    s_cbranch_scc1 ga_ns_102
    s_sub_u32 s64, s54, 3
    s_add_u32 s64, s64, s58
    s_add_u32 s93, s64, 0
    s_lshl_b32 s93, s93, 8
    v_mov_b32 v254, s93
    v_mov_b32 v255, 1
    s_mov_b64 s[94:95], exec
    s_mov_b64 exec, 1
    buffer_atomic_add v255, v254, s[28:31], 0 offen
    s_mov_b64 exec, s[94:95]
ga_ns_102:
    s_cmp_lt_u32 s54, 4
    s_cselect_b32 s64, 0x7f000000, s55
    s_cselect_b32 s65, 0, s56
    s_add_u32 s55, s55, s65
    ds_read_b128 v[112:115], v66 offset:40960
    ds_read_b128 v[116:119], v67 offset:40960
    ds_read_b128 v[120:123], v68 offset:40960
    ds_read_b128 v[124:127], v69 offset:40960
    ds_read_b128 v[128:131], v66 offset:41216
    ds_read_b128 v[132:135], v67 offset:41216
    ds_read_b128 v[176:179], v71 offset:0
    ds_read_b128 v[180:183], v72 offset:0
    ds_read_b128 v[184:187], v73 offset:0
    s_waitcnt lgkmcnt(8)
    v_mfma_f32_16x16x32_bf16 v[88:91], a[0:3], v[112:115], 0
    v_mfma_f32_16x16x32_bf16 v[92:95], a[80:83], v[112:115], 0
    v_mfma_f32_16x16x32_bf16 v[96:99], a[160:163], v[112:115], 0
    ds_read_b128 v[136:139], v68 offset:41216
    s_waitcnt lgkmcnt(8)
    v_mfma_f32_16x16x32_bf16 v[88:91], a[4:7], v[116:119], v[88:91]
    v_mfma_f32_16x16x32_bf16 v[92:95], a[84:87], v[116:119], v[92:95]
    v_mfma_f32_16x16x32_bf16 v[96:99], a[164:167], v[116:119], v[96:99]
    ds_read_b128 v[140:143], v69 offset:41216
    ds_write_b128 v56, v[16:19] offset:0
    s_waitcnt lgkmcnt(9)
    v_mfma_f32_16x16x32_bf16 v[88:91], a[8:11], v[120:123], v[88:91]
    v_mfma_f32_16x16x32_bf16 v[92:95], a[88:91], v[120:123], v[92:95]
    v_mfma_f32_16x16x32_bf16 v[96:99], a[168:171], v[120:123], v[96:99]
    ds_read_b128 v[112:115], v66 offset:41472
    buffer_load_dwordx4 v[16:19], v4, s[40:43], s48 offen
    s_add_u32 s48, s48, 4096
    s_waitcnt lgkmcnt(9)
    v_mfma_f32_16x16x32_bf16 v[88:91], a[12:15], v[124:127], v[88:91]
    v_mfma_f32_16x16x32_bf16 v[92:95], a[92:95], v[124:127], v[92:95]
    v_mfma_f32_16x16x32_bf16 v[96:99], a[172:175], v[124:127], v[96:99]
    ds_read_b128 v[116:119], v67 offset:41472
    ds_write_b128 v57, v[20:23] offset:0
    s_waitcnt lgkmcnt(10)
    v_mfma_f32_16x16x32_bf16 v[88:91], a[16:19], v[128:131], v[88:91]
    v_mfma_f32_16x16x32_bf16 v[92:95], a[96:99], v[128:131], v[92:95]
    v_mfma_f32_16x16x32_bf16 v[96:99], a[176:179], v[128:131], v[96:99]
    ds_read_b128 v[120:123], v68 offset:41472
    buffer_load_dwordx4 v[20:23], v4, s[40:43], s48 offen
    s_add_u32 s48, s48, 4096
    s_waitcnt lgkmcnt(10)
    v_mfma_f32_16x16x32_bf16 v[88:91], a[20:23], v[132:135], v[88:91]
    v_mfma_f32_16x16x32_bf16 v[92:95], a[100:103], v[132:135], v[92:95]
    v_mfma_f32_16x16x32_bf16 v[96:99], a[180:183], v[132:135], v[96:99]
    ds_read_b128 v[124:127], v69 offset:41472
    ds_write_b128 v58, v[24:27] offset:0
    s_waitcnt lgkmcnt(8)
    v_mfma_f32_16x16x32_bf16 v[88:91], a[24:27], v[136:139], v[88:91]
    v_mfma_f32_16x16x32_bf16 v[92:95], a[104:107], v[136:139], v[92:95]
    v_mfma_f32_16x16x32_bf16 v[96:99], a[184:187], v[136:139], v[96:99]
    ds_read_b128 v[128:131], v66 offset:41728
    buffer_load_dwordx4 v[24:27], v4, s[40:43], s48 offen
    s_add_u32 s48, s48, 4096
    s_waitcnt lgkmcnt(8)
    v_mfma_f32_16x16x32_bf16 v[88:91], a[28:31], v[140:143], v[88:91]
    v_mfma_f32_16x16x32_bf16 v[92:95], a[108:111], v[140:143], v[92:95]
    v_mfma_f32_16x16x32_bf16 v[96:99], a[188:191], v[140:143], v[96:99]
    ds_read_b128 v[132:135], v67 offset:41728
    ds_write_b128 v59, v[28:31] offset:0
    s_waitcnt lgkmcnt(8)
    v_mfma_f32_16x16x32_bf16 v[88:91], a[32:35], v[112:115], v[88:91]
    v_mfma_f32_16x16x32_bf16 v[92:95], a[112:115], v[112:115], v[92:95]
    v_mfma_f32_16x16x32_bf16 v[96:99], a[192:195], v[112:115], v[96:99]
    ds_read_b128 v[136:139], v68 offset:41728
    buffer_load_dwordx4 v[28:31], v4, s[40:43], s48 offen
    s_add_u32 s48, s48, 4096
    s_waitcnt lgkmcnt(8)
    v_mfma_f32_16x16x32_bf16 v[88:91], a[36:39], v[116:119], v[88:91]
    v_mfma_f32_16x16x32_bf16 v[92:95], a[116:119], v[116:119], v[92:95]
    v_mfma_f32_16x16x32_bf16 v[96:99], a[196:199], v[116:119], v[96:99]
    ds_read_b128 v[140:143], v69 offset:41728
    ds_write_b128 v60, v[32:35] offset:0
    s_waitcnt lgkmcnt(8)
    v_mfma_f32_16x16x32_bf16 v[88:91], a[40:43], v[120:123], v[88:91]
    v_mfma_f32_16x16x32_bf16 v[92:95], a[120:123], v[120:123], v[92:95]
    v_mfma_f32_16x16x32_bf16 v[96:99], a[200:203], v[120:123], v[96:99]
    ds_read_b128 v[112:115], v66 offset:41984
    buffer_load_dwordx4 v[32:35], v4, s[40:43], s48 offen
    s_add_u32 s48, s48, 4096
    s_waitcnt lgkmcnt(8)
    v_mfma_f32_16x16x32_bf16 v[88:91], a[44:47], v[124:127], v[88:91]
    v_mfma_f32_16x16x32_bf16 v[92:95], a[124:127], v[124:127], v[92:95]
    v_mfma_f32_16x16x32_bf16 v[96:99], a[204:207], v[124:127], v[96:99]
    ds_read_b128 v[116:119], v67 offset:41984
    ds_write_b128 v61, v[36:39] offset:0
    s_waitcnt lgkmcnt(8)
    v_mfma_f32_16x16x32_bf16 v[88:91], a[48:51], v[128:131], v[88:91]
    v_mfma_f32_16x16x32_bf16 v[92:95], a[128:131], v[128:131], v[92:95]
    v_mfma_f32_16x16x32_bf16 v[96:99], a[208:211], v[128:131], v[96:99]
    ds_read_b128 v[120:123], v68 offset:41984
    buffer_load_dwordx4 v[36:39], v4, s[40:43], s48 offen
    s_add_u32 s48, s48, 4096
    s_waitcnt lgkmcnt(8)
    v_mfma_f32_16x16x32_bf16 v[88:91], a[52:55], v[132:135], v[88:91]
    v_mfma_f32_16x16x32_bf16 v[92:95], a[132:135], v[132:135], v[92:95]
    v_mfma_f32_16x16x32_bf16 v[96:99], a[212:215], v[132:135], v[96:99]
    ds_read_b128 v[124:127], v69 offset:41984
    ds_write_b128 v62, v[40:43] offset:0
    s_waitcnt lgkmcnt(8)
    v_mfma_f32_16x16x32_bf16 v[88:91], a[56:59], v[136:139], v[88:91]
    v_mfma_f32_16x16x32_bf16 v[92:95], a[136:139], v[136:139], v[92:95]
    v_mfma_f32_16x16x32_bf16 v[96:99], a[216:219], v[136:139], v[96:99]
    ds_read_b128 v[128:131], v66 offset:61440
    buffer_load_dwordx4 v[40:43], v4, s[40:43], s48 offen
    s_add_u32 s48, s48, 4096
    s_waitcnt lgkmcnt(8)
    v_mfma_f32_16x16x32_bf16 v[88:91], a[60:63], v[140:143], v[88:91]
    v_mfma_f32_16x16x32_bf16 v[92:95], a[140:143], v[140:143], v[92:95]
    v_mfma_f32_16x16x32_bf16 v[96:99], a[220:223], v[140:143], v[96:99]
    ds_read_b128 v[132:135], v67 offset:61440
    ds_write_b128 v63, v[44:47] offset:0
    s_waitcnt lgkmcnt(8)
    v_mfma_f32_16x16x32_bf16 v[88:91], a[64:67], v[112:115], v[88:91]
    v_mfma_f32_16x16x32_bf16 v[92:95], a[144:147], v[112:115], v[92:95]
    v_mfma_f32_16x16x32_bf16 v[96:99], a[224:227], v[112:115], v[96:99]
    ds_read_b128 v[136:139], v68 offset:61440
    buffer_load_dwordx4 v[44:47], v4, s[40:43], s48 offen
    s_add_u32 s48, s48, 4096
    s_waitcnt lgkmcnt(8)
    v_mfma_f32_16x16x32_bf16 v[88:91], a[68:71], v[116:119], v[88:91]
    v_mfma_f32_16x16x32_bf16 v[92:95], a[148:151], v[116:119], v[92:95]
    v_mfma_f32_16x16x32_bf16 v[96:99], a[228:231], v[116:119], v[96:99]
    ds_read_b128 v[140:143], v69 offset:61440
    ds_write_b128 v64, v[48:51] offset:0
    s_waitcnt lgkmcnt(8)
    v_mfma_f32_16x16x32_bf16 v[88:91], a[72:75], v[120:123], v[88:91]
    v_mfma_f32_16x16x32_bf16 v[92:95], a[152:155], v[120:123], v[92:95]
    v_mfma_f32_16x16x32_bf16 v[96:99], a[232:235], v[120:123], v[96:99]
    ds_read_b128 v[112:115], v66 offset:61696
    buffer_load_dwordx4 v[48:51], v4, s[40:43], s48 offen
    s_add_u32 s48, s48, 4096
    s_waitcnt lgkmcnt(8)
    v_mfma_f32_16x16x32_bf16 v[88:91], a[76:79], v[124:127], v[88:91]
    v_mfma_f32_16x16x32_bf16 v[92:95], a[156:159], v[124:127], v[92:95]
    v_mfma_f32_16x16x32_bf16 v[96:99], a[236:239], v[124:127], v[96:99]
    ds_read_b128 v[116:119], v67 offset:61696
    ds_write_b128 v65, v[52:55] offset:0
    s_waitcnt lgkmcnt(8)
    v_mfma_f32_16x16x32_bf16 v[100:103], a[0:3], v[128:131], 0
    v_mfma_f32_16x16x32_bf16 v[104:107], a[80:83], v[128:131], 0
    v_mfma_f32_16x16x32_bf16 v[108:111], a[160:163], v[128:131], 0
    ds_read_b128 v[120:123], v68 offset:61696
    buffer_load_dwordx4 v[52:55], v4, s[40:43], s48 offen
    s_add_u32 s48, s48, 4096
    s_waitcnt lgkmcnt(8)
    v_mfma_f32_16x16x32_bf16 v[100:103], a[4:7], v[132:135], v[100:103]
    v_mfma_f32_16x16x32_bf16 v[104:107], a[84:87], v[132:135], v[104:107]
    v_mfma_f32_16x16x32_bf16 v[108:111], a[164:167], v[132:135], v[108:111]
    ds_read_b128 v[124:127], v69 offset:61696
    s_waitcnt lgkmcnt(7)
    v_mfma_f32_16x16x32_bf16 v[100:103], a[8:11], v[136:139], v[100:103]
    v_mfma_f32_16x16x32_bf16 v[104:107], a[88:91], v[136:139], v[104:107]
    v_mfma_f32_16x16x32_bf16 v[108:111], a[168:171], v[136:139], v[108:111]
    ds_read_b128 v[128:131], v66 offset:61952
    buffer_store_dwordx4 v[176:179], v74, s[60:63], s64 offen sc1
    s_waitcnt lgkmcnt(7)
    v_mfma_f32_16x16x32_bf16 v[100:103], a[12:15], v[140:143], v[100:103]
    v_mfma_f32_16x16x32_bf16 v[104:107], a[92:95], v[140:143], v[104:107]
    v_mfma_f32_16x16x32_bf16 v[108:111], a[172:175], v[140:143], v[108:111]
    ds_read_b128 v[132:135], v67 offset:61952
    s_waitcnt lgkmcnt(6)
    v_mfma_f32_16x16x32_bf16 v[100:103], a[16:19], v[112:115], v[100:103]
    v_mfma_f32_16x16x32_bf16 v[104:107], a[96:99], v[112:115], v[104:107]
    v_mfma_f32_16x16x32_bf16 v[108:111], a[176:179], v[112:115], v[108:111]
    ds_read_b128 v[136:139], v68 offset:61952
    buffer_store_dwordx4 v[180:183], v75, s[60:63], s64 offen sc1
    s_waitcnt lgkmcnt(6)
    v_mfma_f32_16x16x32_bf16 v[100:103], a[20:23], v[116:119], v[100:103]
    v_mfma_f32_16x16x32_bf16 v[104:107], a[100:103], v[116:119], v[104:107]
    v_mfma_f32_16x16x32_bf16 v[108:111], a[180:183], v[116:119], v[108:111]
    ds_read_b128 v[140:143], v69 offset:61952
    s_waitcnt lgkmcnt(5)
    v_mfma_f32_16x16x32_bf16 v[100:103], a[24:27], v[120:123], v[100:103]
    v_mfma_f32_16x16x32_bf16 v[104:107], a[104:107], v[120:123], v[104:107]
    v_mfma_f32_16x16x32_bf16 v[108:111], a[184:187], v[120:123], v[108:111]
    ds_read_b128 v[112:115], v66 offset:62208
    buffer_store_dwordx4 v[184:187], v15, s[60:63], s64 offen sc1
    s_waitcnt lgkmcnt(5)
    v_mfma_f32_16x16x32_bf16 v[100:103], a[28:31], v[124:127], v[100:103]
    v_mfma_f32_16x16x32_bf16 v[104:107], a[108:111], v[124:127], v[104:107]
    v_mfma_f32_16x16x32_bf16 v[108:111], a[188:191], v[124:127], v[108:111]
    ds_read_b128 v[116:119], v67 offset:62208
    s_waitcnt lgkmcnt(5)
    v_mfma_f32_16x16x32_bf16 v[100:103], a[32:35], v[128:131], v[100:103]
    v_mfma_f32_16x16x32_bf16 v[104:107], a[112:115], v[128:131], v[104:107]
    v_mfma_f32_16x16x32_bf16 v[108:111], a[192:195], v[128:131], v[108:111]
    ds_read_b128 v[120:123], v68 offset:62208
    s_waitcnt lgkmcnt(5)
    v_mfma_f32_16x16x32_bf16 v[100:103], a[36:39], v[132:135], v[100:103]
    v_mfma_f32_16x16x32_bf16 v[104:107], a[116:119], v[132:135], v[104:107]
    v_mfma_f32_16x16x32_bf16 v[108:111], a[196:199], v[132:135], v[108:111]
    ds_read_b128 v[124:127], v69 offset:62208
    s_waitcnt lgkmcnt(5)
    v_mfma_f32_16x16x32_bf16 v[100:103], a[40:43], v[136:139], v[100:103]
    v_mfma_f32_16x16x32_bf16 v[104:107], a[120:123], v[136:139], v[104:107]
    v_mfma_f32_16x16x32_bf16 v[108:111], a[200:203], v[136:139], v[108:111]
    ds_read_b128 v[128:131], v66 offset:62464
    s_waitcnt lgkmcnt(5)
    v_mfma_f32_16x16x32_bf16 v[100:103], a[44:47], v[140:143], v[100:103]
    v_mfma_f32_16x16x32_bf16 v[104:107], a[124:127], v[140:143], v[104:107]
    v_mfma_f32_16x16x32_bf16 v[108:111], a[204:207], v[140:143], v[108:111]
    ds_read_b128 v[132:135], v67 offset:62464
    s_waitcnt lgkmcnt(5)
    v_mfma_f32_16x16x32_bf16 v[100:103], a[48:51], v[112:115], v[100:103]
    v_mfma_f32_16x16x32_bf16 v[104:107], a[128:131], v[112:115], v[104:107]
    v_mfma_f32_16x16x32_bf16 v[108:111], a[208:211], v[112:115], v[108:111]
    ds_read_b128 v[136:139], v68 offset:62464
    s_waitcnt lgkmcnt(5)
    v_mfma_f32_16x16x32_bf16 v[100:103], a[52:55], v[116:119], v[100:103]
    v_mfma_f32_16x16x32_bf16 v[104:107], a[132:135], v[116:119], v[104:107]
    v_mfma_f32_16x16x32_bf16 v[108:111], a[212:215], v[116:119], v[108:111]
    ds_read_b128 v[140:143], v69 offset:62464
    s_waitcnt lgkmcnt(5)
    v_mfma_f32_16x16x32_bf16 v[100:103], a[56:59], v[120:123], v[100:103]
    v_mfma_f32_16x16x32_bf16 v[104:107], a[136:139], v[120:123], v[104:107]
    v_mfma_f32_16x16x32_bf16 v[108:111], a[216:219], v[120:123], v[108:111]
    s_waitcnt lgkmcnt(4)
    v_mfma_f32_16x16x32_bf16 v[100:103], a[60:63], v[124:127], v[100:103]
    v_mfma_f32_16x16x32_bf16 v[104:107], a[140:143], v[124:127], v[104:107]
    v_mfma_f32_16x16x32_bf16 v[108:111], a[220:223], v[124:127], v[108:111]
    s_waitcnt lgkmcnt(3)
    v_mfma_f32_16x16x32_bf16 v[100:103], a[64:67], v[128:131], v[100:103]
    v_mfma_f32_16x16x32_bf16 v[104:107], a[144:147], v[128:131], v[104:107]
    v_mfma_f32_16x16x32_bf16 v[108:111], a[224:227], v[128:131], v[108:111]
    s_waitcnt lgkmcnt(2)
    v_mfma_f32_16x16x32_bf16 v[100:103], a[68:71], v[132:135], v[100:103]
    v_mfma_f32_16x16x32_bf16 v[104:107], a[148:151], v[132:135], v[104:107]
    v_mfma_f32_16x16x32_bf16 v[108:111], a[228:231], v[132:135], v[108:111]
    s_waitcnt lgkmcnt(1)
    v_mfma_f32_16x16x32_bf16 v[100:103], a[72:75], v[136:139], v[100:103]
    v_mfma_f32_16x16x32_bf16 v[104:107], a[152:155], v[136:139], v[104:107]
    v_mfma_f32_16x16x32_bf16 v[108:111], a[232:235], v[136:139], v[108:111]
    s_waitcnt lgkmcnt(0)
    v_mfma_f32_16x16x32_bf16 v[100:103], a[76:79], v[140:143], v[100:103]
    v_mfma_f32_16x16x32_bf16 v[104:107], a[156:159], v[140:143], v[104:107]
    v_mfma_f32_16x16x32_bf16 v[108:111], a[236:239], v[140:143], v[108:111]
    s_nop 7
    v_cvt_pk_bf16_f32 v152, v88, v89
    v_cvt_pk_bf16_f32 v153, v90, v91
    ds_write_b64 v70, v[152:153] offset:15360
    v_cvt_pk_bf16_f32 v154, v92, v93
    v_cvt_pk_bf16_f32 v155, v94, v95
    ds_write_b64 v70, v[154:155] offset:15392
    v_cvt_pk_bf16_f32 v156, v96, v97
    v_cvt_pk_bf16_f32 v157, v98, v99
    ds_write_b64 v70, v[156:157] offset:15424
    v_cvt_pk_bf16_f32 v158, v100, v101
    v_cvt_pk_bf16_f32 v159, v102, v103
    ds_write_b64 v70, v[158:159] offset:21760
    v_cvt_pk_bf16_f32 v152, v104, v105
    v_cvt_pk_bf16_f32 v153, v106, v107
    ds_write_b64 v70, v[152:153] offset:21792
    v_cvt_pk_bf16_f32 v154, v108, v109
    v_cvt_pk_bf16_f32 v155, v110, v111
    ds_write_b64 v70, v[154:155] offset:21824
    s_cmp_ge_u32 s54, 3
    s_cbranch_scc1 ga_nf_103
    s_waitcnt lgkmcnt(0)
    s_barrier
    ds_read_b128 v[176:179], v71 offset:15360
    ds_read_b128 v[180:183], v72 offset:15360
    ds_read_b128 v[184:187], v73 offset:15360
    s_waitcnt lgkmcnt(0)
    buffer_store_dwordx4 v[176:179], v74, s[60:63], s55 offen sc1
    buffer_store_dwordx4 v[180:183], v75, s[60:63], s55 offen sc1
    buffer_store_dwordx4 v[184:187], v15, s[60:63], s55 offen sc1
    s_add_u32 s55, s55, s56
    s_waitcnt vmcnt(0)
    s_barrier
    s_cmp_lg_u32 s91, 0
    s_cbranch_scc1 ga_nf2_104
    s_add_u32 s64, s58, s54
    s_add_u32 s93, s64, 0
    s_lshl_b32 s93, s93, 8
    v_mov_b32 v254, s93
    v_mov_b32 v255, 1
    s_mov_b64 s[94:95], exec
    s_mov_b64 exec, 1
    buffer_atomic_add v255, v254, s[28:31], 0 offen
    s_mov_b64 exec, s[94:95]
ga_nf2_104:
ga_nf_103:
    s_add_u32 s54, s54, 1
    s_cmp_lt_u32 s54, 64
    s_cbranch_scc1 ga_loop_q_95
    s_branch ga_tail_98
ga_loop_v_96:
    s_waitcnt vmcnt(3) lgkmcnt(0)
    s_barrier
    s_cmp_lt_u32 s54, 6
    s_cbranch_scc1 ga_ns_105
    s_cmp_lg_u32 s91, 0
    s_cbranch_scc1 ga_ns_105
    s_sub_u32 s64, s54, 3
    s_add_u32 s64, s64, s58
    s_add_u32 s93, s64, 0
    s_lshl_b32 s93, s93, 8
    v_mov_b32 v254, s93
    v_mov_b32 v255, 1
    s_mov_b64 s[94:95], exec
    s_mov_b64 exec, 1
    buffer_atomic_add v255, v254, s[28:31], 0 offen
    s_mov_b64 exec, s[94:95]
ga_ns_105:
    s_cmp_lt_u32 s54, 4
    s_cselect_b32 s64, 0x7f000000, s55
    s_cselect_b32 s65, 0, s56
    s_add_u32 s55, s55, s65
    ds_read_b128 v[112:115], v66 offset:0
    ds_read_b128 v[116:119], v67 offset:0
    ds_read_b128 v[120:123], v68 offset:0
    ds_read_b128 v[124:127], v69 offset:0
    ds_read_b128 v[128:131], v66 offset:256
    ds_read_b128 v[132:135], v67 offset:256
    ds_read_b128 v[176:179], v71 offset:15360
    ds_read_b128 v[180:183], v72 offset:15360
    ds_read_b128 v[184:187], v73 offset:15360
    s_waitcnt lgkmcnt(8)
    v_mfma_f32_16x16x32_bf16 v[88:91], v[112:115], a[0:3], 0
    v_mfma_f32_16x16x32_bf16 v[92:95], v[112:115], a[80:83], 0
    v_mfma_f32_16x16x32_bf16 v[96:99], v[112:115], a[160:163], 0
    ds_read_b128 v[136:139], v68 offset:256
    s_waitcnt lgkmcnt(8)
    v_mfma_f32_16x16x32_bf16 v[88:91], v[116:119], a[4:7], v[88:91]
    v_mfma_f32_16x16x32_bf16 v[92:95], v[116:119], a[84:87], v[92:95]
    v_mfma_f32_16x16x32_bf16 v[96:99], v[116:119], a[164:167], v[96:99]
    ds_read_b128 v[140:143], v69 offset:256
    ds_write_b128 v56, v[16:19] offset:40960
    s_waitcnt lgkmcnt(9)
    v_mfma_f32_16x16x32_bf16 v[88:91], v[120:123], a[8:11], v[88:91]
    v_mfma_f32_16x16x32_bf16 v[92:95], v[120:123], a[88:91], v[92:95]
    v_mfma_f32_16x16x32_bf16 v[96:99], v[120:123], a[168:171], v[96:99]
    ds_read_b128 v[112:115], v66 offset:512
    buffer_load_dwordx4 v[16:19], v4, s[40:43], s48 offen
    s_add_u32 s48, s48, 4096
    s_waitcnt lgkmcnt(9)
    v_mfma_f32_16x16x32_bf16 v[88:91], v[124:127], a[12:15], v[88:91]
    v_mfma_f32_16x16x32_bf16 v[92:95], v[124:127], a[92:95], v[92:95]
    v_mfma_f32_16x16x32_bf16 v[96:99], v[124:127], a[172:175], v[96:99]
    ds_read_b128 v[116:119], v67 offset:512
    ds_write_b128 v57, v[20:23] offset:40960
    s_waitcnt lgkmcnt(10)
    v_mfma_f32_16x16x32_bf16 v[88:91], v[128:131], a[16:19], v[88:91]
    v_mfma_f32_16x16x32_bf16 v[92:95], v[128:131], a[96:99], v[92:95]
    v_mfma_f32_16x16x32_bf16 v[96:99], v[128:131], a[176:179], v[96:99]
    ds_read_b128 v[120:123], v68 offset:512
    buffer_load_dwordx4 v[20:23], v4, s[40:43], s48 offen
    s_add_u32 s48, s48, 4096
    s_waitcnt lgkmcnt(10)
    v_mfma_f32_16x16x32_bf16 v[88:91], v[132:135], a[20:23], v[88:91]
    v_mfma_f32_16x16x32_bf16 v[92:95], v[132:135], a[100:103], v[92:95]
    v_mfma_f32_16x16x32_bf16 v[96:99], v[132:135], a[180:183], v[96:99]
    ds_read_b128 v[124:127], v69 offset:512
    ds_write_b128 v58, v[24:27] offset:40960
    s_waitcnt lgkmcnt(8)
    v_mfma_f32_16x16x32_bf16 v[88:91], v[136:139], a[24:27], v[88:91]
    v_mfma_f32_16x16x32_bf16 v[92:95], v[136:139], a[104:107], v[92:95]
    v_mfma_f32_16x16x32_bf16 v[96:99], v[136:139], a[184:187], v[96:99]
    ds_read_b128 v[128:131], v66 offset:768
    buffer_load_dwordx4 v[24:27], v4, s[40:43], s48 offen
    s_add_u32 s48, s48, 4096
    s_waitcnt lgkmcnt(8)
    v_mfma_f32_16x16x32_bf16 v[88:91], v[140:143], a[28:31], v[88:91]
    v_mfma_f32_16x16x32_bf16 v[92:95], v[140:143], a[108:111], v[92:95]
    v_mfma_f32_16x16x32_bf16 v[96:99], v[140:143], a[188:191], v[96:99]
    ds_read_b128 v[132:135], v67 offset:768
    ds_write_b128 v59, v[28:31] offset:40960
    s_waitcnt lgkmcnt(8)
    v_mfma_f32_16x16x32_bf16 v[88:91], v[112:115], a[32:35], v[88:91]
    v_mfma_f32_16x16x32_bf16 v[92:95], v[112:115], a[112:115], v[92:95]
    v_mfma_f32_16x16x32_bf16 v[96:99], v[112:115], a[192:195], v[96:99]
    ds_read_b128 v[136:139], v68 offset:768
    buffer_load_dwordx4 v[28:31], v4, s[40:43], s48 offen
    s_add_u32 s48, s48, 4096
    s_waitcnt lgkmcnt(8)
    v_mfma_f32_16x16x32_bf16 v[88:91], v[116:119], a[36:39], v[88:91]
    v_mfma_f32_16x16x32_bf16 v[92:95], v[116:119], a[116:119], v[92:95]
    v_mfma_f32_16x16x32_bf16 v[96:99], v[116:119], a[196:199], v[96:99]
    ds_read_b128 v[140:143], v69 offset:768
    ds_write_b128 v60, v[32:35] offset:40960
    s_waitcnt lgkmcnt(8)
    v_mfma_f32_16x16x32_bf16 v[88:91], v[120:123], a[40:43], v[88:91]
    v_mfma_f32_16x16x32_bf16 v[92:95], v[120:123], a[120:123], v[92:95]
    v_mfma_f32_16x16x32_bf16 v[96:99], v[120:123], a[200:203], v[96:99]
    ds_read_b128 v[112:115], v66 offset:1024
    buffer_load_dwordx4 v[32:35], v4, s[40:43], s48 offen
    s_add_u32 s48, s48, 4096
    s_waitcnt lgkmcnt(8)
    v_mfma_f32_16x16x32_bf16 v[88:91], v[124:127], a[44:47], v[88:91]
    v_mfma_f32_16x16x32_bf16 v[92:95], v[124:127], a[124:127], v[92:95]
    v_mfma_f32_16x16x32_bf16 v[96:99], v[124:127], a[204:207], v[96:99]
    ds_read_b128 v[116:119], v67 offset:1024
    ds_write_b128 v61, v[36:39] offset:40960
    s_waitcnt lgkmcnt(8)
    v_mfma_f32_16x16x32_bf16 v[88:91], v[128:131], a[48:51], v[88:91]
    v_mfma_f32_16x16x32_bf16 v[92:95], v[128:131], a[128:131], v[92:95]
    v_mfma_f32_16x16x32_bf16 v[96:99], v[128:131], a[208:211], v[96:99]
    ds_read_b128 v[120:123], v68 offset:1024
    buffer_load_dwordx4 v[36:39], v4, s[40:43], s48 offen
    s_add_u32 s48, s48, 4096
    s_waitcnt lgkmcnt(8)
    v_mfma_f32_16x16x32_bf16 v[88:91], v[132:135], a[52:55], v[88:91]
    v_mfma_f32_16x16x32_bf16 v[92:95], v[132:135], a[132:135], v[92:95]
    v_mfma_f32_16x16x32_bf16 v[96:99], v[132:135], a[212:215], v[96:99]
    ds_read_b128 v[124:127], v69 offset:1024
    ds_write_b128 v62, v[40:43] offset:40960
    s_waitcnt lgkmcnt(8)
    v_mfma_f32_16x16x32_bf16 v[88:91], v[136:139], a[56:59], v[88:91]
    v_mfma_f32_16x16x32_bf16 v[92:95], v[136:139], a[136:139], v[92:95]
    v_mfma_f32_16x16x32_bf16 v[96:99], v[136:139], a[216:219], v[96:99]
    ds_read_b128 v[128:131], v66 offset:20480
    buffer_load_dwordx4 v[40:43], v4, s[40:43], s48 offen
    s_add_u32 s48, s48, 4096
    s_waitcnt lgkmcnt(8)
    v_mfma_f32_16x16x32_bf16 v[88:91], v[140:143], a[60:63], v[88:91]
    v_mfma_f32_16x16x32_bf16 v[92:95], v[140:143], a[140:143], v[92:95]
    v_mfma_f32_16x16x32_bf16 v[96:99], v[140:143], a[220:223], v[96:99]
    ds_read_b128 v[132:135], v67 offset:20480
    ds_write_b128 v63, v[44:47] offset:40960
    s_waitcnt lgkmcnt(8)
    v_mfma_f32_16x16x32_bf16 v[88:91], v[112:115], a[64:67], v[88:91]
    v_mfma_f32_16x16x32_bf16 v[92:95], v[112:115], a[144:147], v[92:95]
    v_mfma_f32_16x16x32_bf16 v[96:99], v[112:115], a[224:227], v[96:99]
    ds_read_b128 v[136:139], v68 offset:20480
    buffer_load_dwordx4 v[44:47], v4, s[40:43], s48 offen
    s_add_u32 s48, s48, 4096
    s_waitcnt lgkmcnt(8)
    v_mfma_f32_16x16x32_bf16 v[88:91], v[116:119], a[68:71], v[88:91]
    v_mfma_f32_16x16x32_bf16 v[92:95], v[116:119], a[148:151], v[92:95]
    v_mfma_f32_16x16x32_bf16 v[96:99], v[116:119], a[228:231], v[96:99]
    ds_read_b128 v[140:143], v69 offset:20480
    ds_write_b128 v64, v[48:51] offset:40960
    s_waitcnt lgkmcnt(8)
    v_mfma_f32_16x16x32_bf16 v[88:91], v[120:123], a[72:75], v[88:91]
    v_mfma_f32_16x16x32_bf16 v[92:95], v[120:123], a[152:155], v[92:95]
    v_mfma_f32_16x16x32_bf16 v[96:99], v[120:123], a[232:235], v[96:99]
    ds_read_b128 v[112:115], v66 offset:20736
    buffer_load_dwordx4 v[48:51], v4, s[40:43], s48 offen
    s_add_u32 s48, s48, 4096
    s_waitcnt lgkmcnt(8)
    v_mfma_f32_16x16x32_bf16 v[88:91], v[124:127], a[76:79], v[88:91]
    v_mfma_f32_16x16x32_bf16 v[92:95], v[124:127], a[156:159], v[92:95]
    v_mfma_f32_16x16x32_bf16 v[96:99], v[124:127], a[236:239], v[96:99]
    ds_read_b128 v[116:119], v67 offset:20736
    ds_write_b128 v65, v[52:55] offset:40960
    s_waitcnt lgkmcnt(8)
    v_mfma_f32_16x16x32_bf16 v[100:103], v[128:131], a[0:3], 0
    v_mfma_f32_16x16x32_bf16 v[104:107], v[128:131], a[80:83], 0
    v_mfma_f32_16x16x32_bf16 v[108:111], v[128:131], a[160:163], 0
    ds_read_b128 v[120:123], v68 offset:20736
    buffer_load_dwordx4 v[52:55], v4, s[40:43], s48 offen
    s_add_u32 s48, s48, 4096
    s_waitcnt lgkmcnt(8)
    v_mfma_f32_16x16x32_bf16 v[100:103], v[132:135], a[4:7], v[100:103]
    v_mfma_f32_16x16x32_bf16 v[104:107], v[132:135], a[84:87], v[104:107]
    v_mfma_f32_16x16x32_bf16 v[108:111], v[132:135], a[164:167], v[108:111]
    ds_read_b128 v[124:127], v69 offset:20736
    s_waitcnt lgkmcnt(7)
    v_mfma_f32_16x16x32_bf16 v[100:103], v[136:139], a[8:11], v[100:103]
    v_mfma_f32_16x16x32_bf16 v[104:107], v[136:139], a[88:91], v[104:107]
    v_mfma_f32_16x16x32_bf16 v[108:111], v[136:139], a[168:171], v[108:111]
    ds_read_b128 v[128:131], v66 offset:20992
    buffer_store_dwordx4 v[176:179], v74, s[60:63], s64 offen sc1
    s_waitcnt lgkmcnt(7)
    v_mfma_f32_16x16x32_bf16 v[100:103], v[140:143], a[12:15], v[100:103]
    v_mfma_f32_16x16x32_bf16 v[104:107], v[140:143], a[92:95], v[104:107]
    v_mfma_f32_16x16x32_bf16 v[108:111], v[140:143], a[172:175], v[108:111]
    ds_read_b128 v[132:135], v67 offset:20992
    s_waitcnt lgkmcnt(6)
    v_mfma_f32_16x16x32_bf16 v[100:103], v[112:115], a[16:19], v[100:103]
    v_mfma_f32_16x16x32_bf16 v[104:107], v[112:115], a[96:99], v[104:107]
    v_mfma_f32_16x16x32_bf16 v[108:111], v[112:115], a[176:179], v[108:111]
    ds_read_b128 v[136:139], v68 offset:20992
    buffer_store_dwordx4 v[180:183], v75, s[60:63], s64 offen sc1
    s_waitcnt lgkmcnt(6)
    v_mfma_f32_16x16x32_bf16 v[100:103], v[116:119], a[20:23], v[100:103]
    v_mfma_f32_16x16x32_bf16 v[104:107], v[116:119], a[100:103], v[104:107]
    v_mfma_f32_16x16x32_bf16 v[108:111], v[116:119], a[180:183], v[108:111]
    ds_read_b128 v[140:143], v69 offset:20992
    s_waitcnt lgkmcnt(5)
    v_mfma_f32_16x16x32_bf16 v[100:103], v[120:123], a[24:27], v[100:103]
    v_mfma_f32_16x16x32_bf16 v[104:107], v[120:123], a[104:107], v[104:107]
    v_mfma_f32_16x16x32_bf16 v[108:111], v[120:123], a[184:187], v[108:111]
    ds_read_b128 v[112:115], v66 offset:21248
    buffer_store_dwordx4 v[184:187], v15, s[60:63], s64 offen sc1
    s_waitcnt lgkmcnt(5)
    v_mfma_f32_16x16x32_bf16 v[100:103], v[124:127], a[28:31], v[100:103]
    v_mfma_f32_16x16x32_bf16 v[104:107], v[124:127], a[108:111], v[104:107]
    v_mfma_f32_16x16x32_bf16 v[108:111], v[124:127], a[188:191], v[108:111]
    ds_read_b128 v[116:119], v67 offset:21248
    s_waitcnt lgkmcnt(5)
    v_mfma_f32_16x16x32_bf16 v[100:103], v[128:131], a[32:35], v[100:103]
    v_mfma_f32_16x16x32_bf16 v[104:107], v[128:131], a[112:115], v[104:107]
    v_mfma_f32_16x16x32_bf16 v[108:111], v[128:131], a[192:195], v[108:111]
    ds_read_b128 v[120:123], v68 offset:21248
    s_waitcnt lgkmcnt(5)
    v_mfma_f32_16x16x32_bf16 v[100:103], v[132:135], a[36:39], v[100:103]
    v_mfma_f32_16x16x32_bf16 v[104:107], v[132:135], a[116:119], v[104:107]
    v_mfma_f32_16x16x32_bf16 v[108:111], v[132:135], a[196:199], v[108:111]
    ds_read_b128 v[124:127], v69 offset:21248
    s_waitcnt lgkmcnt(5)
    v_mfma_f32_16x16x32_bf16 v[100:103], v[136:139], a[40:43], v[100:103]
    v_mfma_f32_16x16x32_bf16 v[104:107], v[136:139], a[120:123], v[104:107]
    v_mfma_f32_16x16x32_bf16 v[108:111], v[136:139], a[200:203], v[108:111]
    ds_read_b128 v[128:131], v66 offset:21504
    s_waitcnt lgkmcnt(5)
    v_mfma_f32_16x16x32_bf16 v[100:103], v[140:143], a[44:47], v[100:103]
    v_mfma_f32_16x16x32_bf16 v[104:107], v[140:143], a[124:127], v[104:107]
    v_mfma_f32_16x16x32_bf16 v[108:111], v[140:143], a[204:207], v[108:111]
    ds_read_b128 v[132:135], v67 offset:21504
    s_waitcnt lgkmcnt(5)
    v_mfma_f32_16x16x32_bf16 v[100:103], v[112:115], a[48:51], v[100:103]
    v_mfma_f32_16x16x32_bf16 v[104:107], v[112:115], a[128:131], v[104:107]
    v_mfma_f32_16x16x32_bf16 v[108:111], v[112:115], a[208:211], v[108:111]
    ds_read_b128 v[136:139], v68 offset:21504
    s_waitcnt lgkmcnt(5)
    v_mfma_f32_16x16x32_bf16 v[100:103], v[116:119], a[52:55], v[100:103]
    v_mfma_f32_16x16x32_bf16 v[104:107], v[116:119], a[132:135], v[104:107]
    v_mfma_f32_16x16x32_bf16 v[108:111], v[116:119], a[212:215], v[108:111]
    ds_read_b128 v[140:143], v69 offset:21504
    s_waitcnt lgkmcnt(5)
    v_mfma_f32_16x16x32_bf16 v[100:103], v[120:123], a[56:59], v[100:103]
    v_mfma_f32_16x16x32_bf16 v[104:107], v[120:123], a[136:139], v[104:107]
    v_mfma_f32_16x16x32_bf16 v[108:111], v[120:123], a[216:219], v[108:111]
    s_waitcnt lgkmcnt(4)
    v_mfma_f32_16x16x32_bf16 v[100:103], v[124:127], a[60:63], v[100:103]
    v_mfma_f32_16x16x32_bf16 v[104:107], v[124:127], a[140:143], v[104:107]
    v_mfma_f32_16x16x32_bf16 v[108:111], v[124:127], a[220:223], v[108:111]
    s_waitcnt lgkmcnt(3)
    v_mfma_f32_16x16x32_bf16 v[100:103], v[128:131], a[64:67], v[100:103]
    v_mfma_f32_16x16x32_bf16 v[104:107], v[128:131], a[144:147], v[104:107]
    v_mfma_f32_16x16x32_bf16 v[108:111], v[128:131], a[224:227], v[108:111]
    s_waitcnt lgkmcnt(2)
    v_mfma_f32_16x16x32_bf16 v[100:103], v[132:135], a[68:71], v[100:103]
    v_mfma_f32_16x16x32_bf16 v[104:107], v[132:135], a[148:151], v[104:107]
    v_mfma_f32_16x16x32_bf16 v[108:111], v[132:135], a[228:231], v[108:111]
    s_waitcnt lgkmcnt(1)
    v_mfma_f32_16x16x32_bf16 v[100:103], v[136:139], a[72:75], v[100:103]
    v_mfma_f32_16x16x32_bf16 v[104:107], v[136:139], a[152:155], v[104:107]
    v_mfma_f32_16x16x32_bf16 v[108:111], v[136:139], a[232:235], v[108:111]
    s_waitcnt lgkmcnt(0)
    v_mfma_f32_16x16x32_bf16 v[100:103], v[140:143], a[76:79], v[100:103]
    v_mfma_f32_16x16x32_bf16 v[104:107], v[140:143], a[156:159], v[104:107]
    v_mfma_f32_16x16x32_bf16 v[108:111], v[140:143], a[236:239], v[108:111]
    s_nop 7
    v_cvt_pk_bf16_f32 v152, v88, v89
    v_cvt_pk_bf16_f32 v153, v90, v91
    ds_write_b64 v70, v[152:153] offset:0
    v_cvt_pk_bf16_f32 v154, v92, v93
    v_cvt_pk_bf16_f32 v155, v94, v95
    ds_write_b64 v70, v[154:155] offset:1280
    v_cvt_pk_bf16_f32 v156, v96, v97
    v_cvt_pk_bf16_f32 v157, v98, v99
    ds_write_b64 v70, v[156:157] offset:2560
    v_cvt_pk_bf16_f32 v158, v100, v101
    v_cvt_pk_bf16_f32 v159, v102, v103
    ds_write_b64 v70, v[158:159] offset:32
    v_cvt_pk_bf16_f32 v152, v104, v105
    v_cvt_pk_bf16_f32 v153, v106, v107
    ds_write_b64 v70, v[152:153] offset:1312
    v_cvt_pk_bf16_f32 v154, v108, v109
    v_cvt_pk_bf16_f32 v155, v110, v111
    ds_write_b64 v70, v[154:155] offset:2592
    s_cmp_ge_u32 s54, 3
    s_cbranch_scc1 ga_nf_106
    s_waitcnt lgkmcnt(0)
    s_barrier
    ds_read_b128 v[176:179], v71 offset:0
    ds_read_b128 v[180:183], v72 offset:0
    ds_read_b128 v[184:187], v73 offset:0
    s_waitcnt lgkmcnt(0)
    buffer_store_dwordx4 v[176:179], v74, s[60:63], s55 offen sc1
    buffer_store_dwordx4 v[180:183], v75, s[60:63], s55 offen sc1
    buffer_store_dwordx4 v[184:187], v15, s[60:63], s55 offen sc1
    s_add_u32 s55, s55, s56
    s_waitcnt vmcnt(0)
    s_barrier
    s_cmp_lg_u32 s91, 0
    s_cbranch_scc1 ga_nf2_107
    s_add_u32 s64, s58, s54
    s_add_u32 s93, s64, 0
    s_lshl_b32 s93, s93, 8
    v_mov_b32 v254, s93
    v_mov_b32 v255, 1
    s_mov_b64 s[94:95], exec
    s_mov_b64 exec, 1
    buffer_atomic_add v255, v254, s[28:31], 0 offen
    s_mov_b64 exec, s[94:95]
ga_nf2_107:
ga_nf_106:
    s_add_u32 s54, s54, 1
    s_waitcnt vmcnt(3) lgkmcnt(0)
    s_barrier
    s_cmp_lt_u32 s54, 6
    s_cbranch_scc1 ga_ns_108
    s_cmp_lg_u32 s91, 0
    s_cbranch_scc1 ga_ns_108
    s_sub_u32 s64, s54, 3
    s_add_u32 s64, s64, s58
    s_add_u32 s93, s64, 0
    s_lshl_b32 s93, s93, 8
    v_mov_b32 v254, s93
    v_mov_b32 v255, 1
    s_mov_b64 s[94:95], exec
    s_mov_b64 exec, 1
    buffer_atomic_add v255, v254, s[28:31], 0 offen
    s_mov_b64 exec, s[94:95]
ga_ns_108:
    s_cmp_lt_u32 s54, 4
    s_cselect_b32 s64, 0x7f000000, s55
    s_cselect_b32 s65, 0, s56
    s_add_u32 s55, s55, s65
    ds_read_b128 v[112:115], v66 offset:40960
    ds_read_b128 v[116:119], v67 offset:40960
    ds_read_b128 v[120:123], v68 offset:40960
    ds_read_b128 v[124:127], v69 offset:40960
    ds_read_b128 v[128:131], v66 offset:41216
    ds_read_b128 v[132:135], v67 offset:41216
    ds_read_b128 v[176:179], v71 offset:0
    ds_read_b128 v[180:183], v72 offset:0
    ds_read_b128 v[184:187], v73 offset:0
    s_waitcnt lgkmcnt(8)
    v_mfma_f32_16x16x32_bf16 v[88:91], v[112:115], a[0:3], 0
    v_mfma_f32_16x16x32_bf16 v[92:95], v[112:115], a[80:83], 0
    v_mfma_f32_16x16x32_bf16 v[96:99], v[112:115], a[160:163], 0
    ds_read_b128 v[136:139], v68 offset:41216
    s_waitcnt lgkmcnt(8)
    v_mfma_f32_16x16x32_bf16 v[88:91], v[116:119], a[4:7], v[88:91]
    v_mfma_f32_16x16x32_bf16 v[92:95], v[116:119], a[84:87], v[92:95]
    v_mfma_f32_16x16x32_bf16 v[96:99], v[116:119], a[164:167], v[96:99]
    ds_read_b128 v[140:143], v69 offset:41216
    ds_write_b128 v56, v[16:19] offset:0
    s_waitcnt lgkmcnt(9)
    v_mfma_f32_16x16x32_bf16 v[88:91], v[120:123], a[8:11], v[88:91]
    v_mfma_f32_16x16x32_bf16 v[92:95], v[120:123], a[88:91], v[92:95]
    v_mfma_f32_16x16x32_bf16 v[96:99], v[120:123], a[168:171], v[96:99]
    ds_read_b128 v[112:115], v66 offset:41472
    buffer_load_dwordx4 v[16:19], v4, s[40:43], s48 offen
    s_add_u32 s48, s48, 4096
    s_waitcnt lgkmcnt(9)
    v_mfma_f32_16x16x32_bf16 v[88:91], v[124:127], a[12:15], v[88:91]
    v_mfma_f32_16x16x32_bf16 v[92:95], v[124:127], a[92:95], v[92:95]
    v_mfma_f32_16x16x32_bf16 v[96:99], v[124:127], a[172:175], v[96:99]
    ds_read_b128 v[116:119], v67 offset:41472
    ds_write_b128 v57, v[20:23] offset:0
    s_waitcnt lgkmcnt(10)
    v_mfma_f32_16x16x32_bf16 v[88:91], v[128:131], a[16:19], v[88:91]
    v_mfma_f32_16x16x32_bf16 v[92:95], v[128:131], a[96:99], v[92:95]
    v_mfma_f32_16x16x32_bf16 v[96:99], v[128:131], a[176:179], v[96:99]
    ds_read_b128 v[120:123], v68 offset:41472
    buffer_load_dwordx4 v[20:23], v4, s[40:43], s48 offen
    s_add_u32 s48, s48, 4096
    s_waitcnt lgkmcnt(10)
    v_mfma_f32_16x16x32_bf16 v[88:91], v[132:135], a[20:23], v[88:91]
    v_mfma_f32_16x16x32_bf16 v[92:95], v[132:135], a[100:103], v[92:95]
    v_mfma_f32_16x16x32_bf16 v[96:99], v[132:135], a[180:183], v[96:99]
    ds_read_b128 v[124:127], v69 offset:41472
    ds_write_b128 v58, v[24:27] offset:0
    s_waitcnt lgkmcnt(8)
    v_mfma_f32_16x16x32_bf16 v[88:91], v[136:139], a[24:27], v[88:91]
    v_mfma_f32_16x16x32_bf16 v[92:95], v[136:139], a[104:107], v[92:95]
    v_mfma_f32_16x16x32_bf16 v[96:99], v[136:139], a[184:187], v[96:99]
    ds_read_b128 v[128:131], v66 offset:41728
    buffer_load_dwordx4 v[24:27], v4, s[40:43], s48 offen
    s_add_u32 s48, s48, 4096
    s_waitcnt lgkmcnt(8)
    v_mfma_f32_16x16x32_bf16 v[88:91], v[140:143], a[28:31], v[88:91]
    v_mfma_f32_16x16x32_bf16 v[92:95], v[140:143], a[108:111], v[92:95]
    v_mfma_f32_16x16x32_bf16 v[96:99], v[140:143], a[188:191], v[96:99]
    ds_read_b128 v[132:135], v67 offset:41728
    ds_write_b128 v59, v[28:31] offset:0
    s_waitcnt lgkmcnt(8)
    v_mfma_f32_16x16x32_bf16 v[88:91], v[112:115], a[32:35], v[88:91]
    v_mfma_f32_16x16x32_bf16 v[92:95], v[112:115], a[112:115], v[92:95]
    v_mfma_f32_16x16x32_bf16 v[96:99], v[112:115], a[192:195], v[96:99]
    ds_read_b128 v[136:139], v68 offset:41728
    buffer_load_dwordx4 v[28:31], v4, s[40:43], s48 offen
    s_add_u32 s48, s48, 4096
    s_waitcnt lgkmcnt(8)
    v_mfma_f32_16x16x32_bf16 v[88:91], v[116:119], a[36:39], v[88:91]
    v_mfma_f32_16x16x32_bf16 v[92:95], v[116:119], a[116:119], v[92:95]
    v_mfma_f32_16x16x32_bf16 v[96:99], v[116:119], a[196:199], v[96:99]
    ds_read_b128 v[140:143], v69 offset:41728
    ds_write_b128 v60, v[32:35] offset:0
    s_waitcnt lgkmcnt(8)
    v_mfma_f32_16x16x32_bf16 v[88:91], v[120:123], a[40:43], v[88:91]
    v_mfma_f32_16x16x32_bf16 v[92:95], v[120:123], a[120:123], v[92:95]
    v_mfma_f32_16x16x32_bf16 v[96:99], v[120:123], a[200:203], v[96:99]
    ds_read_b128 v[112:115], v66 offset:41984
    buffer_load_dwordx4 v[32:35], v4, s[40:43], s48 offen
    s_add_u32 s48, s48, 4096
    s_waitcnt lgkmcnt(8)
    v_mfma_f32_16x16x32_bf16 v[88:91], v[124:127], a[44:47], v[88:91]
    v_mfma_f32_16x16x32_bf16 v[92:95], v[124:127], a[124:127], v[92:95]
    v_mfma_f32_16x16x32_bf16 v[96:99], v[124:127], a[204:207], v[96:99]
    ds_read_b128 v[116:119], v67 offset:41984
    ds_write_b128 v61, v[36:39] offset:0
    s_waitcnt lgkmcnt(8)
    v_mfma_f32_16x16x32_bf16 v[88:91], v[128:131], a[48:51], v[88:91]
    v_mfma_f32_16x16x32_bf16 v[92:95], v[128:131], a[128:131], v[92:95]
    v_mfma_f32_16x16x32_bf16 v[96:99], v[128:131], a[208:211], v[96:99]
    ds_read_b128 v[120:123], v68 offset:41984
    buffer_load_dwordx4 v[36:39], v4, s[40:43], s48 offen
    s_add_u32 s48, s48, 4096
    s_waitcnt lgkmcnt(8)
    v_mfma_f32_16x16x32_bf16 v[88:91], v[132:135], a[52:55], v[88:91]
    v_mfma_f32_16x16x32_bf16 v[92:95], v[132:135], a[132:135], v[92:95]
    v_mfma_f32_16x16x32_bf16 v[96:99], v[132:135], a[212:215], v[96:99]
    ds_read_b128 v[124:127], v69 offset:41984
    ds_write_b128 v62, v[40:43] offset:0
    s_waitcnt lgkmcnt(8)
    v_mfma_f32_16x16x32_bf16 v[88:91], v[136:139], a[56:59], v[88:91]
    v_mfma_f32_16x16x32_bf16 v[92:95], v[136:139], a[136:139], v[92:95]
    v_mfma_f32_16x16x32_bf16 v[96:99], v[136:139], a[216:219], v[96:99]
    ds_read_b128 v[128:131], v66 offset:61440
    buffer_load_dwordx4 v[40:43], v4, s[40:43], s48 offen
    s_add_u32 s48, s48, 4096
    s_waitcnt lgkmcnt(8)
    v_mfma_f32_16x16x32_bf16 v[88:91], v[140:143], a[60:63], v[88:91]
    v_mfma_f32_16x16x32_bf16 v[92:95], v[140:143], a[140:143], v[92:95]
    v_mfma_f32_16x16x32_bf16 v[96:99], v[140:143], a[220:223], v[96:99]
    ds_read_b128 v[132:135], v67 offset:61440
    ds_write_b128 v63, v[44:47] offset:0
    s_waitcnt lgkmcnt(8)
    v_mfma_f32_16x16x32_bf16 v[88:91], v[112:115], a[64:67], v[88:91]
    v_mfma_f32_16x16x32_bf16 v[92:95], v[112:115], a[144:147], v[92:95]
    v_mfma_f32_16x16x32_bf16 v[96:99], v[112:115], a[224:227], v[96:99]
    ds_read_b128 v[136:139], v68 offset:61440
    buffer_load_dwordx4 v[44:47], v4, s[40:43], s48 offen
    s_add_u32 s48, s48, 4096
    s_waitcnt lgkmcnt(8)
    v_mfma_f32_16x16x32_bf16 v[88:91], v[116:119], a[68:71], v[88:91]
    v_mfma_f32_16x16x32_bf16 v[92:95], v[116:119], a[148:151], v[92:95]
    v_mfma_f32_16x16x32_bf16 v[96:99], v[116:119], a[228:231], v[96:99]
    ds_read_b128 v[140:143], v69 offset:61440
    ds_write_b128 v64, v[48:51] offset:0
    s_waitcnt lgkmcnt(8)
    v_mfma_f32_16x16x32_bf16 v[88:91], v[120:123], a[72:75], v[88:91]
    v_mfma_f32_16x16x32_bf16 v[92:95], v[120:123], a[152:155], v[92:95]
    v_mfma_f32_16x16x32_bf16 v[96:99], v[120:123], a[232:235], v[96:99]
    ds_read_b128 v[112:115], v66 offset:61696
    buffer_load_dwordx4 v[48:51], v4, s[40:43], s48 offen
    s_add_u32 s48, s48, 4096
    s_waitcnt lgkmcnt(8)
    v_mfma_f32_16x16x32_bf16 v[88:91], v[124:127], a[76:79], v[88:91]
    v_mfma_f32_16x16x32_bf16 v[92:95], v[124:127], a[156:159], v[92:95]
    v_mfma_f32_16x16x32_bf16 v[96:99], v[124:127], a[236:239], v[96:99]
    ds_read_b128 v[116:119], v67 offset:61696
    ds_write_b128 v65, v[52:55] offset:0
    s_waitcnt lgkmcnt(8)
    v_mfma_f32_16x16x32_bf16 v[100:103], v[128:131], a[0:3], 0
    v_mfma_f32_16x16x32_bf16 v[104:107], v[128:131], a[80:83], 0
    v_mfma_f32_16x16x32_bf16 v[108:111], v[128:131], a[160:163], 0
    ds_read_b128 v[120:123], v68 offset:61696
    buffer_load_dwordx4 v[52:55], v4, s[40:43], s48 offen
    s_add_u32 s48, s48, 4096
    s_waitcnt lgkmcnt(8)
    v_mfma_f32_16x16x32_bf16 v[100:103], v[132:135], a[4:7], v[100:103]
    v_mfma_f32_16x16x32_bf16 v[104:107], v[132:135], a[84:87], v[104:107]
    v_mfma_f32_16x16x32_bf16 v[108:111], v[132:135], a[164:167], v[108:111]
    ds_read_b128 v[124:127], v69 offset:61696
    s_waitcnt lgkmcnt(7)
    v_mfma_f32_16x16x32_bf16 v[100:103], v[136:139], a[8:11], v[100:103]
    v_mfma_f32_16x16x32_bf16 v[104:107], v[136:139], a[88:91], v[104:107]
    v_mfma_f32_16x16x32_bf16 v[108:111], v[136:139], a[168:171], v[108:111]
    ds_read_b128 v[128:131], v66 offset:61952
    buffer_store_dwordx4 v[176:179], v74, s[60:63], s64 offen sc1
    s_waitcnt lgkmcnt(7)
    v_mfma_f32_16x16x32_bf16 v[100:103], v[140:143], a[12:15], v[100:103]
    v_mfma_f32_16x16x32_bf16 v[104:107], v[140:143], a[92:95], v[104:107]
    v_mfma_f32_16x16x32_bf16 v[108:111], v[140:143], a[172:175], v[108:111]
    ds_read_b128 v[132:135], v67 offset:61952
    s_waitcnt lgkmcnt(6)
    v_mfma_f32_16x16x32_bf16 v[100:103], v[112:115], a[16:19], v[100:103]
    v_mfma_f32_16x16x32_bf16 v[104:107], v[112:115], a[96:99], v[104:107]
    v_mfma_f32_16x16x32_bf16 v[108:111], v[112:115], a[176:179], v[108:111]
    ds_read_b128 v[136:139], v68 offset:61952
    buffer_store_dwordx4 v[180:183], v75, s[60:63], s64 offen sc1
    s_waitcnt lgkmcnt(6)
    v_mfma_f32_16x16x32_bf16 v[100:103], v[116:119], a[20:23], v[100:103]
    v_mfma_f32_16x16x32_bf16 v[104:107], v[116:119], a[100:103], v[104:107]
    v_mfma_f32_16x16x32_bf16 v[108:111], v[116:119], a[180:183], v[108:111]
    ds_read_b128 v[140:143], v69 offset:61952
    s_waitcnt lgkmcnt(5)
    v_mfma_f32_16x16x32_bf16 v[100:103], v[120:123], a[24:27], v[100:103]
    v_mfma_f32_16x16x32_bf16 v[104:107], v[120:123], a[104:107], v[104:107]
    v_mfma_f32_16x16x32_bf16 v[108:111], v[120:123], a[184:187], v[108:111]
    ds_read_b128 v[112:115], v66 offset:62208
    buffer_store_dwordx4 v[184:187], v15, s[60:63], s64 offen sc1
    s_waitcnt lgkmcnt(5)
    v_mfma_f32_16x16x32_bf16 v[100:103], v[124:127], a[28:31], v[100:103]
    v_mfma_f32_16x16x32_bf16 v[104:107], v[124:127], a[108:111], v[104:107]
    v_mfma_f32_16x16x32_bf16 v[108:111], v[124:127], a[188:191], v[108:111]
    ds_read_b128 v[116:119], v67 offset:62208
    s_waitcnt lgkmcnt(5)
    v_mfma_f32_16x16x32_bf16 v[100:103], v[128:131], a[32:35], v[100:103]
    v_mfma_f32_16x16x32_bf16 v[104:107], v[128:131], a[112:115], v[104:107]
    v_mfma_f32_16x16x32_bf16 v[108:111], v[128:131], a[192:195], v[108:111]
    ds_read_b128 v[120:123], v68 offset:62208
    s_waitcnt lgkmcnt(5)
    v_mfma_f32_16x16x32_bf16 v[100:103], v[132:135], a[36:39], v[100:103]
    v_mfma_f32_16x16x32_bf16 v[104:107], v[132:135], a[116:119], v[104:107]
    v_mfma_f32_16x16x32_bf16 v[108:111], v[132:135], a[196:199], v[108:111]
    ds_read_b128 v[124:127], v69 offset:62208
    s_waitcnt lgkmcnt(5)
    v_mfma_f32_16x16x32_bf16 v[100:103], v[136:139], a[40:43], v[100:103]
    v_mfma_f32_16x16x32_bf16 v[104:107], v[136:139], a[120:123], v[104:107]
    v_mfma_f32_16x16x32_bf16 v[108:111], v[136:139], a[200:203], v[108:111]
    ds_read_b128 v[128:131], v66 offset:62464
    s_waitcnt lgkmcnt(5)
    v_mfma_f32_16x16x32_bf16 v[100:103], v[140:143], a[44:47], v[100:103]
    v_mfma_f32_16x16x32_bf16 v[104:107], v[140:143], a[124:127], v[104:107]
    v_mfma_f32_16x16x32_bf16 v[108:111], v[140:143], a[204:207], v[108:111]
    ds_read_b128 v[132:135], v67 offset:62464
    s_waitcnt lgkmcnt(5)
    v_mfma_f32_16x16x32_bf16 v[100:103], v[112:115], a[48:51], v[100:103]
    v_mfma_f32_16x16x32_bf16 v[104:107], v[112:115], a[128:131], v[104:107]
    v_mfma_f32_16x16x32_bf16 v[108:111], v[112:115], a[208:211], v[108:111]
    ds_read_b128 v[136:139], v68 offset:62464
    s_waitcnt lgkmcnt(5)
    v_mfma_f32_16x16x32_bf16 v[100:103], v[116:119], a[52:55], v[100:103]
    v_mfma_f32_16x16x32_bf16 v[104:107], v[116:119], a[132:135], v[104:107]
    v_mfma_f32_16x16x32_bf16 v[108:111], v[116:119], a[212:215], v[108:111]
    ds_read_b128 v[140:143], v69 offset:62464
    s_waitcnt lgkmcnt(5)
    v_mfma_f32_16x16x32_bf16 v[100:103], v[120:123], a[56:59], v[100:103]
    v_mfma_f32_16x16x32_bf16 v[104:107], v[120:123], a[136:139], v[104:107]
    v_mfma_f32_16x16x32_bf16 v[108:111], v[120:123], a[216:219], v[108:111]
    s_waitcnt lgkmcnt(4)
    v_mfma_f32_16x16x32_bf16 v[100:103], v[124:127], a[60:63], v[100:103]
    v_mfma_f32_16x16x32_bf16 v[104:107], v[124:127], a[140:143], v[104:107]
    v_mfma_f32_16x16x32_bf16 v[108:111], v[124:127], a[220:223], v[108:111]
    s_waitcnt lgkmcnt(3)
    v_mfma_f32_16x16x32_bf16 v[100:103], v[128:131], a[64:67], v[100:103]
    v_mfma_f32_16x16x32_bf16 v[104:107], v[128:131], a[144:147], v[104:107]
    v_mfma_f32_16x16x32_bf16 v[108:111], v[128:131], a[224:227], v[108:111]
    s_waitcnt lgkmcnt(2)
    v_mfma_f32_16x16x32_bf16 v[100:103], v[132:135], a[68:71], v[100:103]
    v_mfma_f32_16x16x32_bf16 v[104:107], v[132:135], a[148:151], v[104:107]
    v_mfma_f32_16x16x32_bf16 v[108:111], v[132:135], a[228:231], v[108:111]
    s_waitcnt lgkmcnt(1)
    v_mfma_f32_16x16x32_bf16 v[100:103], v[136:139], a[72:75], v[100:103]
    v_mfma_f32_16x16x32_bf16 v[104:107], v[136:139], a[152:155], v[104:107]
    v_mfma_f32_16x16x32_bf16 v[108:111], v[136:139], a[232:235], v[108:111]
    s_waitcnt lgkmcnt(0)
    v_mfma_f32_16x16x32_bf16 v[100:103], v[140:143], a[76:79], v[100:103]
    v_mfma_f32_16x16x32_bf16 v[104:107], v[140:143], a[156:159], v[104:107]
    v_mfma_f32_16x16x32_bf16 v[108:111], v[140:143], a[236:239], v[108:111]
    s_nop 7
    v_cvt_pk_bf16_f32 v152, v88, v89
    v_cvt_pk_bf16_f32 v153, v90, v91
    ds_write_b64 v70, v[152:153] offset:15360
    v_cvt_pk_bf16_f32 v154, v92, v93
    v_cvt_pk_bf16_f32 v155, v94, v95
    ds_write_b64 v70, v[154:155] offset:16640
    v_cvt_pk_bf16_f32 v156, v96, v97
    v_cvt_pk_bf16_f32 v157, v98, v99
    ds_write_b64 v70, v[156:157] offset:17920
    v_cvt_pk_bf16_f32 v158, v100, v101
    v_cvt_pk_bf16_f32 v159, v102, v103
    ds_write_b64 v70, v[158:159] offset:15392
    v_cvt_pk_bf16_f32 v152, v104, v105
    v_cvt_pk_bf16_f32 v153, v106, v107
    ds_write_b64 v70, v[152:153] offset:16672
    v_cvt_pk_bf16_f32 v154, v108, v109
    v_cvt_pk_bf16_f32 v155, v110, v111
    ds_write_b64 v70, v[154:155] offset:17952
    s_cmp_ge_u32 s54, 3
    s_cbranch_scc1 ga_nf_109
    s_waitcnt lgkmcnt(0)
    s_barrier
    ds_read_b128 v[176:179], v71 offset:15360
    ds_read_b128 v[180:183], v72 offset:15360
    ds_read_b128 v[184:187], v73 offset:15360
    s_waitcnt lgkmcnt(0)
    buffer_store_dwordx4 v[176:179], v74, s[60:63], s55 offen sc1
    buffer_store_dwordx4 v[180:183], v75, s[60:63], s55 offen sc1
    buffer_store_dwordx4 v[184:187], v15, s[60:63], s55 offen sc1
    s_add_u32 s55, s55, s56
    s_waitcnt vmcnt(0)
    s_barrier
    s_cmp_lg_u32 s91, 0
    s_cbranch_scc1 ga_nf2_110
    s_add_u32 s64, s58, s54
    s_add_u32 s93, s64, 0
    s_lshl_b32 s93, s93, 8
    v_mov_b32 v254, s93
    v_mov_b32 v255, 1
    s_mov_b64 s[94:95], exec
    s_mov_b64 exec, 1
    buffer_atomic_add v255, v254, s[28:31], 0 offen
    s_mov_b64 exec, s[94:95]
ga_nf2_110:
ga_nf_109:
    s_add_u32 s54, s54, 1
    s_cmp_lt_u32 s54, 64
    s_cbranch_scc1 ga_loop_v_96
    s_branch ga_tail_98
ga_loop_h_97:
    s_waitcnt vmcnt(3) lgkmcnt(0)
    s_barrier
    s_cmp_lt_u32 s54, 6
    s_cbranch_scc1 ga_ns_111
    s_cmp_lg_u32 s91, 0
    s_cbranch_scc1 ga_ns_111
    s_sub_u32 s64, s54, 3
    s_add_u32 s64, s64, s58
    s_add_u32 s93, s64, 0
    s_lshl_b32 s93, s93, 8
    v_mov_b32 v254, s93
    v_mov_b32 v255, 1
    s_mov_b64 s[94:95], exec
    s_mov_b64 exec, 1
    buffer_atomic_add v255, v254, s[28:31], 0 offen
    s_mov_b64 exec, s[94:95]
ga_ns_111:
    s_cmp_lt_u32 s54, 4
    s_cselect_b32 s64, 0x7f000000, s55
    s_cselect_b32 s65, 0, s56
    s_add_u32 s55, s55, s65
    ds_read_b128 v[112:115], v66 offset:0
    ds_read_b128 v[116:119], v67 offset:0
    ds_read_b128 v[120:123], v68 offset:0
    ds_read_b128 v[124:127], v69 offset:0
    ds_read_b128 v[128:131], v66 offset:256
    ds_read_b128 v[132:135], v67 offset:256
    ds_read_b128 v[176:179], v71 offset:15360
    ds_read_b128 v[180:183], v72 offset:15360
    ds_read_b128 v[184:187], v73 offset:15360
    s_waitcnt lgkmcnt(8)
    v_mfma_f32_16x16x32_bf16 v[88:91], a[0:3], v[112:115], 0
    v_mfma_f32_16x16x32_bf16 v[92:95], a[80:83], v[112:115], 0
    v_mfma_f32_16x16x32_bf16 v[96:99], a[160:163], v[112:115], 0
    ds_read_b128 v[136:139], v68 offset:256
    s_waitcnt lgkmcnt(8)
    v_mfma_f32_16x16x32_bf16 v[88:91], a[4:7], v[116:119], v[88:91]
    v_mfma_f32_16x16x32_bf16 v[92:95], a[84:87], v[116:119], v[92:95]
    v_mfma_f32_16x16x32_bf16 v[96:99], a[164:167], v[116:119], v[96:99]
    ds_read_b128 v[140:143], v69 offset:256
    ds_write_b128 v56, v[16:19] offset:40960
    s_waitcnt lgkmcnt(9)
    v_mfma_f32_16x16x32_bf16 v[88:91], a[8:11], v[120:123], v[88:91]
    v_mfma_f32_16x16x32_bf16 v[92:95], a[88:91], v[120:123], v[92:95]
    v_mfma_f32_16x16x32_bf16 v[96:99], a[168:171], v[120:123], v[96:99]
    ds_read_b128 v[112:115], v66 offset:512
    buffer_load_dwordx4 v[16:19], v4, s[40:43], s48 offen
    s_add_u32 s48, s48, 4096
    s_waitcnt lgkmcnt(9)
    v_mfma_f32_16x16x32_bf16 v[88:91], a[12:15], v[124:127], v[88:91]
    v_mfma_f32_16x16x32_bf16 v[92:95], a[92:95], v[124:127], v[92:95]
    v_mfma_f32_16x16x32_bf16 v[96:99], a[172:175], v[124:127], v[96:99]
    ds_read_b128 v[116:119], v67 offset:512
    ds_write_b128 v57, v[20:23] offset:40960
    s_waitcnt lgkmcnt(10)
    v_mfma_f32_16x16x32_bf16 v[88:91], a[16:19], v[128:131], v[88:91]
    v_mfma_f32_16x16x32_bf16 v[92:95], a[96:99], v[128:131], v[92:95]
    v_mfma_f32_16x16x32_bf16 v[96:99], a[176:179], v[128:131], v[96:99]
    ds_read_b128 v[120:123], v68 offset:512
    buffer_load_dwordx4 v[20:23], v4, s[40:43], s48 offen
    s_add_u32 s48, s48, 4096
    s_waitcnt lgkmcnt(10)
    v_mfma_f32_16x16x32_bf16 v[88:91], a[20:23], v[132:135], v[88:91]
    v_mfma_f32_16x16x32_bf16 v[92:95], a[100:103], v[132:135], v[92:95]
    v_mfma_f32_16x16x32_bf16 v[96:99], a[180:183], v[132:135], v[96:99]
    ds_read_b128 v[124:127], v69 offset:512
    ds_write_b128 v58, v[24:27] offset:40960
    s_waitcnt lgkmcnt(8)
    v_mfma_f32_16x16x32_bf16 v[88:91], a[24:27], v[136:139], v[88:91]
    v_mfma_f32_16x16x32_bf16 v[92:95], a[104:107], v[136:139], v[92:95]
    v_mfma_f32_16x16x32_bf16 v[96:99], a[184:187], v[136:139], v[96:99]
    ds_read_b128 v[128:131], v66 offset:768
    buffer_load_dwordx4 v[24:27], v4, s[40:43], s48 offen
    s_add_u32 s48, s48, 4096
    s_waitcnt lgkmcnt(8)
    v_mfma_f32_16x16x32_bf16 v[88:91], a[28:31], v[140:143], v[88:91]
    v_mfma_f32_16x16x32_bf16 v[92:95], a[108:111], v[140:143], v[92:95]
    v_mfma_f32_16x16x32_bf16 v[96:99], a[188:191], v[140:143], v[96:99]
    ds_read_b128 v[132:135], v67 offset:768
    ds_write_b128 v59, v[28:31] offset:40960
    s_waitcnt lgkmcnt(8)
    v_mfma_f32_16x16x32_bf16 v[88:91], a[32:35], v[112:115], v[88:91]
    v_mfma_f32_16x16x32_bf16 v[92:95], a[112:115], v[112:115], v[92:95]
    v_mfma_f32_16x16x32_bf16 v[96:99], a[192:195], v[112:115], v[96:99]
    ds_read_b128 v[136:139], v68 offset:768
    buffer_load_dwordx4 v[28:31], v4, s[40:43], s48 offen
    s_add_u32 s48, s48, 4096
    s_waitcnt lgkmcnt(8)
    v_mfma_f32_16x16x32_bf16 v[88:91], a[36:39], v[116:119], v[88:91]
    v_mfma_f32_16x16x32_bf16 v[92:95], a[116:119], v[116:119], v[92:95]
    v_mfma_f32_16x16x32_bf16 v[96:99], a[196:199], v[116:119], v[96:99]
    ds_read_b128 v[140:143], v69 offset:768
    ds_write_b128 v60, v[32:35] offset:40960
    s_waitcnt lgkmcnt(8)
    v_mfma_f32_16x16x32_bf16 v[88:91], a[40:43], v[120:123], v[88:91]
    v_mfma_f32_16x16x32_bf16 v[92:95], a[120:123], v[120:123], v[92:95]
    v_mfma_f32_16x16x32_bf16 v[96:99], a[200:203], v[120:123], v[96:99]
    ds_read_b128 v[112:115], v66 offset:1024
    buffer_load_dwordx4 v[32:35], v4, s[40:43], s48 offen
    s_add_u32 s48, s48, 4096
    s_waitcnt lgkmcnt(8)
    v_mfma_f32_16x16x32_bf16 v[88:91], a[44:47], v[124:127], v[88:91]
    v_mfma_f32_16x16x32_bf16 v[92:95], a[124:127], v[124:127], v[92:95]
    v_mfma_f32_16x16x32_bf16 v[96:99], a[204:207], v[124:127], v[96:99]
    ds_read_b128 v[116:119], v67 offset:1024
    ds_write_b128 v61, v[36:39] offset:40960
    s_waitcnt lgkmcnt(8)
    v_mfma_f32_16x16x32_bf16 v[88:91], a[48:51], v[128:131], v[88:91]
    v_mfma_f32_16x16x32_bf16 v[92:95], a[128:131], v[128:131], v[92:95]
    v_mfma_f32_16x16x32_bf16 v[96:99], a[208:211], v[128:131], v[96:99]
    ds_read_b128 v[120:123], v68 offset:1024
    buffer_load_dwordx4 v[36:39], v4, s[40:43], s48 offen
    s_add_u32 s48, s48, 4096
    s_waitcnt lgkmcnt(8)
    v_mfma_f32_16x16x32_bf16 v[88:91], a[52:55], v[132:135], v[88:91]
    v_mfma_f32_16x16x32_bf16 v[92:95], a[132:135], v[132:135], v[92:95]
    v_mfma_f32_16x16x32_bf16 v[96:99], a[212:215], v[132:135], v[96:99]
    ds_read_b128 v[124:127], v69 offset:1024
    ds_write_b128 v62, v[40:43] offset:40960
    s_waitcnt lgkmcnt(8)
    v_mfma_f32_16x16x32_bf16 v[88:91], a[56:59], v[136:139], v[88:91]
    v_mfma_f32_16x16x32_bf16 v[92:95], a[136:139], v[136:139], v[92:95]
    v_mfma_f32_16x16x32_bf16 v[96:99], a[216:219], v[136:139], v[96:99]
    ds_read_b128 v[128:131], v66 offset:20480
    buffer_load_dwordx4 v[40:43], v4, s[40:43], s48 offen
    s_add_u32 s48, s48, 4096
    s_waitcnt lgkmcnt(8)
    v_mfma_f32_16x16x32_bf16 v[88:91], a[60:63], v[140:143], v[88:91]
    v_mfma_f32_16x16x32_bf16 v[92:95], a[140:143], v[140:143], v[92:95]
    v_mfma_f32_16x16x32_bf16 v[96:99], a[220:223], v[140:143], v[96:99]
    ds_read_b128 v[132:135], v67 offset:20480
    ds_write_b128 v63, v[44:47] offset:40960
    s_waitcnt lgkmcnt(8)
    v_mfma_f32_16x16x32_bf16 v[88:91], a[64:67], v[112:115], v[88:91]
    v_mfma_f32_16x16x32_bf16 v[92:95], a[144:147], v[112:115], v[92:95]
    v_mfma_f32_16x16x32_bf16 v[96:99], a[224:227], v[112:115], v[96:99]
    ds_read_b128 v[136:139], v68 offset:20480
    buffer_load_dwordx4 v[44:47], v4, s[40:43], s48 offen
    s_add_u32 s48, s48, 4096
    s_waitcnt lgkmcnt(8)
    v_mfma_f32_16x16x32_bf16 v[88:91], a[68:71], v[116:119], v[88:91]
    v_mfma_f32_16x16x32_bf16 v[92:95], a[148:151], v[116:119], v[92:95]
    v_mfma_f32_16x16x32_bf16 v[96:99], a[228:231], v[116:119], v[96:99]
    ds_read_b128 v[140:143], v69 offset:20480
    ds_write_b128 v64, v[48:51] offset:40960
    s_waitcnt lgkmcnt(8)
    v_mfma_f32_16x16x32_bf16 v[88:91], a[72:75], v[120:123], v[88:91]
    v_mfma_f32_16x16x32_bf16 v[92:95], a[152:155], v[120:123], v[92:95]
    v_mfma_f32_16x16x32_bf16 v[96:99], a[232:235], v[120:123], v[96:99]
    ds_read_b128 v[112:115], v66 offset:20736
    buffer_load_dwordx4 v[48:51], v4, s[40:43], s48 offen
    s_add_u32 s48, s48, 4096
    s_waitcnt lgkmcnt(8)
    v_mfma_f32_16x16x32_bf16 v[88:91], a[76:79], v[124:127], v[88:91]
    v_mfma_f32_16x16x32_bf16 v[92:95], a[156:159], v[124:127], v[92:95]
    v_mfma_f32_16x16x32_bf16 v[96:99], a[236:239], v[124:127], v[96:99]
    ds_read_b128 v[116:119], v67 offset:20736
    ds_write_b128 v65, v[52:55] offset:40960
    s_waitcnt lgkmcnt(8)
    v_mfma_f32_16x16x32_bf16 v[100:103], a[0:3], v[128:131], 0
    v_mfma_f32_16x16x32_bf16 v[104:107], a[80:83], v[128:131], 0
    v_mfma_f32_16x16x32_bf16 v[108:111], a[160:163], v[128:131], 0
    ds_read_b128 v[120:123], v68 offset:20736
    buffer_load_dwordx4 v[52:55], v4, s[40:43], s48 offen
    s_add_u32 s48, s48, 4096
    s_waitcnt lgkmcnt(8)
    v_mfma_f32_16x16x32_bf16 v[100:103], a[4:7], v[132:135], v[100:103]
    v_mfma_f32_16x16x32_bf16 v[104:107], a[84:87], v[132:135], v[104:107]
    v_mfma_f32_16x16x32_bf16 v[108:111], a[164:167], v[132:135], v[108:111]
    ds_read_b128 v[124:127], v69 offset:20736
    s_waitcnt lgkmcnt(7)
    v_mfma_f32_16x16x32_bf16 v[100:103], a[8:11], v[136:139], v[100:103]
    v_mfma_f32_16x16x32_bf16 v[104:107], a[88:91], v[136:139], v[104:107]
    v_mfma_f32_16x16x32_bf16 v[108:111], a[168:171], v[136:139], v[108:111]
    ds_read_b128 v[128:131], v66 offset:20992
    buffer_store_dwordx4 v[176:179], v74, s[60:63], s64 offen sc1
    s_waitcnt lgkmcnt(7)
    v_mfma_f32_16x16x32_bf16 v[100:103], a[12:15], v[140:143], v[100:103]
    v_mfma_f32_16x16x32_bf16 v[104:107], a[92:95], v[140:143], v[104:107]
    v_mfma_f32_16x16x32_bf16 v[108:111], a[172:175], v[140:143], v[108:111]
    ds_read_b128 v[132:135], v67 offset:20992
    s_waitcnt lgkmcnt(6)
    v_mfma_f32_16x16x32_bf16 v[100:103], a[16:19], v[112:115], v[100:103]
    v_mfma_f32_16x16x32_bf16 v[104:107], a[96:99], v[112:115], v[104:107]
    v_mfma_f32_16x16x32_bf16 v[108:111], a[176:179], v[112:115], v[108:111]
    ds_read_b128 v[136:139], v68 offset:20992
    buffer_store_dwordx4 v[180:183], v75, s[60:63], s64 offen sc1
    s_waitcnt lgkmcnt(6)
    v_mfma_f32_16x16x32_bf16 v[100:103], a[20:23], v[116:119], v[100:103]
    v_mfma_f32_16x16x32_bf16 v[104:107], a[100:103], v[116:119], v[104:107]
    v_mfma_f32_16x16x32_bf16 v[108:111], a[180:183], v[116:119], v[108:111]
    ds_read_b128 v[140:143], v69 offset:20992
    s_waitcnt lgkmcnt(5)
    v_mfma_f32_16x16x32_bf16 v[100:103], a[24:27], v[120:123], v[100:103]
    v_mfma_f32_16x16x32_bf16 v[104:107], a[104:107], v[120:123], v[104:107]
    v_mfma_f32_16x16x32_bf16 v[108:111], a[184:187], v[120:123], v[108:111]
    ds_read_b128 v[112:115], v66 offset:21248
    buffer_store_dwordx4 v[184:187], v15, s[60:63], s64 offen sc1
    s_waitcnt lgkmcnt(5)
    v_mfma_f32_16x16x32_bf16 v[100:103], a[28:31], v[124:127], v[100:103]
    v_mfma_f32_16x16x32_bf16 v[104:107], a[108:111], v[124:127], v[104:107]
    v_mfma_f32_16x16x32_bf16 v[108:111], a[188:191], v[124:127], v[108:111]
    ds_read_b128 v[116:119], v67 offset:21248
    s_waitcnt lgkmcnt(5)
    v_mfma_f32_16x16x32_bf16 v[100:103], a[32:35], v[128:131], v[100:103]
    v_mfma_f32_16x16x32_bf16 v[104:107], a[112:115], v[128:131], v[104:107]
    v_mfma_f32_16x16x32_bf16 v[108:111], a[192:195], v[128:131], v[108:111]
    ds_read_b128 v[120:123], v68 offset:21248
    s_waitcnt lgkmcnt(5)
    v_mfma_f32_16x16x32_bf16 v[100:103], a[36:39], v[132:135], v[100:103]
    v_mfma_f32_16x16x32_bf16 v[104:107], a[116:119], v[132:135], v[104:107]
    v_mfma_f32_16x16x32_bf16 v[108:111], a[196:199], v[132:135], v[108:111]
    ds_read_b128 v[124:127], v69 offset:21248
    s_waitcnt lgkmcnt(5)
    v_mfma_f32_16x16x32_bf16 v[100:103], a[40:43], v[136:139], v[100:103]
    v_mfma_f32_16x16x32_bf16 v[104:107], a[120:123], v[136:139], v[104:107]
    v_mfma_f32_16x16x32_bf16 v[108:111], a[200:203], v[136:139], v[108:111]
    ds_read_b128 v[128:131], v66 offset:21504
    s_waitcnt lgkmcnt(5)
    v_mfma_f32_16x16x32_bf16 v[100:103], a[44:47], v[140:143], v[100:103]
    v_mfma_f32_16x16x32_bf16 v[104:107], a[124:127], v[140:143], v[104:107]
    v_mfma_f32_16x16x32_bf16 v[108:111], a[204:207], v[140:143], v[108:111]
    ds_read_b128 v[132:135], v67 offset:21504
    s_waitcnt lgkmcnt(5)
    v_mfma_f32_16x16x32_bf16 v[100:103], a[48:51], v[112:115], v[100:103]
    v_mfma_f32_16x16x32_bf16 v[104:107], a[128:131], v[112:115], v[104:107]
    v_mfma_f32_16x16x32_bf16 v[108:111], a[208:211], v[112:115], v[108:111]
    ds_read_b128 v[136:139], v68 offset:21504
    s_waitcnt lgkmcnt(5)
    v_mfma_f32_16x16x32_bf16 v[100:103], a[52:55], v[116:119], v[100:103]
    v_mfma_f32_16x16x32_bf16 v[104:107], a[132:135], v[116:119], v[104:107]
    v_mfma_f32_16x16x32_bf16 v[108:111], a[212:215], v[116:119], v[108:111]
    ds_read_b128 v[140:143], v69 offset:21504
    s_waitcnt lgkmcnt(5)
    v_mfma_f32_16x16x32_bf16 v[100:103], a[56:59], v[120:123], v[100:103]
    v_mfma_f32_16x16x32_bf16 v[104:107], a[136:139], v[120:123], v[104:107]
    v_mfma_f32_16x16x32_bf16 v[108:111], a[216:219], v[120:123], v[108:111]
    s_waitcnt lgkmcnt(4)
    v_mfma_f32_16x16x32_bf16 v[100:103], a[60:63], v[124:127], v[100:103]
    v_mfma_f32_16x16x32_bf16 v[104:107], a[140:143], v[124:127], v[104:107]
    v_mfma_f32_16x16x32_bf16 v[108:111], a[220:223], v[124:127], v[108:111]
    s_waitcnt lgkmcnt(3)
    v_mfma_f32_16x16x32_bf16 v[100:103], a[64:67], v[128:131], v[100:103]
    v_mfma_f32_16x16x32_bf16 v[104:107], a[144:147], v[128:131], v[104:107]
    v_mfma_f32_16x16x32_bf16 v[108:111], a[224:227], v[128:131], v[108:111]
    s_waitcnt lgkmcnt(2)
    v_mfma_f32_16x16x32_bf16 v[100:103], a[68:71], v[132:135], v[100:103]
    v_mfma_f32_16x16x32_bf16 v[104:107], a[148:151], v[132:135], v[104:107]
    v_mfma_f32_16x16x32_bf16 v[108:111], a[228:231], v[132:135], v[108:111]
    s_waitcnt lgkmcnt(1)
    v_mfma_f32_16x16x32_bf16 v[100:103], a[72:75], v[136:139], v[100:103]
    v_mfma_f32_16x16x32_bf16 v[104:107], a[152:155], v[136:139], v[104:107]
    v_mfma_f32_16x16x32_bf16 v[108:111], a[232:235], v[136:139], v[108:111]
    s_waitcnt lgkmcnt(0)
    v_mfma_f32_16x16x32_bf16 v[100:103], a[76:79], v[140:143], v[100:103]
    v_mfma_f32_16x16x32_bf16 v[104:107], a[156:159], v[140:143], v[104:107]
    v_mfma_f32_16x16x32_bf16 v[108:111], a[236:239], v[140:143], v[108:111]
    s_nop 7
    v_cvt_pk_bf16_f32 v144, v88, v89
    v_and_b32 v89, 0xffff0000, v144
    v_lshlrev_b32 v88, 16, v144
    v_add_f32 v88, v88, v76
    v_add_f32 v89, v89, v77
    v_cvt_pk_bf16_f32 v144, v88, v89
    v_and_b32 v89, 0xffff0000, v144
    v_lshlrev_b32 v88, 16, v144
    v_mul_f32 v145, v88, v88
    v_fma_f32 v145, v145, s57, v147
    v_mul_f32 v145, v145, v88
    v_exp_f32 v145, -v145
    v_mul_f32 v146, v89, v89
    v_fma_f32 v146, v146, s57, v147
    v_mul_f32 v146, v146, v89
    v_exp_f32 v146, -v146
    s_nop 0
    v_add_f32 v145, 1.0, v145
    v_rcp_f32 v145, v145
    v_add_f32 v146, 1.0, v146
    v_rcp_f32 v146, v146
    s_nop 0
    v_mul_f32 v88, v88, v145
    v_mul_f32 v89, v89, v146
    v_cvt_pk_bf16_f32 v144, v88, v89
    v_cvt_pk_bf16_f32 v148, v90, v91
    v_and_b32 v91, 0xffff0000, v148
    v_lshlrev_b32 v90, 16, v148
    v_add_f32 v90, v90, v78
    v_add_f32 v91, v91, v79
    v_cvt_pk_bf16_f32 v148, v90, v91
    v_and_b32 v91, 0xffff0000, v148
    v_lshlrev_b32 v90, 16, v148
    v_mul_f32 v149, v90, v90
    v_fma_f32 v149, v149, s57, v151
    v_mul_f32 v149, v149, v90
    v_exp_f32 v149, -v149
    v_mul_f32 v150, v91, v91
    v_fma_f32 v150, v150, s57, v151
    v_mul_f32 v150, v150, v91
    v_exp_f32 v150, -v150
    s_nop 0
    v_add_f32 v149, 1.0, v149
    v_rcp_f32 v149, v149
    v_add_f32 v150, 1.0, v150
    v_rcp_f32 v150, v150
    s_nop 0
    v_mul_f32 v90, v90, v149
    v_mul_f32 v91, v91, v150
    v_cvt_pk_bf16_f32 v148, v90, v91
    v_mov_b32 v152, v144
    v_mov_b32 v153, v148
    ds_write_b64 v70, v[152:153] offset:0
    v_cvt_pk_bf16_f32 v144, v92, v93
    v_and_b32 v93, 0xffff0000, v144
    v_lshlrev_b32 v92, 16, v144
    v_add_f32 v92, v92, v80
    v_add_f32 v93, v93, v81
    v_cvt_pk_bf16_f32 v144, v92, v93
    v_and_b32 v93, 0xffff0000, v144
    v_lshlrev_b32 v92, 16, v144
    v_mul_f32 v145, v92, v92
    v_fma_f32 v145, v145, s57, v147
    v_mul_f32 v145, v145, v92
    v_exp_f32 v145, -v145
    v_mul_f32 v146, v93, v93
    v_fma_f32 v146, v146, s57, v147
    v_mul_f32 v146, v146, v93
    v_exp_f32 v146, -v146
    s_nop 0
    v_add_f32 v145, 1.0, v145
    v_rcp_f32 v145, v145
    v_add_f32 v146, 1.0, v146
    v_rcp_f32 v146, v146
    s_nop 0
    v_mul_f32 v92, v92, v145
    v_mul_f32 v93, v93, v146
    v_cvt_pk_bf16_f32 v144, v92, v93
    v_cvt_pk_bf16_f32 v148, v94, v95
    v_and_b32 v95, 0xffff0000, v148
    v_lshlrev_b32 v94, 16, v148
    v_add_f32 v94, v94, v82
    v_add_f32 v95, v95, v83
    v_cvt_pk_bf16_f32 v148, v94, v95
    v_and_b32 v95, 0xffff0000, v148
    v_lshlrev_b32 v94, 16, v148
    v_mul_f32 v149, v94, v94
    v_fma_f32 v149, v149, s57, v151
    v_mul_f32 v149, v149, v94
    v_exp_f32 v149, -v149
    v_mul_f32 v150, v95, v95
    v_fma_f32 v150, v150, s57, v151
    v_mul_f32 v150, v150, v95
    v_exp_f32 v150, -v150
    s_nop 0
    v_add_f32 v149, 1.0, v149
    v_rcp_f32 v149, v149
    v_add_f32 v150, 1.0, v150
    v_rcp_f32 v150, v150
    s_nop 0
    v_mul_f32 v94, v94, v149
    v_mul_f32 v95, v95, v150
    v_cvt_pk_bf16_f32 v148, v94, v95
    v_mov_b32 v152, v144
    v_mov_b32 v153, v148
    ds_write_b64 v70, v[152:153] offset:32
    v_cvt_pk_bf16_f32 v144, v96, v97
    v_and_b32 v97, 0xffff0000, v144
    v_lshlrev_b32 v96, 16, v144
    v_add_f32 v96, v96, v84
    v_add_f32 v97, v97, v85
    v_cvt_pk_bf16_f32 v144, v96, v97
    v_and_b32 v97, 0xffff0000, v144
    v_lshlrev_b32 v96, 16, v144
    v_mul_f32 v145, v96, v96
    v_fma_f32 v145, v145, s57, v147
    v_mul_f32 v145, v145, v96
    v_exp_f32 v145, -v145
    v_mul_f32 v146, v97, v97
    v_fma_f32 v146, v146, s57, v147
    v_mul_f32 v146, v146, v97
    v_exp_f32 v146, -v146
    s_nop 0
    v_add_f32 v145, 1.0, v145
    v_rcp_f32 v145, v145
    v_add_f32 v146, 1.0, v146
    v_rcp_f32 v146, v146
    s_nop 0
    v_mul_f32 v96, v96, v145
    v_mul_f32 v97, v97, v146
    v_cvt_pk_bf16_f32 v144, v96, v97
    v_cvt_pk_bf16_f32 v148, v98, v99
    v_and_b32 v99, 0xffff0000, v148
    v_lshlrev_b32 v98, 16, v148
    v_add_f32 v98, v98, v86
    v_add_f32 v99, v99, v87
    v_cvt_pk_bf16_f32 v148, v98, v99
    v_and_b32 v99, 0xffff0000, v148
    v_lshlrev_b32 v98, 16, v148
    v_mul_f32 v149, v98, v98
    v_fma_f32 v149, v149, s57, v151
    v_mul_f32 v149, v149, v98
    v_exp_f32 v149, -v149
    v_mul_f32 v150, v99, v99
    v_fma_f32 v150, v150, s57, v151
    v_mul_f32 v150, v150, v99
    v_exp_f32 v150, -v150
    s_nop 0
    v_add_f32 v149, 1.0, v149
    v_rcp_f32 v149, v149
    v_add_f32 v150, 1.0, v150
    v_rcp_f32 v150, v150
    s_nop 0
    v_mul_f32 v98, v98, v149
    v_mul_f32 v99, v99, v150
    v_cvt_pk_bf16_f32 v148, v98, v99
    v_mov_b32 v152, v144
    v_mov_b32 v153, v148
    ds_write_b64 v70, v[152:153] offset:64
    v_cvt_pk_bf16_f32 v144, v100, v101
    v_and_b32 v101, 0xffff0000, v144
    v_lshlrev_b32 v100, 16, v144
    v_add_f32 v100, v100, v76
    v_add_f32 v101, v101, v77
    v_cvt_pk_bf16_f32 v144, v100, v101
    v_and_b32 v101, 0xffff0000, v144
    v_lshlrev_b32 v100, 16, v144
    v_mul_f32 v145, v100, v100
    v_fma_f32 v145, v145, s57, v147
    v_mul_f32 v145, v145, v100
    v_exp_f32 v145, -v145
    v_mul_f32 v146, v101, v101
    v_fma_f32 v146, v146, s57, v147
    v_mul_f32 v146, v146, v101
    v_exp_f32 v146, -v146
    s_nop 0
    v_add_f32 v145, 1.0, v145
    v_rcp_f32 v145, v145
    v_add_f32 v146, 1.0, v146
    v_rcp_f32 v146, v146
    s_nop 0
    v_mul_f32 v100, v100, v145
    v_mul_f32 v101, v101, v146
    v_cvt_pk_bf16_f32 v144, v100, v101
    v_cvt_pk_bf16_f32 v148, v102, v103
    v_and_b32 v103, 0xffff0000, v148
    v_lshlrev_b32 v102, 16, v148
    v_add_f32 v102, v102, v78
    v_add_f32 v103, v103, v79
    v_cvt_pk_bf16_f32 v148, v102, v103
    v_and_b32 v103, 0xffff0000, v148
    v_lshlrev_b32 v102, 16, v148
    v_mul_f32 v149, v102, v102
    v_fma_f32 v149, v149, s57, v151
    v_mul_f32 v149, v149, v102
    v_exp_f32 v149, -v149
    v_mul_f32 v150, v103, v103
    v_fma_f32 v150, v150, s57, v151
    v_mul_f32 v150, v150, v103
    v_exp_f32 v150, -v150
    s_nop 0
    v_add_f32 v149, 1.0, v149
    v_rcp_f32 v149, v149
    v_add_f32 v150, 1.0, v150
    v_rcp_f32 v150, v150
    s_nop 0
    v_mul_f32 v102, v102, v149
    v_mul_f32 v103, v103, v150
    v_cvt_pk_bf16_f32 v148, v102, v103
    v_mov_b32 v152, v144
    v_mov_b32 v153, v148
    ds_write_b64 v70, v[152:153] offset:6400
    v_cvt_pk_bf16_f32 v144, v104, v105
    v_and_b32 v105, 0xffff0000, v144
    v_lshlrev_b32 v104, 16, v144
    v_add_f32 v104, v104, v80
    v_add_f32 v105, v105, v81
    v_cvt_pk_bf16_f32 v144, v104, v105
    v_and_b32 v105, 0xffff0000, v144
    v_lshlrev_b32 v104, 16, v144
    v_mul_f32 v145, v104, v104
    v_fma_f32 v145, v145, s57, v147
    v_mul_f32 v145, v145, v104
    v_exp_f32 v145, -v145
    v_mul_f32 v146, v105, v105
    v_fma_f32 v146, v146, s57, v147
    v_mul_f32 v146, v146, v105
    v_exp_f32 v146, -v146
    s_nop 0
    v_add_f32 v145, 1.0, v145
    v_rcp_f32 v145, v145
    v_add_f32 v146, 1.0, v146
    v_rcp_f32 v146, v146
    s_nop 0
    v_mul_f32 v104, v104, v145
    v_mul_f32 v105, v105, v146
    v_cvt_pk_bf16_f32 v144, v104, v105
    v_cvt_pk_bf16_f32 v148, v106, v107
    v_and_b32 v107, 0xffff0000, v148
    v_lshlrev_b32 v106, 16, v148
    v_add_f32 v106, v106, v82
    v_add_f32 v107, v107, v83
    v_cvt_pk_bf16_f32 v148, v106, v107
    v_and_b32 v107, 0xffff0000, v148
    v_lshlrev_b32 v106, 16, v148
    v_mul_f32 v149, v106, v106
    v_fma_f32 v149, v149, s57, v151
    v_mul_f32 v149, v149, v106
    v_exp_f32 v149, -v149
    v_mul_f32 v150, v107, v107
    v_fma_f32 v150, v150, s57, v151
    v_mul_f32 v150, v150, v107
    v_exp_f32 v150, -v150
    s_nop 0
    v_add_f32 v149, 1.0, v149
    v_rcp_f32 v149, v149
    v_add_f32 v150, 1.0, v150
    v_rcp_f32 v150, v150
    s_nop 0
    v_mul_f32 v106, v106, v149
    v_mul_f32 v107, v107, v150
    v_cvt_pk_bf16_f32 v148, v106, v107
    v_mov_b32 v152, v144
    v_mov_b32 v153, v148
    ds_write_b64 v70, v[152:153] offset:6432
    v_cvt_pk_bf16_f32 v144, v108, v109
    v_and_b32 v109, 0xffff0000, v144
    v_lshlrev_b32 v108, 16, v144
    v_add_f32 v108, v108, v84
    v_add_f32 v109, v109, v85
    v_cvt_pk_bf16_f32 v144, v108, v109
    v_and_b32 v109, 0xffff0000, v144
    v_lshlrev_b32 v108, 16, v144
    v_mul_f32 v145, v108, v108
    v_fma_f32 v145, v145, s57, v147
    v_mul_f32 v145, v145, v108
    v_exp_f32 v145, -v145
    v_mul_f32 v146, v109, v109
    v_fma_f32 v146, v146, s57, v147
    v_mul_f32 v146, v146, v109
    v_exp_f32 v146, -v146
    s_nop 0
    v_add_f32 v145, 1.0, v145
    v_rcp_f32 v145, v145
    v_add_f32 v146, 1.0, v146
    v_rcp_f32 v146, v146
    s_nop 0
    v_mul_f32 v108, v108, v145
    v_mul_f32 v109, v109, v146
    v_cvt_pk_bf16_f32 v144, v108, v109
    v_cvt_pk_bf16_f32 v148, v110, v111
    v_and_b32 v111, 0xffff0000, v148
    v_lshlrev_b32 v110, 16, v148
    v_add_f32 v110, v110, v86
    v_add_f32 v111, v111, v87
    v_cvt_pk_bf16_f32 v148, v110, v111
    v_and_b32 v111, 0xffff0000, v148
    v_lshlrev_b32 v110, 16, v148
    v_mul_f32 v149, v110, v110
    v_fma_f32 v149, v149, s57, v151
    v_mul_f32 v149, v149, v110
    v_exp_f32 v149, -v149
    v_mul_f32 v150, v111, v111
    v_fma_f32 v150, v150, s57, v151
    v_mul_f32 v150, v150, v111
    v_exp_f32 v150, -v150
    s_nop 0
    v_add_f32 v149, 1.0, v149
    v_rcp_f32 v149, v149
    v_add_f32 v150, 1.0, v150
    v_rcp_f32 v150, v150
    s_nop 0
    v_mul_f32 v110, v110, v149
    v_mul_f32 v111, v111, v150
    v_cvt_pk_bf16_f32 v148, v110, v111
    v_mov_b32 v152, v144
    v_mov_b32 v153, v148
    ds_write_b64 v70, v[152:153] offset:6464
    s_cmp_ge_u32 s54, 3
    s_cbranch_scc1 ga_nf_112
    s_waitcnt lgkmcnt(0)
    s_barrier
    ds_read_b128 v[176:179], v71 offset:0
    ds_read_b128 v[180:183], v72 offset:0
    ds_read_b128 v[184:187], v73 offset:0
    s_waitcnt lgkmcnt(0)
    buffer_store_dwordx4 v[176:179], v74, s[60:63], s55 offen sc1
    buffer_store_dwordx4 v[180:183], v75, s[60:63], s55 offen sc1
    buffer_store_dwordx4 v[184:187], v15, s[60:63], s55 offen sc1
    s_add_u32 s55, s55, s56
    s_waitcnt vmcnt(0)
    s_barrier
    s_cmp_lg_u32 s91, 0
    s_cbranch_scc1 ga_nf2_113
    s_add_u32 s64, s58, s54
    s_add_u32 s93, s64, 0
    s_lshl_b32 s93, s93, 8
    v_mov_b32 v254, s93
    v_mov_b32 v255, 1
    s_mov_b64 s[94:95], exec
    s_mov_b64 exec, 1
    buffer_atomic_add v255, v254, s[28:31], 0 offen
    s_mov_b64 exec, s[94:95]
ga_nf2_113:
ga_nf_112:
    s_add_u32 s54, s54, 1
    s_waitcnt vmcnt(3) lgkmcnt(0)
    s_barrier
    s_cmp_lt_u32 s54, 6
    s_cbranch_scc1 ga_ns_114
    s_cmp_lg_u32 s91, 0
    s_cbranch_scc1 ga_ns_114
    s_sub_u32 s64, s54, 3
    s_add_u32 s64, s64, s58
    s_add_u32 s93, s64, 0
    s_lshl_b32 s93, s93, 8
    v_mov_b32 v254, s93
    v_mov_b32 v255, 1
    s_mov_b64 s[94:95], exec
    s_mov_b64 exec, 1
    buffer_atomic_add v255, v254, s[28:31], 0 offen
    s_mov_b64 exec, s[94:95]
ga_ns_114:
    s_cmp_lt_u32 s54, 4
    s_cselect_b32 s64, 0x7f000000, s55
    s_cselect_b32 s65, 0, s56
    s_add_u32 s55, s55, s65
    ds_read_b128 v[112:115], v66 offset:40960
    ds_read_b128 v[116:119], v67 offset:40960
    ds_read_b128 v[120:123], v68 offset:40960
    ds_read_b128 v[124:127], v69 offset:40960
    ds_read_b128 v[128:131], v66 offset:41216
    ds_read_b128 v[132:135], v67 offset:41216
    ds_read_b128 v[176:179], v71 offset:0
    ds_read_b128 v[180:183], v72 offset:0
    ds_read_b128 v[184:187], v73 offset:0
    s_waitcnt lgkmcnt(8)
    v_mfma_f32_16x16x32_bf16 v[88:91], a[0:3], v[112:115], 0
    v_mfma_f32_16x16x32_bf16 v[92:95], a[80:83], v[112:115], 0
    v_mfma_f32_16x16x32_bf16 v[96:99], a[160:163], v[112:115], 0
    ds_read_b128 v[136:139], v68 offset:41216
    s_waitcnt lgkmcnt(8)
    v_mfma_f32_16x16x32_bf16 v[88:91], a[4:7], v[116:119], v[88:91]
    v_mfma_f32_16x16x32_bf16 v[92:95], a[84:87], v[116:119], v[92:95]
    v_mfma_f32_16x16x32_bf16 v[96:99], a[164:167], v[116:119], v[96:99]
    ds_read_b128 v[140:143], v69 offset:41216
    ds_write_b128 v56, v[16:19] offset:0
    s_waitcnt lgkmcnt(9)
    v_mfma_f32_16x16x32_bf16 v[88:91], a[8:11], v[120:123], v[88:91]
    v_mfma_f32_16x16x32_bf16 v[92:95], a[88:91], v[120:123], v[92:95]
    v_mfma_f32_16x16x32_bf16 v[96:99], a[168:171], v[120:123], v[96:99]
    ds_read_b128 v[112:115], v66 offset:41472
    buffer_load_dwordx4 v[16:19], v4, s[40:43], s48 offen
    s_add_u32 s48, s48, 4096
    s_waitcnt lgkmcnt(9)
    v_mfma_f32_16x16x32_bf16 v[88:91], a[12:15], v[124:127], v[88:91]
    v_mfma_f32_16x16x32_bf16 v[92:95], a[92:95], v[124:127], v[92:95]
    v_mfma_f32_16x16x32_bf16 v[96:99], a[172:175], v[124:127], v[96:99]
    ds_read_b128 v[116:119], v67 offset:41472
    ds_write_b128 v57, v[20:23] offset:0
    s_waitcnt lgkmcnt(10)
    v_mfma_f32_16x16x32_bf16 v[88:91], a[16:19], v[128:131], v[88:91]
    v_mfma_f32_16x16x32_bf16 v[92:95], a[96:99], v[128:131], v[92:95]
    v_mfma_f32_16x16x32_bf16 v[96:99], a[176:179], v[128:131], v[96:99]
    ds_read_b128 v[120:123], v68 offset:41472
    buffer_load_dwordx4 v[20:23], v4, s[40:43], s48 offen
    s_add_u32 s48, s48, 4096
    s_waitcnt lgkmcnt(10)
    v_mfma_f32_16x16x32_bf16 v[88:91], a[20:23], v[132:135], v[88:91]
    v_mfma_f32_16x16x32_bf16 v[92:95], a[100:103], v[132:135], v[92:95]
    v_mfma_f32_16x16x32_bf16 v[96:99], a[180:183], v[132:135], v[96:99]
    ds_read_b128 v[124:127], v69 offset:41472
    ds_write_b128 v58, v[24:27] offset:0
    s_waitcnt lgkmcnt(8)
    v_mfma_f32_16x16x32_bf16 v[88:91], a[24:27], v[136:139], v[88:91]
    v_mfma_f32_16x16x32_bf16 v[92:95], a[104:107], v[136:139], v[92:95]
    v_mfma_f32_16x16x32_bf16 v[96:99], a[184:187], v[136:139], v[96:99]
    ds_read_b128 v[128:131], v66 offset:41728
    buffer_load_dwordx4 v[24:27], v4, s[40:43], s48 offen
    s_add_u32 s48, s48, 4096
    s_waitcnt lgkmcnt(8)
    v_mfma_f32_16x16x32_bf16 v[88:91], a[28:31], v[140:143], v[88:91]
    v_mfma_f32_16x16x32_bf16 v[92:95], a[108:111], v[140:143], v[92:95]
    v_mfma_f32_16x16x32_bf16 v[96:99], a[188:191], v[140:143], v[96:99]
    ds_read_b128 v[132:135], v67 offset:41728
    ds_write_b128 v59, v[28:31] offset:0
    s_waitcnt lgkmcnt(8)
    v_mfma_f32_16x16x32_bf16 v[88:91], a[32:35], v[112:115], v[88:91]
    v_mfma_f32_16x16x32_bf16 v[92:95], a[112:115], v[112:115], v[92:95]
    v_mfma_f32_16x16x32_bf16 v[96:99], a[192:195], v[112:115], v[96:99]
    ds_read_b128 v[136:139], v68 offset:41728
    buffer_load_dwordx4 v[28:31], v4, s[40:43], s48 offen
    s_add_u32 s48, s48, 4096
    s_waitcnt lgkmcnt(8)
    v_mfma_f32_16x16x32_bf16 v[88:91], a[36:39], v[116:119], v[88:91]
    v_mfma_f32_16x16x32_bf16 v[92:95], a[116:119], v[116:119], v[92:95]
    v_mfma_f32_16x16x32_bf16 v[96:99], a[196:199], v[116:119], v[96:99]
    ds_read_b128 v[140:143], v69 offset:41728
    ds_write_b128 v60, v[32:35] offset:0
    s_waitcnt lgkmcnt(8)
    v_mfma_f32_16x16x32_bf16 v[88:91], a[40:43], v[120:123], v[88:91]
    v_mfma_f32_16x16x32_bf16 v[92:95], a[120:123], v[120:123], v[92:95]
    v_mfma_f32_16x16x32_bf16 v[96:99], a[200:203], v[120:123], v[96:99]
    ds_read_b128 v[112:115], v66 offset:41984
    buffer_load_dwordx4 v[32:35], v4, s[40:43], s48 offen
    s_add_u32 s48, s48, 4096
    s_waitcnt lgkmcnt(8)
    v_mfma_f32_16x16x32_bf16 v[88:91], a[44:47], v[124:127], v[88:91]
    v_mfma_f32_16x16x32_bf16 v[92:95], a[124:127], v[124:127], v[92:95]
    v_mfma_f32_16x16x32_bf16 v[96:99], a[204:207], v[124:127], v[96:99]
    ds_read_b128 v[116:119], v67 offset:41984
    ds_write_b128 v61, v[36:39] offset:0
    s_waitcnt lgkmcnt(8)
    v_mfma_f32_16x16x32_bf16 v[88:91], a[48:51], v[128:131], v[88:91]
    v_mfma_f32_16x16x32_bf16 v[92:95], a[128:131], v[128:131], v[92:95]
    v_mfma_f32_16x16x32_bf16 v[96:99], a[208:211], v[128:131], v[96:99]
    ds_read_b128 v[120:123], v68 offset:41984
    buffer_load_dwordx4 v[36:39], v4, s[40:43], s48 offen
    s_add_u32 s48, s48, 4096
    s_waitcnt lgkmcnt(8)
    v_mfma_f32_16x16x32_bf16 v[88:91], a[52:55], v[132:135], v[88:91]
    v_mfma_f32_16x16x32_bf16 v[92:95], a[132:135], v[132:135], v[92:95]
    v_mfma_f32_16x16x32_bf16 v[96:99], a[212:215], v[132:135], v[96:99]
    ds_read_b128 v[124:127], v69 offset:41984
    ds_write_b128 v62, v[40:43] offset:0
    s_waitcnt lgkmcnt(8)
    v_mfma_f32_16x16x32_bf16 v[88:91], a[56:59], v[136:139], v[88:91]
    v_mfma_f32_16x16x32_bf16 v[92:95], a[136:139], v[136:139], v[92:95]
    v_mfma_f32_16x16x32_bf16 v[96:99], a[216:219], v[136:139], v[96:99]
    ds_read_b128 v[128:131], v66 offset:61440
    buffer_load_dwordx4 v[40:43], v4, s[40:43], s48 offen
    s_add_u32 s48, s48, 4096
    s_waitcnt lgkmcnt(8)
    v_mfma_f32_16x16x32_bf16 v[88:91], a[60:63], v[140:143], v[88:91]
    v_mfma_f32_16x16x32_bf16 v[92:95], a[140:143], v[140:143], v[92:95]
    v_mfma_f32_16x16x32_bf16 v[96:99], a[220:223], v[140:143], v[96:99]
    ds_read_b128 v[132:135], v67 offset:61440
    ds_write_b128 v63, v[44:47] offset:0
    s_waitcnt lgkmcnt(8)
    v_mfma_f32_16x16x32_bf16 v[88:91], a[64:67], v[112:115], v[88:91]
    v_mfma_f32_16x16x32_bf16 v[92:95], a[144:147], v[112:115], v[92:95]
    v_mfma_f32_16x16x32_bf16 v[96:99], a[224:227], v[112:115], v[96:99]
    ds_read_b128 v[136:139], v68 offset:61440
    buffer_load_dwordx4 v[44:47], v4, s[40:43], s48 offen
    s_add_u32 s48, s48, 4096
    s_waitcnt lgkmcnt(8)
    v_mfma_f32_16x16x32_bf16 v[88:91], a[68:71], v[116:119], v[88:91]
    v_mfma_f32_16x16x32_bf16 v[92:95], a[148:151], v[116:119], v[92:95]
    v_mfma_f32_16x16x32_bf16 v[96:99], a[228:231], v[116:119], v[96:99]
    ds_read_b128 v[140:143], v69 offset:61440
    ds_write_b128 v64, v[48:51] offset:0
    s_waitcnt lgkmcnt(8)
    v_mfma_f32_16x16x32_bf16 v[88:91], a[72:75], v[120:123], v[88:91]
    v_mfma_f32_16x16x32_bf16 v[92:95], a[152:155], v[120:123], v[92:95]
    v_mfma_f32_16x16x32_bf16 v[96:99], a[232:235], v[120:123], v[96:99]
    ds_read_b128 v[112:115], v66 offset:61696
    buffer_load_dwordx4 v[48:51], v4, s[40:43], s48 offen
    s_add_u32 s48, s48, 4096
    s_waitcnt lgkmcnt(8)
    v_mfma_f32_16x16x32_bf16 v[88:91], a[76:79], v[124:127], v[88:91]
    v_mfma_f32_16x16x32_bf16 v[92:95], a[156:159], v[124:127], v[92:95]
    v_mfma_f32_16x16x32_bf16 v[96:99], a[236:239], v[124:127], v[96:99]
    ds_read_b128 v[116:119], v67 offset:61696
    ds_write_b128 v65, v[52:55] offset:0
    s_waitcnt lgkmcnt(8)
    v_mfma_f32_16x16x32_bf16 v[100:103], a[0:3], v[128:131], 0
    v_mfma_f32_16x16x32_bf16 v[104:107], a[80:83], v[128:131], 0
    v_mfma_f32_16x16x32_bf16 v[108:111], a[160:163], v[128:131], 0
    ds_read_b128 v[120:123], v68 offset:61696
    buffer_load_dwordx4 v[52:55], v4, s[40:43], s48 offen
    s_add_u32 s48, s48, 4096
    s_waitcnt lgkmcnt(8)
    v_mfma_f32_16x16x32_bf16 v[100:103], a[4:7], v[132:135], v[100:103]
    v_mfma_f32_16x16x32_bf16 v[104:107], a[84:87], v[132:135], v[104:107]
    v_mfma_f32_16x16x32_bf16 v[108:111], a[164:167], v[132:135], v[108:111]
    ds_read_b128 v[124:127], v69 offset:61696
    s_waitcnt lgkmcnt(7)
    v_mfma_f32_16x16x32_bf16 v[100:103], a[8:11], v[136:139], v[100:103]
    v_mfma_f32_16x16x32_bf16 v[104:107], a[88:91], v[136:139], v[104:107]
    v_mfma_f32_16x16x32_bf16 v[108:111], a[168:171], v[136:139], v[108:111]
    ds_read_b128 v[128:131], v66 offset:61952
    buffer_store_dwordx4 v[176:179], v74, s[60:63], s64 offen sc1
    s_waitcnt lgkmcnt(7)
    v_mfma_f32_16x16x32_bf16 v[100:103], a[12:15], v[140:143], v[100:103]
    v_mfma_f32_16x16x32_bf16 v[104:107], a[92:95], v[140:143], v[104:107]
    v_mfma_f32_16x16x32_bf16 v[108:111], a[172:175], v[140:143], v[108:111]
    ds_read_b128 v[132:135], v67 offset:61952
    s_waitcnt lgkmcnt(6)
    v_mfma_f32_16x16x32_bf16 v[100:103], a[16:19], v[112:115], v[100:103]
    v_mfma_f32_16x16x32_bf16 v[104:107], a[96:99], v[112:115], v[104:107]
    v_mfma_f32_16x16x32_bf16 v[108:111], a[176:179], v[112:115], v[108:111]
    ds_read_b128 v[136:139], v68 offset:61952
    buffer_store_dwordx4 v[180:183], v75, s[60:63], s64 offen sc1
    s_waitcnt lgkmcnt(6)
    v_mfma_f32_16x16x32_bf16 v[100:103], a[20:23], v[116:119], v[100:103]
    v_mfma_f32_16x16x32_bf16 v[104:107], a[100:103], v[116:119], v[104:107]
    v_mfma_f32_16x16x32_bf16 v[108:111], a[180:183], v[116:119], v[108:111]
    ds_read_b128 v[140:143], v69 offset:61952
    s_waitcnt lgkmcnt(5)
    v_mfma_f32_16x16x32_bf16 v[100:103], a[24:27], v[120:123], v[100:103]
    v_mfma_f32_16x16x32_bf16 v[104:107], a[104:107], v[120:123], v[104:107]
    v_mfma_f32_16x16x32_bf16 v[108:111], a[184:187], v[120:123], v[108:111]
    ds_read_b128 v[112:115], v66 offset:62208
    buffer_store_dwordx4 v[184:187], v15, s[60:63], s64 offen sc1
    s_waitcnt lgkmcnt(5)
    v_mfma_f32_16x16x32_bf16 v[100:103], a[28:31], v[124:127], v[100:103]
    v_mfma_f32_16x16x32_bf16 v[104:107], a[108:111], v[124:127], v[104:107]
    v_mfma_f32_16x16x32_bf16 v[108:111], a[188:191], v[124:127], v[108:111]
    ds_read_b128 v[116:119], v67 offset:62208
    s_waitcnt lgkmcnt(5)
    v_mfma_f32_16x16x32_bf16 v[100:103], a[32:35], v[128:131], v[100:103]
    v_mfma_f32_16x16x32_bf16 v[104:107], a[112:115], v[128:131], v[104:107]
    v_mfma_f32_16x16x32_bf16 v[108:111], a[192:195], v[128:131], v[108:111]
    ds_read_b128 v[120:123], v68 offset:62208
    s_waitcnt lgkmcnt(5)
    v_mfma_f32_16x16x32_bf16 v[100:103], a[36:39], v[132:135], v[100:103]
    v_mfma_f32_16x16x32_bf16 v[104:107], a[116:119], v[132:135], v[104:107]
    v_mfma_f32_16x16x32_bf16 v[108:111], a[196:199], v[132:135], v[108:111]
    ds_read_b128 v[124:127], v69 offset:62208
    s_waitcnt lgkmcnt(5)
    v_mfma_f32_16x16x32_bf16 v[100:103], a[40:43], v[136:139], v[100:103]
    v_mfma_f32_16x16x32_bf16 v[104:107], a[120:123], v[136:139], v[104:107]
    v_mfma_f32_16x16x32_bf16 v[108:111], a[200:203], v[136:139], v[108:111]
    ds_read_b128 v[128:131], v66 offset:62464
    s_waitcnt lgkmcnt(5)
    v_mfma_f32_16x16x32_bf16 v[100:103], a[44:47], v[140:143], v[100:103]
    v_mfma_f32_16x16x32_bf16 v[104:107], a[124:127], v[140:143], v[104:107]
    v_mfma_f32_16x16x32_bf16 v[108:111], a[204:207], v[140:143], v[108:111]
    ds_read_b128 v[132:135], v67 offset:62464
    s_waitcnt lgkmcnt(5)
    v_mfma_f32_16x16x32_bf16 v[100:103], a[48:51], v[112:115], v[100:103]
    v_mfma_f32_16x16x32_bf16 v[104:107], a[128:131], v[112:115], v[104:107]
    v_mfma_f32_16x16x32_bf16 v[108:111], a[208:211], v[112:115], v[108:111]
    ds_read_b128 v[136:139], v68 offset:62464
    s_waitcnt lgkmcnt(5)
    v_mfma_f32_16x16x32_bf16 v[100:103], a[52:55], v[116:119], v[100:103]
    v_mfma_f32_16x16x32_bf16 v[104:107], a[132:135], v[116:119], v[104:107]
    v_mfma_f32_16x16x32_bf16 v[108:111], a[212:215], v[116:119], v[108:111]
    ds_read_b128 v[140:143], v69 offset:62464
    s_waitcnt lgkmcnt(5)
    v_mfma_f32_16x16x32_bf16 v[100:103], a[56:59], v[120:123], v[100:103]
    v_mfma_f32_16x16x32_bf16 v[104:107], a[136:139], v[120:123], v[104:107]
    v_mfma_f32_16x16x32_bf16 v[108:111], a[216:219], v[120:123], v[108:111]
    s_waitcnt lgkmcnt(4)
    v_mfma_f32_16x16x32_bf16 v[100:103], a[60:63], v[124:127], v[100:103]
    v_mfma_f32_16x16x32_bf16 v[104:107], a[140:143], v[124:127], v[104:107]
    v_mfma_f32_16x16x32_bf16 v[108:111], a[220:223], v[124:127], v[108:111]
    s_waitcnt lgkmcnt(3)
    v_mfma_f32_16x16x32_bf16 v[100:103], a[64:67], v[128:131], v[100:103]
    v_mfma_f32_16x16x32_bf16 v[104:107], a[144:147], v[128:131], v[104:107]
    v_mfma_f32_16x16x32_bf16 v[108:111], a[224:227], v[128:131], v[108:111]
    s_waitcnt lgkmcnt(2)
    v_mfma_f32_16x16x32_bf16 v[100:103], a[68:71], v[132:135], v[100:103]
    v_mfma_f32_16x16x32_bf16 v[104:107], a[148:151], v[132:135], v[104:107]
    v_mfma_f32_16x16x32_bf16 v[108:111], a[228:231], v[132:135], v[108:111]
    s_waitcnt lgkmcnt(1)
    v_mfma_f32_16x16x32_bf16 v[100:103], a[72:75], v[136:139], v[100:103]
    v_mfma_f32_16x16x32_bf16 v[104:107], a[152:155], v[136:139], v[104:107]
    v_mfma_f32_16x16x32_bf16 v[108:111], a[232:235], v[136:139], v[108:111]
    s_waitcnt lgkmcnt(0)
    v_mfma_f32_16x16x32_bf16 v[100:103], a[76:79], v[140:143], v[100:103]
    v_mfma_f32_16x16x32_bf16 v[104:107], a[156:159], v[140:143], v[104:107]
    v_mfma_f32_16x16x32_bf16 v[108:111], a[236:239], v[140:143], v[108:111]
    s_nop 7
    v_cvt_pk_bf16_f32 v144, v88, v89
    v_and_b32 v89, 0xffff0000, v144
    v_lshlrev_b32 v88, 16, v144
    v_add_f32 v88, v88, v76
    v_add_f32 v89, v89, v77
    v_cvt_pk_bf16_f32 v144, v88, v89
    v_and_b32 v89, 0xffff0000, v144
    v_lshlrev_b32 v88, 16, v144
    v_mul_f32 v145, v88, v88
    v_fma_f32 v145, v145, s57, v147
    v_mul_f32 v145, v145, v88
    v_exp_f32 v145, -v145
    v_mul_f32 v146, v89, v89
    v_fma_f32 v146, v146, s57, v147
    v_mul_f32 v146, v146, v89
    v_exp_f32 v146, -v146
    s_nop 0
    v_add_f32 v145, 1.0, v145
    v_rcp_f32 v145, v145
    v_add_f32 v146, 1.0, v146
    v_rcp_f32 v146, v146
    s_nop 0
    v_mul_f32 v88, v88, v145
    v_mul_f32 v89, v89, v146
    v_cvt_pk_bf16_f32 v144, v88, v89
    v_cvt_pk_bf16_f32 v148, v90, v91
    v_and_b32 v91, 0xffff0000, v148
    v_lshlrev_b32 v90, 16, v148
    v_add_f32 v90, v90, v78
    v_add_f32 v91, v91, v79
    v_cvt_pk_bf16_f32 v148, v90, v91
    v_and_b32 v91, 0xffff0000, v148
    v_lshlrev_b32 v90, 16, v148
    v_mul_f32 v149, v90, v90
    v_fma_f32 v149, v149, s57, v151
    v_mul_f32 v149, v149, v90
    v_exp_f32 v149, -v149
    v_mul_f32 v150, v91, v91
    v_fma_f32 v150, v150, s57, v151
    v_mul_f32 v150, v150, v91
    v_exp_f32 v150, -v150
    s_nop 0
    v_add_f32 v149, 1.0, v149
    v_rcp_f32 v149, v149
    v_add_f32 v150, 1.0, v150
    v_rcp_f32 v150, v150
    s_nop 0
    v_mul_f32 v90, v90, v149
    v_mul_f32 v91, v91, v150
    v_cvt_pk_bf16_f32 v148, v90, v91
    v_mov_b32 v152, v144
    v_mov_b32 v153, v148
    ds_write_b64 v70, v[152:153] offset:15360
    v_cvt_pk_bf16_f32 v144, v92, v93
    v_and_b32 v93, 0xffff0000, v144
    v_lshlrev_b32 v92, 16, v144
    v_add_f32 v92, v92, v80
    v_add_f32 v93, v93, v81
    v_cvt_pk_bf16_f32 v144, v92, v93
    v_and_b32 v93, 0xffff0000, v144
    v_lshlrev_b32 v92, 16, v144
    v_mul_f32 v145, v92, v92
    v_fma_f32 v145, v145, s57, v147
    v_mul_f32 v145, v145, v92
    v_exp_f32 v145, -v145
    v_mul_f32 v146, v93, v93
    v_fma_f32 v146, v146, s57, v147
    v_mul_f32 v146, v146, v93
    v_exp_f32 v146, -v146
    s_nop 0
    v_add_f32 v145, 1.0, v145
    v_rcp_f32 v145, v145
    v_add_f32 v146, 1.0, v146
    v_rcp_f32 v146, v146
    s_nop 0
    v_mul_f32 v92, v92, v145
    v_mul_f32 v93, v93, v146
    v_cvt_pk_bf16_f32 v144, v92, v93
    v_cvt_pk_bf16_f32 v148, v94, v95
    v_and_b32 v95, 0xffff0000, v148
    v_lshlrev_b32 v94, 16, v148
    v_add_f32 v94, v94, v82
    v_add_f32 v95, v95, v83
    v_cvt_pk_bf16_f32 v148, v94, v95
    v_and_b32 v95, 0xffff0000, v148
    v_lshlrev_b32 v94, 16, v148
    v_mul_f32 v149, v94, v94
    v_fma_f32 v149, v149, s57, v151
    v_mul_f32 v149, v149, v94
    v_exp_f32 v149, -v149
    v_mul_f32 v150, v95, v95
    v_fma_f32 v150, v150, s57, v151
    v_mul_f32 v150, v150, v95
    v_exp_f32 v150, -v150
    s_nop 0
    v_add_f32 v149, 1.0, v149
    v_rcp_f32 v149, v149
    v_add_f32 v150, 1.0, v150
    v_rcp_f32 v150, v150
    s_nop 0
    v_mul_f32 v94, v94, v149
    v_mul_f32 v95, v95, v150
    v_cvt_pk_bf16_f32 v148, v94, v95
    v_mov_b32 v152, v144
    v_mov_b32 v153, v148
    ds_write_b64 v70, v[152:153] offset:15392
    v_cvt_pk_bf16_f32 v144, v96, v97
    v_and_b32 v97, 0xffff0000, v144
    v_lshlrev_b32 v96, 16, v144
    v_add_f32 v96, v96, v84
    v_add_f32 v97, v97, v85
    v_cvt_pk_bf16_f32 v144, v96, v97
    v_and_b32 v97, 0xffff0000, v144
    v_lshlrev_b32 v96, 16, v144
    v_mul_f32 v145, v96, v96
    v_fma_f32 v145, v145, s57, v147
    v_mul_f32 v145, v145, v96
    v_exp_f32 v145, -v145
    v_mul_f32 v146, v97, v97
    v_fma_f32 v146, v146, s57, v147
    v_mul_f32 v146, v146, v97
    v_exp_f32 v146, -v146
    s_nop 0
    v_add_f32 v145, 1.0, v145
    v_rcp_f32 v145, v145
    v_add_f32 v146, 1.0, v146
    v_rcp_f32 v146, v146
    s_nop 0
    v_mul_f32 v96, v96, v145
    v_mul_f32 v97, v97, v146
    v_cvt_pk_bf16_f32 v144, v96, v97
    v_cvt_pk_bf16_f32 v148, v98, v99
    v_and_b32 v99, 0xffff0000, v148
    v_lshlrev_b32 v98, 16, v148
    v_add_f32 v98, v98, v86
    v_add_f32 v99, v99, v87
    v_cvt_pk_bf16_f32 v148, v98, v99
    v_and_b32 v99, 0xffff0000, v148
    v_lshlrev_b32 v98, 16, v148
    v_mul_f32 v149, v98, v98
    v_fma_f32 v149, v149, s57, v151
    v_mul_f32 v149, v149, v98
    v_exp_f32 v149, -v149
    v_mul_f32 v150, v99, v99
    v_fma_f32 v150, v150, s57, v151
    v_mul_f32 v150, v150, v99
    v_exp_f32 v150, -v150
    s_nop 0
    v_add_f32 v149, 1.0, v149
    v_rcp_f32 v149, v149
    v_add_f32 v150, 1.0, v150
    v_rcp_f32 v150, v150
    s_nop 0
    v_mul_f32 v98, v98, v149
    v_mul_f32 v99, v99, v150
    v_cvt_pk_bf16_f32 v148, v98, v99
    v_mov_b32 v152, v144
    v_mov_b32 v153, v148
    ds_write_b64 v70, v[152:153] offset:15424
    v_cvt_pk_bf16_f32 v144, v100, v101
    v_and_b32 v101, 0xffff0000, v144
    v_lshlrev_b32 v100, 16, v144
    v_add_f32 v100, v100, v76
    v_add_f32 v101, v101, v77
    v_cvt_pk_bf16_f32 v144, v100, v101
    v_and_b32 v101, 0xffff0000, v144
    v_lshlrev_b32 v100, 16, v144
    v_mul_f32 v145, v100, v100
    v_fma_f32 v145, v145, s57, v147
    v_mul_f32 v145, v145, v100
    v_exp_f32 v145, -v145
    v_mul_f32 v146, v101, v101
    v_fma_f32 v146, v146, s57, v147
    v_mul_f32 v146, v146, v101
    v_exp_f32 v146, -v146
    s_nop 0
    v_add_f32 v145, 1.0, v145
    v_rcp_f32 v145, v145
    v_add_f32 v146, 1.0, v146
    v_rcp_f32 v146, v146
    s_nop 0
    v_mul_f32 v100, v100, v145
    v_mul_f32 v101, v101, v146
    v_cvt_pk_bf16_f32 v144, v100, v101
    v_cvt_pk_bf16_f32 v148, v102, v103
    v_and_b32 v103, 0xffff0000, v148
    v_lshlrev_b32 v102, 16, v148
    v_add_f32 v102, v102, v78
    v_add_f32 v103, v103, v79
    v_cvt_pk_bf16_f32 v148, v102, v103
    v_and_b32 v103, 0xffff0000, v148
    v_lshlrev_b32 v102, 16, v148
    v_mul_f32 v149, v102, v102
    v_fma_f32 v149, v149, s57, v151
    v_mul_f32 v149, v149, v102
    v_exp_f32 v149, -v149
    v_mul_f32 v150, v103, v103
    v_fma_f32 v150, v150, s57, v151
    v_mul_f32 v150, v150, v103
    v_exp_f32 v150, -v150
    s_nop 0
    v_add_f32 v149, 1.0, v149
    v_rcp_f32 v149, v149
    v_add_f32 v150, 1.0, v150
    v_rcp_f32 v150, v150
    s_nop 0
    v_mul_f32 v102, v102, v149
    v_mul_f32 v103, v103, v150
    v_cvt_pk_bf16_f32 v148, v102, v103
    v_mov_b32 v152, v144
    v_mov_b32 v153, v148
    ds_write_b64 v70, v[152:153] offset:21760
    v_cvt_pk_bf16_f32 v144, v104, v105
    v_and_b32 v105, 0xffff0000, v144
    v_lshlrev_b32 v104, 16, v144
    v_add_f32 v104, v104, v80
    v_add_f32 v105, v105, v81
    v_cvt_pk_bf16_f32 v144, v104, v105
    v_and_b32 v105, 0xffff0000, v144
    v_lshlrev_b32 v104, 16, v144
    v_mul_f32 v145, v104, v104
    v_fma_f32 v145, v145, s57, v147
    v_mul_f32 v145, v145, v104
    v_exp_f32 v145, -v145
    v_mul_f32 v146, v105, v105
    v_fma_f32 v146, v146, s57, v147
    v_mul_f32 v146, v146, v105
    v_exp_f32 v146, -v146
    s_nop 0
    v_add_f32 v145, 1.0, v145
    v_rcp_f32 v145, v145
    v_add_f32 v146, 1.0, v146
    v_rcp_f32 v146, v146
    s_nop 0
    v_mul_f32 v104, v104, v145
    v_mul_f32 v105, v105, v146
    v_cvt_pk_bf16_f32 v144, v104, v105
    v_cvt_pk_bf16_f32 v148, v106, v107
    v_and_b32 v107, 0xffff0000, v148
    v_lshlrev_b32 v106, 16, v148
    v_add_f32 v106, v106, v82
    v_add_f32 v107, v107, v83
    v_cvt_pk_bf16_f32 v148, v106, v107
    v_and_b32 v107, 0xffff0000, v148
    v_lshlrev_b32 v106, 16, v148
    v_mul_f32 v149, v106, v106
    v_fma_f32 v149, v149, s57, v151
    v_mul_f32 v149, v149, v106
    v_exp_f32 v149, -v149
    v_mul_f32 v150, v107, v107
    v_fma_f32 v150, v150, s57, v151
    v_mul_f32 v150, v150, v107
    v_exp_f32 v150, -v150
    s_nop 0
    v_add_f32 v149, 1.0, v149
    v_rcp_f32 v149, v149
    v_add_f32 v150, 1.0, v150
    v_rcp_f32 v150, v150
    s_nop 0
    v_mul_f32 v106, v106, v149
    v_mul_f32 v107, v107, v150
    v_cvt_pk_bf16_f32 v148, v106, v107
    v_mov_b32 v152, v144
    v_mov_b32 v153, v148
    ds_write_b64 v70, v[152:153] offset:21792
    v_cvt_pk_bf16_f32 v144, v108, v109
    v_and_b32 v109, 0xffff0000, v144
    v_lshlrev_b32 v108, 16, v144
    v_add_f32 v108, v108, v84
    v_add_f32 v109, v109, v85
    v_cvt_pk_bf16_f32 v144, v108, v109
    v_and_b32 v109, 0xffff0000, v144
    v_lshlrev_b32 v108, 16, v144
    v_mul_f32 v145, v108, v108
    v_fma_f32 v145, v145, s57, v147
    v_mul_f32 v145, v145, v108
    v_exp_f32 v145, -v145
    v_mul_f32 v146, v109, v109
    v_fma_f32 v146, v146, s57, v147
    v_mul_f32 v146, v146, v109
    v_exp_f32 v146, -v146
    s_nop 0
    v_add_f32 v145, 1.0, v145
    v_rcp_f32 v145, v145
    v_add_f32 v146, 1.0, v146
    v_rcp_f32 v146, v146
    s_nop 0
    v_mul_f32 v108, v108, v145
    v_mul_f32 v109, v109, v146
    v_cvt_pk_bf16_f32 v144, v108, v109
    v_cvt_pk_bf16_f32 v148, v110, v111
    v_and_b32 v111, 0xffff0000, v148
    v_lshlrev_b32 v110, 16, v148
    v_add_f32 v110, v110, v86
    v_add_f32 v111, v111, v87
    v_cvt_pk_bf16_f32 v148, v110, v111
    v_and_b32 v111, 0xffff0000, v148
    v_lshlrev_b32 v110, 16, v148
    v_mul_f32 v149, v110, v110
    v_fma_f32 v149, v149, s57, v151
    v_mul_f32 v149, v149, v110
    v_exp_f32 v149, -v149
    v_mul_f32 v150, v111, v111
    v_fma_f32 v150, v150, s57, v151
    v_mul_f32 v150, v150, v111
    v_exp_f32 v150, -v150
    s_nop 0
    v_add_f32 v149, 1.0, v149
    v_rcp_f32 v149, v149
    v_add_f32 v150, 1.0, v150
    v_rcp_f32 v150, v150
    s_nop 0
    v_mul_f32 v110, v110, v149
    v_mul_f32 v111, v111, v150
    v_cvt_pk_bf16_f32 v148, v110, v111
    v_mov_b32 v152, v144
    v_mov_b32 v153, v148
    ds_write_b64 v70, v[152:153] offset:21824
    s_cmp_ge_u32 s54, 3
    s_cbranch_scc1 ga_nf_115
    s_waitcnt lgkmcnt(0)
    s_barrier
    ds_read_b128 v[176:179], v71 offset:15360
    ds_read_b128 v[180:183], v72 offset:15360
    ds_read_b128 v[184:187], v73 offset:15360
    s_waitcnt lgkmcnt(0)
    buffer_store_dwordx4 v[176:179], v74, s[60:63], s55 offen sc1
    buffer_store_dwordx4 v[180:183], v75, s[60:63], s55 offen sc1
    buffer_store_dwordx4 v[184:187], v15, s[60:63], s55 offen sc1
    s_add_u32 s55, s55, s56
    s_waitcnt vmcnt(0)
    s_barrier
    s_cmp_lg_u32 s91, 0
    s_cbranch_scc1 ga_nf2_116
    s_add_u32 s64, s58, s54
    s_add_u32 s93, s64, 0
    s_lshl_b32 s93, s93, 8
    v_mov_b32 v254, s93
    v_mov_b32 v255, 1
    s_mov_b64 s[94:95], exec
    s_mov_b64 exec, 1
    buffer_atomic_add v255, v254, s[28:31], 0 offen
    s_mov_b64 exec, s[94:95]
ga_nf2_116:
ga_nf_115:
    s_add_u32 s54, s54, 1
    s_cmp_lt_u32 s54, 64
    s_cbranch_scc1 ga_loop_h_97
    s_branch ga_tail_98
ga_tail_98:
    s_waitcnt vmcnt(0) lgkmcnt(0)
    s_barrier
    s_cmp_lg_u32 s91, 0
    s_cbranch_scc1 ga_ns1_117
    s_add_u32 s64, s58, 61
    s_add_u32 s93, s64, 0
    s_lshl_b32 s93, s93, 8
    v_mov_b32 v254, s93
    v_mov_b32 v255, 1
    s_mov_b64 s[94:95], exec
    s_mov_b64 exec, 1
    buffer_atomic_add v255, v254, s[28:31], 0 offen
    s_mov_b64 exec, s[94:95]
    s_add_u32 s64, s58, 62
    s_add_u32 s93, s64, 0
    s_lshl_b32 s93, s93, 8
    v_mov_b32 v254, s93
    v_mov_b32 v255, 1
    s_mov_b64 s[94:95], exec
    s_mov_b64 exec, 1
    buffer_atomic_add v255, v254, s[28:31], 0 offen
    s_mov_b64 exec, s[94:95]
ga_ns1_117:
    ds_read_b128 v[176:179], v71 offset:15360
    ds_read_b128 v[180:183], v72 offset:15360
    ds_read_b128 v[184:187], v73 offset:15360
    s_waitcnt lgkmcnt(0)
    buffer_store_dwordx4 v[176:179], v74, s[60:63], s55 offen sc1
    buffer_store_dwordx4 v[180:183], v75, s[60:63], s55 offen sc1
    buffer_store_dwordx4 v[184:187], v15, s[60:63], s55 offen sc1
    s_waitcnt vmcnt(0)
    s_barrier
    s_cmp_lg_u32 s91, 0
    s_cbranch_scc1 ga_ns2_118
    s_add_u32 s64, s58, 63
    s_add_u32 s93, s64, 0
    s_lshl_b32 s93, s93, 8
    v_mov_b32 v254, s93
    v_mov_b32 v255, 1
    s_mov_b64 s[94:95], exec
    s_mov_b64 exec, 1
    buffer_atomic_add v255, v254, s[28:31], 0 offen
    s_mov_b64 exec, s[94:95]
ga_ns2_118:
    s_cmp_ge_u32 s90, 96
    s_cbranch_scc1 wk_att_79
    s_cmp_ge_u32 s90, 64
    s_cbranch_scc1 wk_f2_80
    s_and_b32 s16, s90, 3
    s_bfe_u32 s17, s90, 0x30002
    s_lshr_b32 s54, s90, 5
    s_mov_b32 s53, 2
    s_mov_b32 s52, 64
    s_mov_b32 s44, s10
    s_mov_b32 s45, s11
    s_mov_b32 s46, 0x00780000
    s_mov_b32 s47, 0x00020000
    s_add_u32 s40, s14, 0x06200000
    s_addc_u32 s41, s15, 0
    s_mov_b32 s42, 0x01800000
    s_mov_b32 s43, 0x00020000
    s_add_u32 s60, s14, 0x08000000
    s_addc_u32 s61, s15, 0
    s_mov_b32 s62, 0x01400000
    s_mov_b32 s63, 0x00020000
    s_mov_b32 s51, 1280
    s_lshl_b32 s65, s16, 2
    s_add_u32 s65, s65, s91
    s_mul_i32 s65, s65, 491520
    s_mul_i32 s66, s17, 160
    s_add_u32 s65, s65, s66
    s_mul_i32 s64, s91, 20480
    v_lshl_add_u32 v5, v3, 4, s64
    v_lshrrev_b32 v6, 2, v1
    v_lshl_add_u32 v7, v2, 3, v6
    v_lshlrev_b32 v7, 5, v7
    v_and_b32 v8, 3, v1
    v_lshl_add_u32 v7, v8, 3, v7
    v_add_u32 v7, s64, v7
    v_lshrrev_b32 v10, 1, v3
    v_mul_lo_u32 v10, v10, s51
    v_and_b32 v11, 1, v3
    v_lshl_add_u32 v10, v11, 4, v10
    s_lshl_b32 s66, s51, 5
    s_add_u32 s67, s65, 0
    buffer_load_dwordx4 v[12:15], v10, s[44:47], s67 offen
    s_add_u32 s67, s67, s66
    buffer_load_dwordx4 v[16:19], v10, s[44:47], s67 offen
    s_add_u32 s67, s67, s66
    buffer_load_dwordx4 v[20:23], v10, s[44:47], s67 offen
    s_add_u32 s67, s67, s66
    buffer_load_dwordx4 v[24:27], v10, s[44:47], s67 offen
    s_add_u32 s67, s67, s66
    buffer_load_dwordx4 v[28:31], v10, s[44:47], s67 offen
    s_add_u32 s67, s67, s66
    buffer_load_dwordx4 v[32:35], v10, s[44:47], s67 offen
    s_add_u32 s67, s67, s66
    buffer_load_dwordx4 v[36:39], v10, s[44:47], s67 offen
    s_add_u32 s67, s67, s66
    buffer_load_dwordx4 v[40:43], v10, s[44:47], s67 offen
    s_add_u32 s67, s67, s66
    buffer_load_dwordx4 v[44:47], v10, s[44:47], s67 offen
    s_add_u32 s67, s67, s66
    buffer_load_dwordx4 v[48:51], v10, s[44:47], s67 offen
    s_add_u32 s67, s67, s66
    buffer_load_dwordx4 v[52:55], v10, s[44:47], s67 offen
    s_add_u32 s67, s67, s66
    buffer_load_dwordx4 v[56:59], v10, s[44:47], s67 offen
    s_add_u32 s67, s67, s66
    s_add_u32 s67, s65, 32
    buffer_load_dwordx4 v[60:63], v10, s[44:47], s67 offen
    s_add_u32 s67, s67, s66
    buffer_load_dwordx4 v[64:67], v10, s[44:47], s67 offen
    s_add_u32 s67, s67, s66
    buffer_load_dwordx4 v[68:71], v10, s[44:47], s67 offen
    s_add_u32 s67, s67, s66
    buffer_load_dwordx4 v[72:75], v10, s[44:47], s67 offen
    s_add_u32 s67, s67, s66
    buffer_load_dwordx4 v[76:79], v10, s[44:47], s67 offen
    s_add_u32 s67, s67, s66
    buffer_load_dwordx4 v[80:83], v10, s[44:47], s67 offen
    s_add_u32 s67, s67, s66
    buffer_load_dwordx4 v[84:87], v10, s[44:47], s67 offen
    s_add_u32 s67, s67, s66
    buffer_load_dwordx4 v[88:91], v10, s[44:47], s67 offen
    s_add_u32 s67, s67, s66
    buffer_load_dwordx4 v[92:95], v10, s[44:47], s67 offen
    s_add_u32 s67, s67, s66
    buffer_load_dwordx4 v[96:99], v10, s[44:47], s67 offen
    s_add_u32 s67, s67, s66
    buffer_load_dwordx4 v[100:103], v10, s[44:47], s67 offen
    s_add_u32 s67, s67, s66
    buffer_load_dwordx4 v[104:107], v10, s[44:47], s67 offen
    s_add_u32 s67, s67, s66
    s_add_u32 s67, s65, 64
    buffer_load_dwordx4 v[108:111], v10, s[44:47], s67 offen
    s_add_u32 s67, s67, s66
    buffer_load_dwordx4 v[112:115], v10, s[44:47], s67 offen
    s_add_u32 s67, s67, s66
    buffer_load_dwordx4 v[116:119], v10, s[44:47], s67 offen
    s_add_u32 s67, s67, s66
    buffer_load_dwordx4 v[120:123], v10, s[44:47], s67 offen
    s_add_u32 s67, s67, s66
    buffer_load_dwordx4 v[124:127], v10, s[44:47], s67 offen
    s_add_u32 s67, s67, s66
    buffer_load_dwordx4 v[128:131], v10, s[44:47], s67 offen
    s_add_u32 s67, s67, s66
    buffer_load_dwordx4 v[132:135], v10, s[44:47], s67 offen
    s_add_u32 s67, s67, s66
    buffer_load_dwordx4 v[136:139], v10, s[44:47], s67 offen
    s_add_u32 s67, s67, s66
    buffer_load_dwordx4 v[140:143], v10, s[44:47], s67 offen
    s_add_u32 s67, s67, s66
    buffer_load_dwordx4 v[144:147], v10, s[44:47], s67 offen
    s_add_u32 s67, s67, s66
    buffer_load_dwordx4 v[148:151], v10, s[44:47], s67 offen
    s_add_u32 s67, s67, s66
    buffer_load_dwordx4 v[152:155], v10, s[44:47], s67 offen
    s_add_u32 s67, s67, s66
    s_add_u32 s67, s65, 96
    buffer_load_dwordx4 v[156:159], v10, s[44:47], s67 offen
    s_add_u32 s67, s67, s66
    buffer_load_dwordx4 v[160:163], v10, s[44:47], s67 offen
    s_add_u32 s67, s67, s66
    buffer_load_dwordx4 v[164:167], v10, s[44:47], s67 offen
    s_add_u32 s67, s67, s66
    buffer_load_dwordx4 v[168:171], v10, s[44:47], s67 offen
    s_add_u32 s67, s67, s66
    buffer_load_dwordx4 v[172:175], v10, s[44:47], s67 offen
    s_add_u32 s67, s67, s66
    buffer_load_dwordx4 v[176:179], v10, s[44:47], s67 offen
    s_add_u32 s67, s67, s66
    buffer_load_dwordx4 v[180:183], v10, s[44:47], s67 offen
    s_add_u32 s67, s67, s66
    buffer_load_dwordx4 v[184:187], v10, s[44:47], s67 offen
    s_add_u32 s67, s67, s66
    buffer_load_dwordx4 v[188:191], v10, s[44:47], s67 offen
    s_add_u32 s67, s67, s66
    buffer_load_dwordx4 v[192:195], v10, s[44:47], s67 offen
    s_add_u32 s67, s67, s66
    buffer_load_dwordx4 v[196:199], v10, s[44:47], s67 offen
    s_add_u32 s67, s67, s66
    buffer_load_dwordx4 v[200:203], v10, s[44:47], s67 offen
    s_add_u32 s67, s67, s66
    s_add_u32 s67, s65, 128
    buffer_load_dwordx4 v[204:207], v10, s[44:47], s67 offen
    s_add_u32 s67, s67, s66
    buffer_load_dwordx4 v[208:211], v10, s[44:47], s67 offen
    s_add_u32 s67, s67, s66
    buffer_load_dwordx4 v[212:215], v10, s[44:47], s67 offen
    s_add_u32 s67, s67, s66
    buffer_load_dwordx4 v[216:219], v10, s[44:47], s67 offen
    s_add_u32 s67, s67, s66
    buffer_load_dwordx4 v[220:223], v10, s[44:47], s67 offen
    s_add_u32 s67, s67, s66
    buffer_load_dwordx4 v[224:227], v10, s[44:47], s67 offen
    s_add_u32 s67, s67, s66
    buffer_load_dwordx4 v[228:231], v10, s[44:47], s67 offen
    s_add_u32 s67, s67, s66
    buffer_load_dwordx4 v[232:235], v10, s[44:47], s67 offen
    s_add_u32 s67, s67, s66
    buffer_load_dwordx4 v[236:239], v10, s[44:47], s67 offen
    s_add_u32 s67, s67, s66
    buffer_load_dwordx4 v[240:243], v10, s[44:47], s67 offen
    s_add_u32 s67, s67, s66
    buffer_load_dwordx4 v[244:247], v10, s[44:47], s67 offen
    s_add_u32 s67, s67, s66
    buffer_load_dwordx4 v[248:251], v10, s[44:47], s67 offen
    s_add_u32 s67, s67, s66
    s_waitcnt vmcnt(59)
    ds_write_b128 v5, v[12:15] offset:0
    s_waitcnt vmcnt(58)
    ds_write_b128 v5, v[16:19] offset:1024
    s_waitcnt vmcnt(57)
    ds_write_b128 v5, v[20:23] offset:2048
    s_waitcnt vmcnt(56)
    ds_write_b128 v5, v[24:27] offset:3072
    s_waitcnt vmcnt(55)
    ds_write_b128 v5, v[28:31] offset:4096
    s_waitcnt vmcnt(54)
    ds_write_b128 v5, v[32:35] offset:5120
    s_waitcnt vmcnt(53)
    ds_write_b128 v5, v[36:39] offset:6144
    s_waitcnt vmcnt(52)
    ds_write_b128 v5, v[40:43] offset:7168
    s_waitcnt vmcnt(51)
    ds_write_b128 v5, v[44:47] offset:8192
    s_waitcnt vmcnt(50)
    ds_write_b128 v5, v[48:51] offset:9216
    s_waitcnt vmcnt(49)
    ds_write_b128 v5, v[52:55] offset:10240
    s_waitcnt vmcnt(48)
    ds_write_b128 v5, v[56:59] offset:11264
    s_waitcnt lgkmcnt(0)
    s_waitcnt lgkmcnt(0)
    ds_read_b64_tr_b16 a[0:1], v7 offset:0
    ds_read_b64_tr_b16 a[2:3], v7 offset:128
    ds_read_b64_tr_b16 a[4:5], v7 offset:1024
    ds_read_b64_tr_b16 a[6:7], v7 offset:1152
    ds_read_b64_tr_b16 a[8:9], v7 offset:2048
    ds_read_b64_tr_b16 a[10:11], v7 offset:2176
    ds_read_b64_tr_b16 a[12:13], v7 offset:3072
    ds_read_b64_tr_b16 a[14:15], v7 offset:3200
    ds_read_b64_tr_b16 a[16:17], v7 offset:4096
    ds_read_b64_tr_b16 a[18:19], v7 offset:4224
    ds_read_b64_tr_b16 a[20:21], v7 offset:5120
    ds_read_b64_tr_b16 a[22:23], v7 offset:5248
    s_waitcnt lgkmcnt(0)
    ds_read_b64_tr_b16 a[24:25], v7 offset:6144
    ds_read_b64_tr_b16 a[26:27], v7 offset:6272
    ds_read_b64_tr_b16 a[28:29], v7 offset:7168
    ds_read_b64_tr_b16 a[30:31], v7 offset:7296
    ds_read_b64_tr_b16 a[32:33], v7 offset:8192
    ds_read_b64_tr_b16 a[34:35], v7 offset:8320
    ds_read_b64_tr_b16 a[36:37], v7 offset:9216
    ds_read_b64_tr_b16 a[38:39], v7 offset:9344
    ds_read_b64_tr_b16 a[40:41], v7 offset:10240
    ds_read_b64_tr_b16 a[42:43], v7 offset:10368
    ds_read_b64_tr_b16 a[44:45], v7 offset:11264
    ds_read_b64_tr_b16 a[46:47], v7 offset:11392
    s_waitcnt lgkmcnt(0)
    s_waitcnt lgkmcnt(0)
    s_waitcnt vmcnt(47)
    ds_write_b128 v5, v[60:63] offset:0
    s_waitcnt vmcnt(46)
    ds_write_b128 v5, v[64:67] offset:1024
    s_waitcnt vmcnt(45)
    ds_write_b128 v5, v[68:71] offset:2048
    s_waitcnt vmcnt(44)
    ds_write_b128 v5, v[72:75] offset:3072
    s_waitcnt vmcnt(43)
    ds_write_b128 v5, v[76:79] offset:4096
    s_waitcnt vmcnt(42)
    ds_write_b128 v5, v[80:83] offset:5120
    s_waitcnt vmcnt(41)
    ds_write_b128 v5, v[84:87] offset:6144
    s_waitcnt vmcnt(40)
    ds_write_b128 v5, v[88:91] offset:7168
    s_waitcnt vmcnt(39)
    ds_write_b128 v5, v[92:95] offset:8192
    s_waitcnt vmcnt(38)
    ds_write_b128 v5, v[96:99] offset:9216
    s_waitcnt vmcnt(37)
    ds_write_b128 v5, v[100:103] offset:10240
    s_waitcnt vmcnt(36)
    ds_write_b128 v5, v[104:107] offset:11264
    s_waitcnt lgkmcnt(0)
    s_waitcnt lgkmcnt(0)
    ds_read_b64_tr_b16 a[48:49], v7 offset:0
    ds_read_b64_tr_b16 a[50:51], v7 offset:128
    ds_read_b64_tr_b16 a[52:53], v7 offset:1024
    ds_read_b64_tr_b16 a[54:55], v7 offset:1152
    ds_read_b64_tr_b16 a[56:57], v7 offset:2048
    ds_read_b64_tr_b16 a[58:59], v7 offset:2176
    ds_read_b64_tr_b16 a[60:61], v7 offset:3072
    ds_read_b64_tr_b16 a[62:63], v7 offset:3200
    ds_read_b64_tr_b16 a[64:65], v7 offset:4096
    ds_read_b64_tr_b16 a[66:67], v7 offset:4224
    ds_read_b64_tr_b16 a[68:69], v7 offset:5120
    ds_read_b64_tr_b16 a[70:71], v7 offset:5248
    s_waitcnt lgkmcnt(0)
    ds_read_b64_tr_b16 a[72:73], v7 offset:6144
    ds_read_b64_tr_b16 a[74:75], v7 offset:6272
    ds_read_b64_tr_b16 a[76:77], v7 offset:7168
    ds_read_b64_tr_b16 a[78:79], v7 offset:7296
    ds_read_b64_tr_b16 a[80:81], v7 offset:8192
    ds_read_b64_tr_b16 a[82:83], v7 offset:8320
    ds_read_b64_tr_b16 a[84:85], v7 offset:9216
    ds_read_b64_tr_b16 a[86:87], v7 offset:9344
    ds_read_b64_tr_b16 a[88:89], v7 offset:10240
    ds_read_b64_tr_b16 a[90:91], v7 offset:10368
    ds_read_b64_tr_b16 a[92:93], v7 offset:11264
    ds_read_b64_tr_b16 a[94:95], v7 offset:11392
    s_waitcnt lgkmcnt(0)
    s_waitcnt lgkmcnt(0)
    s_waitcnt vmcnt(35)
    ds_write_b128 v5, v[108:111] offset:0
    s_waitcnt vmcnt(34)
    ds_write_b128 v5, v[112:115] offset:1024
    s_waitcnt vmcnt(33)
    ds_write_b128 v5, v[116:119] offset:2048
    s_waitcnt vmcnt(32)
    ds_write_b128 v5, v[120:123] offset:3072
    s_waitcnt vmcnt(31)
    ds_write_b128 v5, v[124:127] offset:4096
    s_waitcnt vmcnt(30)
    ds_write_b128 v5, v[128:131] offset:5120
    s_waitcnt vmcnt(29)
    ds_write_b128 v5, v[132:135] offset:6144
    s_waitcnt vmcnt(28)
    ds_write_b128 v5, v[136:139] offset:7168
    s_waitcnt vmcnt(27)
    ds_write_b128 v5, v[140:143] offset:8192
    s_waitcnt vmcnt(26)
    ds_write_b128 v5, v[144:147] offset:9216
    s_waitcnt vmcnt(25)
    ds_write_b128 v5, v[148:151] offset:10240
    s_waitcnt vmcnt(24)
    ds_write_b128 v5, v[152:155] offset:11264
    s_waitcnt lgkmcnt(0)
    s_waitcnt lgkmcnt(0)
    ds_read_b64_tr_b16 a[96:97], v7 offset:0
    ds_read_b64_tr_b16 a[98:99], v7 offset:128
    ds_read_b64_tr_b16 a[100:101], v7 offset:1024
    ds_read_b64_tr_b16 a[102:103], v7 offset:1152
    ds_read_b64_tr_b16 a[104:105], v7 offset:2048
    ds_read_b64_tr_b16 a[106:107], v7 offset:2176
    ds_read_b64_tr_b16 a[108:109], v7 offset:3072
    ds_read_b64_tr_b16 a[110:111], v7 offset:3200
    ds_read_b64_tr_b16 a[112:113], v7 offset:4096
    ds_read_b64_tr_b16 a[114:115], v7 offset:4224
    ds_read_b64_tr_b16 a[116:117], v7 offset:5120
    ds_read_b64_tr_b16 a[118:119], v7 offset:5248
    s_waitcnt lgkmcnt(0)
    ds_read_b64_tr_b16 a[120:121], v7 offset:6144
    ds_read_b64_tr_b16 a[122:123], v7 offset:6272
    ds_read_b64_tr_b16 a[124:125], v7 offset:7168
    ds_read_b64_tr_b16 a[126:127], v7 offset:7296
    ds_read_b64_tr_b16 a[128:129], v7 offset:8192
    ds_read_b64_tr_b16 a[130:131], v7 offset:8320
    ds_read_b64_tr_b16 a[132:133], v7 offset:9216
    ds_read_b64_tr_b16 a[134:135], v7 offset:9344
    ds_read_b64_tr_b16 a[136:137], v7 offset:10240
    ds_read_b64_tr_b16 a[138:139], v7 offset:10368
    ds_read_b64_tr_b16 a[140:141], v7 offset:11264
    ds_read_b64_tr_b16 a[142:143], v7 offset:11392
    s_waitcnt lgkmcnt(0)
    s_waitcnt lgkmcnt(0)
    s_waitcnt vmcnt(23)
    ds_write_b128 v5, v[156:159] offset:0
    s_waitcnt vmcnt(22)
    ds_write_b128 v5, v[160:163] offset:1024
    s_waitcnt vmcnt(21)
    ds_write_b128 v5, v[164:167] offset:2048
    s_waitcnt vmcnt(20)
    ds_write_b128 v5, v[168:171] offset:3072
    s_waitcnt vmcnt(19)
    ds_write_b128 v5, v[172:175] offset:4096
    s_waitcnt vmcnt(18)
    ds_write_b128 v5, v[176:179] offset:5120
    s_waitcnt vmcnt(17)
    ds_write_b128 v5, v[180:183] offset:6144
    s_waitcnt vmcnt(16)
    ds_write_b128 v5, v[184:187] offset:7168
    s_waitcnt vmcnt(15)
    ds_write_b128 v5, v[188:191] offset:8192
    s_waitcnt vmcnt(14)
    ds_write_b128 v5, v[192:195] offset:9216
    s_waitcnt vmcnt(13)
    ds_write_b128 v5, v[196:199] offset:10240
    s_waitcnt vmcnt(12)
    ds_write_b128 v5, v[200:203] offset:11264
    s_waitcnt lgkmcnt(0)
    s_waitcnt lgkmcnt(0)
    ds_read_b64_tr_b16 a[144:145], v7 offset:0
    ds_read_b64_tr_b16 a[146:147], v7 offset:128
    ds_read_b64_tr_b16 a[148:149], v7 offset:1024
    ds_read_b64_tr_b16 a[150:151], v7 offset:1152
    ds_read_b64_tr_b16 a[152:153], v7 offset:2048
    ds_read_b64_tr_b16 a[154:155], v7 offset:2176
    ds_read_b64_tr_b16 a[156:157], v7 offset:3072
    ds_read_b64_tr_b16 a[158:159], v7 offset:3200
    ds_read_b64_tr_b16 a[160:161], v7 offset:4096
    ds_read_b64_tr_b16 a[162:163], v7 offset:4224
    ds_read_b64_tr_b16 a[164:165], v7 offset:5120
    ds_read_b64_tr_b16 a[166:167], v7 offset:5248
    s_waitcnt lgkmcnt(0)
    ds_read_b64_tr_b16 a[168:169], v7 offset:6144
    ds_read_b64_tr_b16 a[170:171], v7 offset:6272
    ds_read_b64_tr_b16 a[172:173], v7 offset:7168
    ds_read_b64_tr_b16 a[174:175], v7 offset:7296
    ds_read_b64_tr_b16 a[176:177], v7 offset:8192
    ds_read_b64_tr_b16 a[178:179], v7 offset:8320
    ds_read_b64_tr_b16 a[180:181], v7 offset:9216
    ds_read_b64_tr_b16 a[182:183], v7 offset:9344
    ds_read_b64_tr_b16 a[184:185], v7 offset:10240
    ds_read_b64_tr_b16 a[186:187], v7 offset:10368
    ds_read_b64_tr_b16 a[188:189], v7 offset:11264
    ds_read_b64_tr_b16 a[190:191], v7 offset:11392
    s_waitcnt lgkmcnt(0)
    s_waitcnt lgkmcnt(0)
    s_waitcnt vmcnt(11)
    ds_write_b128 v5, v[204:207] offset:0
    s_waitcnt vmcnt(10)
    ds_write_b128 v5, v[208:211] offset:1024
    s_waitcnt vmcnt(9)
    ds_write_b128 v5, v[212:215] offset:2048
    s_waitcnt vmcnt(8)
    ds_write_b128 v5, v[216:219] offset:3072
    s_waitcnt vmcnt(7)
    ds_write_b128 v5, v[220:223] offset:4096
    s_waitcnt vmcnt(6)
    ds_write_b128 v5, v[224:227] offset:5120
    s_waitcnt vmcnt(5)
    ds_write_b128 v5, v[228:231] offset:6144
    s_waitcnt vmcnt(4)
    ds_write_b128 v5, v[232:235] offset:7168
    s_waitcnt vmcnt(3)
    ds_write_b128 v5, v[236:239] offset:8192
    s_waitcnt vmcnt(2)
    ds_write_b128 v5, v[240:243] offset:9216
    s_waitcnt vmcnt(1)
    ds_write_b128 v5, v[244:247] offset:10240
    s_waitcnt vmcnt(0)
    ds_write_b128 v5, v[248:251] offset:11264
    s_waitcnt lgkmcnt(0)
    s_waitcnt lgkmcnt(0)
    ds_read_b64_tr_b16 a[192:193], v7 offset:0
    ds_read_b64_tr_b16 a[194:195], v7 offset:128
    ds_read_b64_tr_b16 a[196:197], v7 offset:1024
    ds_read_b64_tr_b16 a[198:199], v7 offset:1152
    ds_read_b64_tr_b16 a[200:201], v7 offset:2048
    ds_read_b64_tr_b16 a[202:203], v7 offset:2176
    ds_read_b64_tr_b16 a[204:205], v7 offset:3072
    ds_read_b64_tr_b16 a[206:207], v7 offset:3200
    ds_read_b64_tr_b16 a[208:209], v7 offset:4096
    ds_read_b64_tr_b16 a[210:211], v7 offset:4224
    ds_read_b64_tr_b16 a[212:213], v7 offset:5120
    ds_read_b64_tr_b16 a[214:215], v7 offset:5248
    s_waitcnt lgkmcnt(0)
    ds_read_b64_tr_b16 a[216:217], v7 offset:6144
    ds_read_b64_tr_b16 a[218:219], v7 offset:6272
    ds_read_b64_tr_b16 a[220:221], v7 offset:7168
    ds_read_b64_tr_b16 a[222:223], v7 offset:7296
    ds_read_b64_tr_b16 a[224:225], v7 offset:8192
    ds_read_b64_tr_b16 a[226:227], v7 offset:8320
    ds_read_b64_tr_b16 a[228:229], v7 offset:9216
    ds_read_b64_tr_b16 a[230:231], v7 offset:9344
    ds_read_b64_tr_b16 a[232:233], v7 offset:10240
    ds_read_b64_tr_b16 a[234:235], v7 offset:10368
    ds_read_b64_tr_b16 a[236:237], v7 offset:11264
    ds_read_b64_tr_b16 a[238:239], v7 offset:11392
    s_waitcnt lgkmcnt(0)
    s_waitcnt lgkmcnt(0)
    v_lshlrev_b32 v4, 6, v1
    v_lshl_add_u32 v4, v2, 4, v4
    s_mul_i32 s64, s16, 48
    s_mul_i32 s65, s91, 12
    s_add_u32 s64, s64, s65
    s_lshl_b32 s50, s64, 11
    s_mul_i32 s64, s91, 10240
    v_lshl_add_u32 v5, v3, 4, s64
    v_lshlrev_b32 v6, 4, v3
    v_mul_u32_u24 v7, 2560, v1
    s_mul_i32 s64, s17, 320
    v_lshl_add_u32 v7, v2, 4, v7
    v_add_u32 v7, s64, v7
    s_barrier
    s_add_u32 s93, s54, 192
    s_lshl_b32 s93, s93, 8
    v_mov_b32 v254, s93
wk_poll_119:
    buffer_load_dword v255, v254, s[28:31], 0 offen sc1
    s_waitcnt vmcnt(0)
    v_cmp_le_u32 vcc, 8, v255
    s_cbranch_vccnz wk_ok_120
    s_sleep 2
    s_add_u32 s92, s92, 1
    s_cmp_lt_u32 s92, 1048576
    s_cbranch_scc1 wk_poll_119
wk_ok_120:
    s_mul_i32 s48, s54, 393216
    s_add_u32 s48, s48, s50
    buffer_load_dwordx4 v[12:15], v4, s[40:43], s48 offen sc1
    s_add_u32 s48, s48, 1024
    buffer_load_dwordx4 v[16:19], v4, s[40:43], s48 offen sc1
    s_add_u32 s48, s48, 1024
    buffer_load_dwordx4 v[20:23], v4, s[40:43], s48 offen sc1
    s_add_u32 s48, s48, 1024
    buffer_load_dwordx4 v[24:27], v4, s[40:43], s48 offen sc1
    s_add_u32 s48, s48, 1024
    buffer_load_dwordx4 v[28:31], v4, s[40:43], s48 offen sc1
    s_add_u32 s48, s48, 1024
    buffer_load_dwordx4 v[32:35], v4, s[40:43], s48 offen sc1
    s_add_u32 s48, s48, 1024
    buffer_load_dwordx4 v[36:39], v4, s[40:43], s48 offen sc1
    s_add_u32 s48, s48, 1024
    buffer_load_dwordx4 v[40:43], v4, s[40:43], s48 offen sc1
    s_add_u32 s48, s48, 1024
    buffer_load_dwordx4 v[44:47], v4, s[40:43], s48 offen sc1
    s_add_u32 s48, s48, 1024
    buffer_load_dwordx4 v[48:51], v4, s[40:43], s48 offen sc1
    s_add_u32 s48, s48, 1024
    buffer_load_dwordx4 v[52:55], v4, s[40:43], s48 offen sc1
    s_add_u32 s48, s48, 1024
    buffer_load_dwordx4 v[56:59], v4, s[40:43], s48 offen sc1
    s_add_u32 s48, s48, 1024
    buffer_load_dwordx4 v[60:63], v4, s[40:43], s48 offen sc1
    s_add_u32 s48, s48, 1024
    buffer_load_dwordx4 v[64:67], v4, s[40:43], s48 offen sc1
    s_add_u32 s48, s48, 1024
    buffer_load_dwordx4 v[68:71], v4, s[40:43], s48 offen sc1
    s_add_u32 s48, s48, 1024
    buffer_load_dwordx4 v[72:75], v4, s[40:43], s48 offen sc1
    s_add_u32 s48, s48, 1024
    buffer_load_dwordx4 v[76:79], v4, s[40:43], s48 offen sc1
    s_add_u32 s48, s48, 1024
    buffer_load_dwordx4 v[80:83], v4, s[40:43], s48 offen sc1
    s_add_u32 s48, s48, 1024
    buffer_load_dwordx4 v[84:87], v4, s[40:43], s48 offen sc1
    s_add_u32 s48, s48, 1024
    buffer_load_dwordx4 v[88:91], v4, s[40:43], s48 offen sc1
    s_add_u32 s48, s48, 1024
    buffer_load_dwordx4 v[92:95], v4, s[40:43], s48 offen sc1
    s_add_u32 s48, s48, 1024
    buffer_load_dwordx4 v[96:99], v4, s[40:43], s48 offen sc1
    s_add_u32 s48, s48, 1024
    buffer_load_dwordx4 v[100:103], v4, s[40:43], s48 offen sc1
    s_add_u32 s48, s48, 1024
    buffer_load_dwordx4 v[104:107], v4, s[40:43], s48 offen sc1
    s_add_u32 s48, s48, 1024
gk_loop_121:
    s_waitcnt vmcnt(0)
    s_add_u32 s57, s54, s53
    s_cmp_ge_u32 s57, s52
    s_cbranch_scc1 gk_nf_123
    s_add_u32 s93, s57, 192
    s_lshl_b32 s93, s93, 8
    v_mov_b32 v254, s93
wk_poll_124:
    buffer_load_dword v255, v254, s[28:31], 0 offen sc1
    s_waitcnt vmcnt(0)
    v_cmp_le_u32 vcc, 8, v255
    s_cbranch_vccnz wk_ok_125
    s_sleep 2
    s_add_u32 s92, s92, 1
    s_cmp_lt_u32 s92, 1048576
    s_cbranch_scc1 wk_poll_124
wk_ok_125:
    s_mul_i32 s48, s57, 393216
    s_add_u32 s48, s48, s50
    buffer_load_dwordx4 v[108:111], v4, s[40:43], s48 offen sc1
    s_add_u32 s48, s48, 1024
    buffer_load_dwordx4 v[112:115], v4, s[40:43], s48 offen sc1
    s_add_u32 s48, s48, 1024
    buffer_load_dwordx4 v[116:119], v4, s[40:43], s48 offen sc1
    s_add_u32 s48, s48, 1024
    buffer_load_dwordx4 v[120:123], v4, s[40:43], s48 offen sc1
    s_add_u32 s48, s48, 1024
    buffer_load_dwordx4 v[124:127], v4, s[40:43], s48 offen sc1
    s_add_u32 s48, s48, 1024
    buffer_load_dwordx4 v[128:131], v4, s[40:43], s48 offen sc1
    s_add_u32 s48, s48, 1024
    buffer_load_dwordx4 v[132:135], v4, s[40:43], s48 offen sc1
    s_add_u32 s48, s48, 1024
    buffer_load_dwordx4 v[136:139], v4, s[40:43], s48 offen sc1
    s_add_u32 s48, s48, 1024
    buffer_load_dwordx4 v[140:143], v4, s[40:43], s48 offen sc1
    s_add_u32 s48, s48, 1024
    buffer_load_dwordx4 v[144:147], v4, s[40:43], s48 offen sc1
    s_add_u32 s48, s48, 1024
    buffer_load_dwordx4 v[148:151], v4, s[40:43], s48 offen sc1
    s_add_u32 s48, s48, 1024
    buffer_load_dwordx4 v[152:155], v4, s[40:43], s48 offen sc1
    s_add_u32 s48, s48, 1024
    buffer_load_dwordx4 v[156:159], v4, s[40:43], s48 offen sc1
    s_add_u32 s48, s48, 1024
    buffer_load_dwordx4 v[160:163], v4, s[40:43], s48 offen sc1
    s_add_u32 s48, s48, 1024
    buffer_load_dwordx4 v[164:167], v4, s[40:43], s48 offen sc1
    s_add_u32 s48, s48, 1024
    buffer_load_dwordx4 v[168:171], v4, s[40:43], s48 offen sc1
    s_add_u32 s48, s48, 1024
    buffer_load_dwordx4 v[172:175], v4, s[40:43], s48 offen sc1
    s_add_u32 s48, s48, 1024
    buffer_load_dwordx4 v[176:179], v4, s[40:43], s48 offen sc1
    s_add_u32 s48, s48, 1024
    buffer_load_dwordx4 v[180:183], v4, s[40:43], s48 offen sc1
    s_add_u32 s48, s48, 1024
    buffer_load_dwordx4 v[184:187], v4, s[40:43], s48 offen sc1
    s_add_u32 s48, s48, 1024
    buffer_load_dwordx4 v[188:191], v4, s[40:43], s48 offen sc1
    s_add_u32 s48, s48, 1024
    buffer_load_dwordx4 v[192:195], v4, s[40:43], s48 offen sc1
    s_add_u32 s48, s48, 1024
    buffer_load_dwordx4 v[196:199], v4, s[40:43], s48 offen sc1
    s_add_u32 s48, s48, 1024
    buffer_load_dwordx4 v[200:203], v4, s[40:43], s48 offen sc1
    s_add_u32 s48, s48, 1024
gk_nf_123:
    v_mfma_f32_16x16x32_bf16 v[204:207], a[0:3], v[12:15], 0
    v_mfma_f32_16x16x32_bf16 v[208:211], a[48:51], v[12:15], 0
    v_mfma_f32_16x16x32_bf16 v[212:215], a[96:99], v[12:15], 0
    v_mfma_f32_16x16x32_bf16 v[216:219], a[144:147], v[12:15], 0
    v_mfma_f32_16x16x32_bf16 v[220:223], a[192:195], v[12:15], 0
    v_mfma_f32_16x16x32_bf16 v[224:227], a[0:3], v[16:19], 0
    v_mfma_f32_16x16x32_bf16 v[228:231], a[48:51], v[16:19], 0
    v_mfma_f32_16x16x32_bf16 v[232:235], a[96:99], v[16:19], 0
    v_mfma_f32_16x16x32_bf16 v[236:239], a[144:147], v[16:19], 0
    v_mfma_f32_16x16x32_bf16 v[240:243], a[192:195], v[16:19], 0
    v_mfma_f32_16x16x32_bf16 v[204:207], a[4:7], v[20:23], v[204:207]
    v_mfma_f32_16x16x32_bf16 v[208:211], a[52:55], v[20:23], v[208:211]
    v_mfma_f32_16x16x32_bf16 v[212:215], a[100:103], v[20:23], v[212:215]
    v_mfma_f32_16x16x32_bf16 v[216:219], a[148:151], v[20:23], v[216:219]
    v_mfma_f32_16x16x32_bf16 v[220:223], a[196:199], v[20:23], v[220:223]
    v_mfma_f32_16x16x32_bf16 v[224:227], a[4:7], v[24:27], v[224:227]
    v_mfma_f32_16x16x32_bf16 v[228:231], a[52:55], v[24:27], v[228:231]
    v_mfma_f32_16x16x32_bf16 v[232:235], a[100:103], v[24:27], v[232:235]
    v_mfma_f32_16x16x32_bf16 v[236:239], a[148:151], v[24:27], v[236:239]
    v_mfma_f32_16x16x32_bf16 v[240:243], a[196:199], v[24:27], v[240:243]
    v_mfma_f32_16x16x32_bf16 v[204:207], a[8:11], v[28:31], v[204:207]
    v_mfma_f32_16x16x32_bf16 v[208:211], a[56:59], v[28:31], v[208:211]
    v_mfma_f32_16x16x32_bf16 v[212:215], a[104:107], v[28:31], v[212:215]
    v_mfma_f32_16x16x32_bf16 v[216:219], a[152:155], v[28:31], v[216:219]
    v_mfma_f32_16x16x32_bf16 v[220:223], a[200:203], v[28:31], v[220:223]
    v_mfma_f32_16x16x32_bf16 v[224:227], a[8:11], v[32:35], v[224:227]
    v_mfma_f32_16x16x32_bf16 v[228:231], a[56:59], v[32:35], v[228:231]
    v_mfma_f32_16x16x32_bf16 v[232:235], a[104:107], v[32:35], v[232:235]
    v_mfma_f32_16x16x32_bf16 v[236:239], a[152:155], v[32:35], v[236:239]
    v_mfma_f32_16x16x32_bf16 v[240:243], a[200:203], v[32:35], v[240:243]
    v_mfma_f32_16x16x32_bf16 v[204:207], a[12:15], v[36:39], v[204:207]
    v_mfma_f32_16x16x32_bf16 v[208:211], a[60:63], v[36:39], v[208:211]
    v_mfma_f32_16x16x32_bf16 v[212:215], a[108:111], v[36:39], v[212:215]
    v_mfma_f32_16x16x32_bf16 v[216:219], a[156:159], v[36:39], v[216:219]
    v_mfma_f32_16x16x32_bf16 v[220:223], a[204:207], v[36:39], v[220:223]
    v_mfma_f32_16x16x32_bf16 v[224:227], a[12:15], v[40:43], v[224:227]
    v_mfma_f32_16x16x32_bf16 v[228:231], a[60:63], v[40:43], v[228:231]
    v_mfma_f32_16x16x32_bf16 v[232:235], a[108:111], v[40:43], v[232:235]
    v_mfma_f32_16x16x32_bf16 v[236:239], a[156:159], v[40:43], v[236:239]
    v_mfma_f32_16x16x32_bf16 v[240:243], a[204:207], v[40:43], v[240:243]
    v_mfma_f32_16x16x32_bf16 v[204:207], a[16:19], v[44:47], v[204:207]
    v_mfma_f32_16x16x32_bf16 v[208:211], a[64:67], v[44:47], v[208:211]
    v_mfma_f32_16x16x32_bf16 v[212:215], a[112:115], v[44:47], v[212:215]
    v_mfma_f32_16x16x32_bf16 v[216:219], a[160:163], v[44:47], v[216:219]
    v_mfma_f32_16x16x32_bf16 v[220:223], a[208:211], v[44:47], v[220:223]
    v_mfma_f32_16x16x32_bf16 v[224:227], a[16:19], v[48:51], v[224:227]
    v_mfma_f32_16x16x32_bf16 v[228:231], a[64:67], v[48:51], v[228:231]
    v_mfma_f32_16x16x32_bf16 v[232:235], a[112:115], v[48:51], v[232:235]
    v_mfma_f32_16x16x32_bf16 v[236:239], a[160:163], v[48:51], v[236:239]
    v_mfma_f32_16x16x32_bf16 v[240:243], a[208:211], v[48:51], v[240:243]
    v_mfma_f32_16x16x32_bf16 v[204:207], a[20:23], v[52:55], v[204:207]
    v_mfma_f32_16x16x32_bf16 v[208:211], a[68:71], v[52:55], v[208:211]
    v_mfma_f32_16x16x32_bf16 v[212:215], a[116:119], v[52:55], v[212:215]
    v_mfma_f32_16x16x32_bf16 v[216:219], a[164:167], v[52:55], v[216:219]
    v_mfma_f32_16x16x32_bf16 v[220:223], a[212:215], v[52:55], v[220:223]
    v_mfma_f32_16x16x32_bf16 v[224:227], a[20:23], v[56:59], v[224:227]
    v_mfma_f32_16x16x32_bf16 v[228:231], a[68:71], v[56:59], v[228:231]
    v_mfma_f32_16x16x32_bf16 v[232:235], a[116:119], v[56:59], v[232:235]
    v_mfma_f32_16x16x32_bf16 v[236:239], a[164:167], v[56:59], v[236:239]
    v_mfma_f32_16x16x32_bf16 v[240:243], a[212:215], v[56:59], v[240:243]
    v_mfma_f32_16x16x32_bf16 v[204:207], a[24:27], v[60:63], v[204:207]
    v_mfma_f32_16x16x32_bf16 v[208:211], a[72:75], v[60:63], v[208:211]
    v_mfma_f32_16x16x32_bf16 v[212:215], a[120:123], v[60:63], v[212:215]
    v_mfma_f32_16x16x32_bf16 v[216:219], a[168:171], v[60:63], v[216:219]
    v_mfma_f32_16x16x32_bf16 v[220:223], a[216:219], v[60:63], v[220:223]
    v_mfma_f32_16x16x32_bf16 v[224:227], a[24:27], v[64:67], v[224:227]
    v_mfma_f32_16x16x32_bf16 v[228:231], a[72:75], v[64:67], v[228:231]
    v_mfma_f32_16x16x32_bf16 v[232:235], a[120:123], v[64:67], v[232:235]
    v_mfma_f32_16x16x32_bf16 v[236:239], a[168:171], v[64:67], v[236:239]
    v_mfma_f32_16x16x32_bf16 v[240:243], a[216:219], v[64:67], v[240:243]
    v_mfma_f32_16x16x32_bf16 v[204:207], a[28:31], v[68:71], v[204:207]
    v_mfma_f32_16x16x32_bf16 v[208:211], a[76:79], v[68:71], v[208:211]
    v_mfma_f32_16x16x32_bf16 v[212:215], a[124:127], v[68:71], v[212:215]
    v_mfma_f32_16x16x32_bf16 v[216:219], a[172:175], v[68:71], v[216:219]
    v_mfma_f32_16x16x32_bf16 v[220:223], a[220:223], v[68:71], v[220:223]
    v_mfma_f32_16x16x32_bf16 v[224:227], a[28:31], v[72:75], v[224:227]
    v_mfma_f32_16x16x32_bf16 v[228:231], a[76:79], v[72:75], v[228:231]
    v_mfma_f32_16x16x32_bf16 v[232:235], a[124:127], v[72:75], v[232:235]
    v_mfma_f32_16x16x32_bf16 v[236:239], a[172:175], v[72:75], v[236:239]
    v_mfma_f32_16x16x32_bf16 v[240:243], a[220:223], v[72:75], v[240:243]
    v_mfma_f32_16x16x32_bf16 v[204:207], a[32:35], v[76:79], v[204:207]
    v_mfma_f32_16x16x32_bf16 v[208:211], a[80:83], v[76:79], v[208:211]
    v_mfma_f32_16x16x32_bf16 v[212:215], a[128:131], v[76:79], v[212:215]
    v_mfma_f32_16x16x32_bf16 v[216:219], a[176:179], v[76:79], v[216:219]
    v_mfma_f32_16x16x32_bf16 v[220:223], a[224:227], v[76:79], v[220:223]
    v_mfma_f32_16x16x32_bf16 v[224:227], a[32:35], v[80:83], v[224:227]
    v_mfma_f32_16x16x32_bf16 v[228:231], a[80:83], v[80:83], v[228:231]
    v_mfma_f32_16x16x32_bf16 v[232:235], a[128:131], v[80:83], v[232:235]
    v_mfma_f32_16x16x32_bf16 v[236:239], a[176:179], v[80:83], v[236:239]
    v_mfma_f32_16x16x32_bf16 v[240:243], a[224:227], v[80:83], v[240:243]
    v_mfma_f32_16x16x32_bf16 v[204:207], a[36:39], v[84:87], v[204:207]
    v_mfma_f32_16x16x32_bf16 v[208:211], a[84:87], v[84:87], v[208:211]
    v_mfma_f32_16x16x32_bf16 v[212:215], a[132:135], v[84:87], v[212:215]
    v_mfma_f32_16x16x32_bf16 v[216:219], a[180:183], v[84:87], v[216:219]
    v_mfma_f32_16x16x32_bf16 v[220:223], a[228:231], v[84:87], v[220:223]
    v_mfma_f32_16x16x32_bf16 v[224:227], a[36:39], v[88:91], v[224:227]
    v_mfma_f32_16x16x32_bf16 v[228:231], a[84:87], v[88:91], v[228:231]
    v_mfma_f32_16x16x32_bf16 v[232:235], a[132:135], v[88:91], v[232:235]
    v_mfma_f32_16x16x32_bf16 v[236:239], a[180:183], v[88:91], v[236:239]
    v_mfma_f32_16x16x32_bf16 v[240:243], a[228:231], v[88:91], v[240:243]
    v_mfma_f32_16x16x32_bf16 v[204:207], a[40:43], v[92:95], v[204:207]
    v_mfma_f32_16x16x32_bf16 v[208:211], a[88:91], v[92:95], v[208:211]
    v_mfma_f32_16x16x32_bf16 v[212:215], a[136:139], v[92:95], v[212:215]
    v_mfma_f32_16x16x32_bf16 v[216:219], a[184:187], v[92:95], v[216:219]
    v_mfma_f32_16x16x32_bf16 v[220:223], a[232:235], v[92:95], v[220:223]
    v_mfma_f32_16x16x32_bf16 v[224:227], a[40:43], v[96:99], v[224:227]
    v_mfma_f32_16x16x32_bf16 v[228:231], a[88:91], v[96:99], v[228:231]
    v_mfma_f32_16x16x32_bf16 v[232:235], a[136:139], v[96:99], v[232:235]
    v_mfma_f32_16x16x32_bf16 v[236:239], a[184:187], v[96:99], v[236:239]
    v_mfma_f32_16x16x32_bf16 v[240:243], a[232:235], v[96:99], v[240:243]
    v_mfma_f32_16x16x32_bf16 v[204:207], a[44:47], v[100:103], v[204:207]
    v_mfma_f32_16x16x32_bf16 v[208:211], a[92:95], v[100:103], v[208:211]
    v_mfma_f32_16x16x32_bf16 v[212:215], a[140:143], v[100:103], v[212:215]
    v_mfma_f32_16x16x32_bf16 v[216:219], a[188:191], v[100:103], v[216:219]
    v_mfma_f32_16x16x32_bf16 v[220:223], a[236:239], v[100:103], v[220:223]
    v_mfma_f32_16x16x32_bf16 v[224:227], a[44:47], v[104:107], v[224:227]
    v_mfma_f32_16x16x32_bf16 v[228:231], a[92:95], v[104:107], v[228:231]
    v_mfma_f32_16x16x32_bf16 v[232:235], a[140:143], v[104:107], v[232:235]
    v_mfma_f32_16x16x32_bf16 v[236:239], a[188:191], v[104:107], v[236:239]
    v_mfma_f32_16x16x32_bf16 v[240:243], a[236:239], v[104:107], v[240:243]
    s_nop 7
    ds_write_b128 v5, v[204:207] offset:0
    ds_write_b128 v5, v[208:211] offset:1024
    ds_write_b128 v5, v[212:215] offset:2048
    ds_write_b128 v5, v[216:219] offset:3072
    ds_write_b128 v5, v[220:223] offset:4096
    ds_write_b128 v5, v[224:227] offset:5120
    ds_write_b128 v5, v[228:231] offset:6144
    ds_write_b128 v5, v[232:235] offset:7168
    ds_write_b128 v5, v[236:239] offset:8192
    ds_write_b128 v5, v[240:243] offset:9216
    s_waitcnt lgkmcnt(0)
    s_barrier
    s_mul_i32 s55, s54, 81920
    s_mul_i32 s64, s16, 5242880
    s_add_u32 s55, s55, s64
    s_cmp_lg_u32 s91, 0
    s_cbranch_scc1 gk_w_127
    ds_read_b128 v[12:15], v6 offset:0
    ds_read_b128 v[16:19], v6 offset:10240
    ds_read_b128 v[20:23], v6 offset:20480
    ds_read_b128 v[24:27], v6 offset:30720
    ds_read_b128 v[28:31], v6 offset:4096
    ds_read_b128 v[32:35], v6 offset:14336
    ds_read_b128 v[36:39], v6 offset:24576
    ds_read_b128 v[40:43], v6 offset:34816
    ds_read_b128 v[44:47], v6 offset:8192
    ds_read_b128 v[48:51], v6 offset:18432
    ds_read_b128 v[52:55], v6 offset:28672
    ds_read_b128 v[56:59], v6 offset:38912
    s_waitcnt lgkmcnt(8)
    v_pk_add_f32 v[12:13], v[12:13], v[16:17]
    v_pk_add_f32 v[20:21], v[20:21], v[24:25]
    v_pk_add_f32 v[14:15], v[14:15], v[18:19]
    v_pk_add_f32 v[22:23], v[22:23], v[26:27]
    v_pk_add_f32 v[12:13], v[12:13], v[20:21]
    v_pk_add_f32 v[14:15], v[14:15], v[22:23]
    s_add_u32 s64, s55, 0
    buffer_store_dwordx4 v[12:15], v7, s[60:63], s64 offen
    s_waitcnt lgkmcnt(4)
    v_pk_add_f32 v[28:29], v[28:29], v[32:33]
    v_pk_add_f32 v[36:37], v[36:37], v[40:41]
    v_pk_add_f32 v[30:31], v[30:31], v[34:35]
    v_pk_add_f32 v[38:39], v[38:39], v[42:43]
    v_pk_add_f32 v[28:29], v[28:29], v[36:37]
    v_pk_add_f32 v[30:31], v[30:31], v[38:39]
    s_add_u32 s64, s55, 256
    buffer_store_dwordx4 v[28:31], v7, s[60:63], s64 offen
    s_waitcnt lgkmcnt(0)
    v_pk_add_f32 v[44:45], v[44:45], v[48:49]
    v_pk_add_f32 v[52:53], v[52:53], v[56:57]
    v_pk_add_f32 v[46:47], v[46:47], v[50:51]
    v_pk_add_f32 v[54:55], v[54:55], v[58:59]
    v_pk_add_f32 v[44:45], v[44:45], v[52:53]
    v_pk_add_f32 v[46:47], v[46:47], v[54:55]
    s_add_u32 s64, s55, 41152
    buffer_store_dwordx4 v[44:47], v7, s[60:63], s64 offen
    s_branch gk_rend_126
gk_w_127:
    s_cmp_lg_u32 s91, 1
    s_cbranch_scc1 gk_w_128
    ds_read_b128 v[12:15], v6 offset:1024
    ds_read_b128 v[16:19], v6 offset:11264
    ds_read_b128 v[20:23], v6 offset:21504
    ds_read_b128 v[24:27], v6 offset:31744
    ds_read_b128 v[28:31], v6 offset:5120
    ds_read_b128 v[32:35], v6 offset:15360
    ds_read_b128 v[36:39], v6 offset:25600
    ds_read_b128 v[40:43], v6 offset:35840
    ds_read_b128 v[44:47], v6 offset:9216
    ds_read_b128 v[48:51], v6 offset:19456
    ds_read_b128 v[52:55], v6 offset:29696
    ds_read_b128 v[56:59], v6 offset:39936
    s_waitcnt lgkmcnt(8)
    v_pk_add_f32 v[12:13], v[12:13], v[16:17]
    v_pk_add_f32 v[20:21], v[20:21], v[24:25]
    v_pk_add_f32 v[14:15], v[14:15], v[18:19]
    v_pk_add_f32 v[22:23], v[22:23], v[26:27]
    v_pk_add_f32 v[12:13], v[12:13], v[20:21]
    v_pk_add_f32 v[14:15], v[14:15], v[22:23]
    s_add_u32 s64, s55, 64
    buffer_store_dwordx4 v[12:15], v7, s[60:63], s64 offen
    s_waitcnt lgkmcnt(4)
    v_pk_add_f32 v[28:29], v[28:29], v[32:33]
    v_pk_add_f32 v[36:37], v[36:37], v[40:41]
    v_pk_add_f32 v[30:31], v[30:31], v[34:35]
    v_pk_add_f32 v[38:39], v[38:39], v[42:43]
    v_pk_add_f32 v[28:29], v[28:29], v[36:37]
    v_pk_add_f32 v[30:31], v[30:31], v[38:39]
    s_add_u32 s64, s55, 40960
    buffer_store_dwordx4 v[28:31], v7, s[60:63], s64 offen
    s_waitcnt lgkmcnt(0)
    v_pk_add_f32 v[44:45], v[44:45], v[48:49]
    v_pk_add_f32 v[52:53], v[52:53], v[56:57]
    v_pk_add_f32 v[46:47], v[46:47], v[50:51]
    v_pk_add_f32 v[54:55], v[54:55], v[58:59]
    v_pk_add_f32 v[44:45], v[44:45], v[52:53]
    v_pk_add_f32 v[46:47], v[46:47], v[54:55]
    s_add_u32 s64, s55, 41216
    buffer_store_dwordx4 v[44:47], v7, s[60:63], s64 offen
    s_branch gk_rend_126
gk_w_128:
    s_cmp_lg_u32 s91, 2
    s_cbranch_scc1 gk_w_129
    ds_read_b128 v[12:15], v6 offset:2048
    ds_read_b128 v[16:19], v6 offset:12288
    ds_read_b128 v[20:23], v6 offset:22528
    ds_read_b128 v[24:27], v6 offset:32768
    ds_read_b128 v[28:31], v6 offset:6144
    ds_read_b128 v[32:35], v6 offset:16384
    ds_read_b128 v[36:39], v6 offset:26624
    ds_read_b128 v[40:43], v6 offset:36864
    s_waitcnt lgkmcnt(4)
    v_pk_add_f32 v[12:13], v[12:13], v[16:17]
    v_pk_add_f32 v[20:21], v[20:21], v[24:25]
    v_pk_add_f32 v[14:15], v[14:15], v[18:19]
    v_pk_add_f32 v[22:23], v[22:23], v[26:27]
    v_pk_add_f32 v[12:13], v[12:13], v[20:21]
    v_pk_add_f32 v[14:15], v[14:15], v[22:23]
    s_add_u32 s64, s55, 128
    buffer_store_dwordx4 v[12:15], v7, s[60:63], s64 offen
    s_waitcnt lgkmcnt(0)
    v_pk_add_f32 v[28:29], v[28:29], v[32:33]
    v_pk_add_f32 v[36:37], v[36:37], v[40:41]
    v_pk_add_f32 v[30:31], v[30:31], v[34:35]
    v_pk_add_f32 v[38:39], v[38:39], v[42:43]
    v_pk_add_f32 v[28:29], v[28:29], v[36:37]
    v_pk_add_f32 v[30:31], v[30:31], v[38:39]
    s_add_u32 s64, s55, 41024
    buffer_store_dwordx4 v[28:31], v7, s[60:63], s64 offen
    s_branch gk_rend_126
gk_w_129:
    s_cmp_lg_u32 s91, 3
    s_cbranch_scc1 gk_w_130
    ds_read_b128 v[12:15], v6 offset:3072
    ds_read_b128 v[16:19], v6 offset:13312
    ds_read_b128 v[20:23], v6 offset:23552
    ds_read_b128 v[24:27], v6 offset:33792
    ds_read_b128 v[28:31], v6 offset:7168
    ds_read_b128 v[32:35], v6 offset:17408
    ds_read_b128 v[36:39], v6 offset:27648
    ds_read_b128 v[40:43], v6 offset:37888
    s_waitcnt lgkmcnt(4)
    v_pk_add_f32 v[12:13], v[12:13], v[16:17]
    v_pk_add_f32 v[20:21], v[20:21], v[24:25]
    v_pk_add_f32 v[14:15], v[14:15], v[18:19]
    v_pk_add_f32 v[22:23], v[22:23], v[26:27]
    v_pk_add_f32 v[12:13], v[12:13], v[20:21]
    v_pk_add_f32 v[14:15], v[14:15], v[22:23]
    s_add_u32 s64, s55, 192
    buffer_store_dwordx4 v[12:15], v7, s[60:63], s64 offen
    s_waitcnt lgkmcnt(0)
    v_pk_add_f32 v[28:29], v[28:29], v[32:33]
    v_pk_add_f32 v[36:37], v[36:37], v[40:41]
    v_pk_add_f32 v[30:31], v[30:31], v[34:35]
    v_pk_add_f32 v[38:39], v[38:39], v[42:43]
    v_pk_add_f32 v[28:29], v[28:29], v[36:37]
    v_pk_add_f32 v[30:31], v[30:31], v[38:39]
    s_add_u32 s64, s55, 41088
    buffer_store_dwordx4 v[28:31], v7, s[60:63], s64 offen
    s_branch gk_rend_126
gk_w_130:
gk_rend_126:
    s_barrier
    s_add_u32 s54, s54, s53
    s_cmp_ge_u32 s54, s52
    s_cbranch_scc1 gk_out_122
    s_waitcnt vmcnt(0)
    s_add_u32 s57, s54, s53
    s_cmp_ge_u32 s57, s52
    s_cbranch_scc1 gk_nf_131
    s_add_u32 s93, s57, 192
    s_lshl_b32 s93, s93, 8
    v_mov_b32 v254, s93
wk_poll_132:
    buffer_load_dword v255, v254, s[28:31], 0 offen sc1
    s_waitcnt vmcnt(0)
    v_cmp_le_u32 vcc, 8, v255
    s_cbranch_vccnz wk_ok_133
    s_sleep 2
    s_add_u32 s92, s92, 1
    s_cmp_lt_u32 s92, 1048576
    s_cbranch_scc1 wk_poll_132
wk_ok_133:
    s_mul_i32 s48, s57, 393216
    s_add_u32 s48, s48, s50
    buffer_load_dwordx4 v[12:15], v4, s[40:43], s48 offen sc1
    s_add_u32 s48, s48, 1024
    buffer_load_dwordx4 v[16:19], v4, s[40:43], s48 offen sc1
    s_add_u32 s48, s48, 1024
    buffer_load_dwordx4 v[20:23], v4, s[40:43], s48 offen sc1
    s_add_u32 s48, s48, 1024
    buffer_load_dwordx4 v[24:27], v4, s[40:43], s48 offen sc1
    s_add_u32 s48, s48, 1024
    buffer_load_dwordx4 v[28:31], v4, s[40:43], s48 offen sc1
    s_add_u32 s48, s48, 1024
    buffer_load_dwordx4 v[32:35], v4, s[40:43], s48 offen sc1
    s_add_u32 s48, s48, 1024
    buffer_load_dwordx4 v[36:39], v4, s[40:43], s48 offen sc1
    s_add_u32 s48, s48, 1024
    buffer_load_dwordx4 v[40:43], v4, s[40:43], s48 offen sc1
    s_add_u32 s48, s48, 1024
    buffer_load_dwordx4 v[44:47], v4, s[40:43], s48 offen sc1
    s_add_u32 s48, s48, 1024
    buffer_load_dwordx4 v[48:51], v4, s[40:43], s48 offen sc1
    s_add_u32 s48, s48, 1024
    buffer_load_dwordx4 v[52:55], v4, s[40:43], s48 offen sc1
    s_add_u32 s48, s48, 1024
    buffer_load_dwordx4 v[56:59], v4, s[40:43], s48 offen sc1
    s_add_u32 s48, s48, 1024
    buffer_load_dwordx4 v[60:63], v4, s[40:43], s48 offen sc1
    s_add_u32 s48, s48, 1024
    buffer_load_dwordx4 v[64:67], v4, s[40:43], s48 offen sc1
    s_add_u32 s48, s48, 1024
    buffer_load_dwordx4 v[68:71], v4, s[40:43], s48 offen sc1
    s_add_u32 s48, s48, 1024
    buffer_load_dwordx4 v[72:75], v4, s[40:43], s48 offen sc1
    s_add_u32 s48, s48, 1024
    buffer_load_dwordx4 v[76:79], v4, s[40:43], s48 offen sc1
    s_add_u32 s48, s48, 1024
    buffer_load_dwordx4 v[80:83], v4, s[40:43], s48 offen sc1
    s_add_u32 s48, s48, 1024
    buffer_load_dwordx4 v[84:87], v4, s[40:43], s48 offen sc1
    s_add_u32 s48, s48, 1024
    buffer_load_dwordx4 v[88:91], v4, s[40:43], s48 offen sc1
    s_add_u32 s48, s48, 1024
    buffer_load_dwordx4 v[92:95], v4, s[40:43], s48 offen sc1
    s_add_u32 s48, s48, 1024
    buffer_load_dwordx4 v[96:99], v4, s[40:43], s48 offen sc1
    s_add_u32 s48, s48, 1024
    buffer_load_dwordx4 v[100:103], v4, s[40:43], s48 offen sc1
    s_add_u32 s48, s48, 1024
    buffer_load_dwordx4 v[104:107], v4, s[40:43], s48 offen sc1
    s_add_u32 s48, s48, 1024
gk_nf_131:
    v_mfma_f32_16x16x32_bf16 v[204:207], a[0:3], v[108:111], 0
    v_mfma_f32_16x16x32_bf16 v[208:211], a[48:51], v[108:111], 0
    v_mfma_f32_16x16x32_bf16 v[212:215], a[96:99], v[108:111], 0
    v_mfma_f32_16x16x32_bf16 v[216:219], a[144:147], v[108:111], 0
    v_mfma_f32_16x16x32_bf16 v[220:223], a[192:195], v[108:111], 0
    v_mfma_f32_16x16x32_bf16 v[224:227], a[0:3], v[112:115], 0
    v_mfma_f32_16x16x32_bf16 v[228:231], a[48:51], v[112:115], 0
    v_mfma_f32_16x16x32_bf16 v[232:235], a[96:99], v[112:115], 0
    v_mfma_f32_16x16x32_bf16 v[236:239], a[144:147], v[112:115], 0
    v_mfma_f32_16x16x32_bf16 v[240:243], a[192:195], v[112:115], 0
    v_mfma_f32_16x16x32_bf16 v[204:207], a[4:7], v[116:119], v[204:207]
    v_mfma_f32_16x16x32_bf16 v[208:211], a[52:55], v[116:119], v[208:211]
    v_mfma_f32_16x16x32_bf16 v[212:215], a[100:103], v[116:119], v[212:215]
    v_mfma_f32_16x16x32_bf16 v[216:219], a[148:151], v[116:119], v[216:219]
    v_mfma_f32_16x16x32_bf16 v[220:223], a[196:199], v[116:119], v[220:223]
    v_mfma_f32_16x16x32_bf16 v[224:227], a[4:7], v[120:123], v[224:227]
    v_mfma_f32_16x16x32_bf16 v[228:231], a[52:55], v[120:123], v[228:231]
    v_mfma_f32_16x16x32_bf16 v[232:235], a[100:103], v[120:123], v[232:235]
    v_mfma_f32_16x16x32_bf16 v[236:239], a[148:151], v[120:123], v[236:239]
    v_mfma_f32_16x16x32_bf16 v[240:243], a[196:199], v[120:123], v[240:243]
    v_mfma_f32_16x16x32_bf16 v[204:207], a[8:11], v[124:127], v[204:207]
    v_mfma_f32_16x16x32_bf16 v[208:211], a[56:59], v[124:127], v[208:211]
    v_mfma_f32_16x16x32_bf16 v[212:215], a[104:107], v[124:127], v[212:215]
    v_mfma_f32_16x16x32_bf16 v[216:219], a[152:155], v[124:127], v[216:219]
    v_mfma_f32_16x16x32_bf16 v[220:223], a[200:203], v[124:127], v[220:223]
    v_mfma_f32_16x16x32_bf16 v[224:227], a[8:11], v[128:131], v[224:227]
    v_mfma_f32_16x16x32_bf16 v[228:231], a[56:59], v[128:131], v[228:231]
    v_mfma_f32_16x16x32_bf16 v[232:235], a[104:107], v[128:131], v[232:235]
    v_mfma_f32_16x16x32_bf16 v[236:239], a[152:155], v[128:131], v[236:239]
    v_mfma_f32_16x16x32_bf16 v[240:243], a[200:203], v[128:131], v[240:243]
    v_mfma_f32_16x16x32_bf16 v[204:207], a[12:15], v[132:135], v[204:207]
    v_mfma_f32_16x16x32_bf16 v[208:211], a[60:63], v[132:135], v[208:211]
    v_mfma_f32_16x16x32_bf16 v[212:215], a[108:111], v[132:135], v[212:215]
    v_mfma_f32_16x16x32_bf16 v[216:219], a[156:159], v[132:135], v[216:219]
    v_mfma_f32_16x16x32_bf16 v[220:223], a[204:207], v[132:135], v[220:223]
    v_mfma_f32_16x16x32_bf16 v[224:227], a[12:15], v[136:139], v[224:227]
    v_mfma_f32_16x16x32_bf16 v[228:231], a[60:63], v[136:139], v[228:231]
    v_mfma_f32_16x16x32_bf16 v[232:235], a[108:111], v[136:139], v[232:235]
    v_mfma_f32_16x16x32_bf16 v[236:239], a[156:159], v[136:139], v[236:239]
    v_mfma_f32_16x16x32_bf16 v[240:243], a[204:207], v[136:139], v[240:243]
    v_mfma_f32_16x16x32_bf16 v[204:207], a[16:19], v[140:143], v[204:207]
    v_mfma_f32_16x16x32_bf16 v[208:211], a[64:67], v[140:143], v[208:211]
    v_mfma_f32_16x16x32_bf16 v[212:215], a[112:115], v[140:143], v[212:215]
    v_mfma_f32_16x16x32_bf16 v[216:219], a[160:163], v[140:143], v[216:219]
    v_mfma_f32_16x16x32_bf16 v[220:223], a[208:211], v[140:143], v[220:223]
    v_mfma_f32_16x16x32_bf16 v[224:227], a[16:19], v[144:147], v[224:227]
    v_mfma_f32_16x16x32_bf16 v[228:231], a[64:67], v[144:147], v[228:231]
    v_mfma_f32_16x16x32_bf16 v[232:235], a[112:115], v[144:147], v[232:235]
    v_mfma_f32_16x16x32_bf16 v[236:239], a[160:163], v[144:147], v[236:239]
    v_mfma_f32_16x16x32_bf16 v[240:243], a[208:211], v[144:147], v[240:243]
    v_mfma_f32_16x16x32_bf16 v[204:207], a[20:23], v[148:151], v[204:207]
    v_mfma_f32_16x16x32_bf16 v[208:211], a[68:71], v[148:151], v[208:211]
    v_mfma_f32_16x16x32_bf16 v[212:215], a[116:119], v[148:151], v[212:215]
    v_mfma_f32_16x16x32_bf16 v[216:219], a[164:167], v[148:151], v[216:219]
    v_mfma_f32_16x16x32_bf16 v[220:223], a[212:215], v[148:151], v[220:223]
    v_mfma_f32_16x16x32_bf16 v[224:227], a[20:23], v[152:155], v[224:227]
    v_mfma_f32_16x16x32_bf16 v[228:231], a[68:71], v[152:155], v[228:231]
    v_mfma_f32_16x16x32_bf16 v[232:235], a[116:119], v[152:155], v[232:235]
    v_mfma_f32_16x16x32_bf16 v[236:239], a[164:167], v[152:155], v[236:239]
    v_mfma_f32_16x16x32_bf16 v[240:243], a[212:215], v[152:155], v[240:243]
    v_mfma_f32_16x16x32_bf16 v[204:207], a[24:27], v[156:159], v[204:207]
    v_mfma_f32_16x16x32_bf16 v[208:211], a[72:75], v[156:159], v[208:211]
    v_mfma_f32_16x16x32_bf16 v[212:215], a[120:123], v[156:159], v[212:215]
    v_mfma_f32_16x16x32_bf16 v[216:219], a[168:171], v[156:159], v[216:219]
    v_mfma_f32_16x16x32_bf16 v[220:223], a[216:219], v[156:159], v[220:223]
    v_mfma_f32_16x16x32_bf16 v[224:227], a[24:27], v[160:163], v[224:227]
    v_mfma_f32_16x16x32_bf16 v[228:231], a[72:75], v[160:163], v[228:231]
    v_mfma_f32_16x16x32_bf16 v[232:235], a[120:123], v[160:163], v[232:235]
    v_mfma_f32_16x16x32_bf16 v[236:239], a[168:171], v[160:163], v[236:239]
    v_mfma_f32_16x16x32_bf16 v[240:243], a[216:219], v[160:163], v[240:243]
    v_mfma_f32_16x16x32_bf16 v[204:207], a[28:31], v[164:167], v[204:207]
    v_mfma_f32_16x16x32_bf16 v[208:211], a[76:79], v[164:167], v[208:211]
    v_mfma_f32_16x16x32_bf16 v[212:215], a[124:127], v[164:167], v[212:215]
    v_mfma_f32_16x16x32_bf16 v[216:219], a[172:175], v[164:167], v[216:219]
    v_mfma_f32_16x16x32_bf16 v[220:223], a[220:223], v[164:167], v[220:223]
    v_mfma_f32_16x16x32_bf16 v[224:227], a[28:31], v[168:171], v[224:227]
    v_mfma_f32_16x16x32_bf16 v[228:231], a[76:79], v[168:171], v[228:231]
    v_mfma_f32_16x16x32_bf16 v[232:235], a[124:127], v[168:171], v[232:235]
    v_mfma_f32_16x16x32_bf16 v[236:239], a[172:175], v[168:171], v[236:239]
    v_mfma_f32_16x16x32_bf16 v[240:243], a[220:223], v[168:171], v[240:243]
    v_mfma_f32_16x16x32_bf16 v[204:207], a[32:35], v[172:175], v[204:207]
    v_mfma_f32_16x16x32_bf16 v[208:211], a[80:83], v[172:175], v[208:211]
    v_mfma_f32_16x16x32_bf16 v[212:215], a[128:131], v[172:175], v[212:215]
    v_mfma_f32_16x16x32_bf16 v[216:219], a[176:179], v[172:175], v[216:219]
    v_mfma_f32_16x16x32_bf16 v[220:223], a[224:227], v[172:175], v[220:223]
    v_mfma_f32_16x16x32_bf16 v[224:227], a[32:35], v[176:179], v[224:227]
    v_mfma_f32_16x16x32_bf16 v[228:231], a[80:83], v[176:179], v[228:231]
    v_mfma_f32_16x16x32_bf16 v[232:235], a[128:131], v[176:179], v[232:235]
    v_mfma_f32_16x16x32_bf16 v[236:239], a[176:179], v[176:179], v[236:239]
    v_mfma_f32_16x16x32_bf16 v[240:243], a[224:227], v[176:179], v[240:243]
    v_mfma_f32_16x16x32_bf16 v[204:207], a[36:39], v[180:183], v[204:207]
    v_mfma_f32_16x16x32_bf16 v[208:211], a[84:87], v[180:183], v[208:211]
    v_mfma_f32_16x16x32_bf16 v[212:215], a[132:135], v[180:183], v[212:215]
    v_mfma_f32_16x16x32_bf16 v[216:219], a[180:183], v[180:183], v[216:219]
    v_mfma_f32_16x16x32_bf16 v[220:223], a[228:231], v[180:183], v[220:223]
    v_mfma_f32_16x16x32_bf16 v[224:227], a[36:39], v[184:187], v[224:227]
    v_mfma_f32_16x16x32_bf16 v[228:231], a[84:87], v[184:187], v[228:231]
    v_mfma_f32_16x16x32_bf16 v[232:235], a[132:135], v[184:187], v[232:235]
    v_mfma_f32_16x16x32_bf16 v[236:239], a[180:183], v[184:187], v[236:239]
    v_mfma_f32_16x16x32_bf16 v[240:243], a[228:231], v[184:187], v[240:243]
    v_mfma_f32_16x16x32_bf16 v[204:207], a[40:43], v[188:191], v[204:207]
    v_mfma_f32_16x16x32_bf16 v[208:211], a[88:91], v[188:191], v[208:211]
    v_mfma_f32_16x16x32_bf16 v[212:215], a[136:139], v[188:191], v[212:215]
    v_mfma_f32_16x16x32_bf16 v[216:219], a[184:187], v[188:191], v[216:219]
    v_mfma_f32_16x16x32_bf16 v[220:223], a[232:235], v[188:191], v[220:223]
    v_mfma_f32_16x16x32_bf16 v[224:227], a[40:43], v[192:195], v[224:227]
    v_mfma_f32_16x16x32_bf16 v[228:231], a[88:91], v[192:195], v[228:231]
    v_mfma_f32_16x16x32_bf16 v[232:235], a[136:139], v[192:195], v[232:235]
    v_mfma_f32_16x16x32_bf16 v[236:239], a[184:187], v[192:195], v[236:239]
    v_mfma_f32_16x16x32_bf16 v[240:243], a[232:235], v[192:195], v[240:243]
    v_mfma_f32_16x16x32_bf16 v[204:207], a[44:47], v[196:199], v[204:207]
    v_mfma_f32_16x16x32_bf16 v[208:211], a[92:95], v[196:199], v[208:211]
    v_mfma_f32_16x16x32_bf16 v[212:215], a[140:143], v[196:199], v[212:215]
    v_mfma_f32_16x16x32_bf16 v[216:219], a[188:191], v[196:199], v[216:219]
    v_mfma_f32_16x16x32_bf16 v[220:223], a[236:239], v[196:199], v[220:223]
    v_mfma_f32_16x16x32_bf16 v[224:227], a[44:47], v[200:203], v[224:227]
    v_mfma_f32_16x16x32_bf16 v[228:231], a[92:95], v[200:203], v[228:231]
    v_mfma_f32_16x16x32_bf16 v[232:235], a[140:143], v[200:203], v[232:235]
    v_mfma_f32_16x16x32_bf16 v[236:239], a[188:191], v[200:203], v[236:239]
    v_mfma_f32_16x16x32_bf16 v[240:243], a[236:239], v[200:203], v[240:243]
    s_nop 7
    ds_write_b128 v5, v[204:207] offset:0
    ds_write_b128 v5, v[208:211] offset:1024
    ds_write_b128 v5, v[212:215] offset:2048
    ds_write_b128 v5, v[216:219] offset:3072
    ds_write_b128 v5, v[220:223] offset:4096
    ds_write_b128 v5, v[224:227] offset:5120
    ds_write_b128 v5, v[228:231] offset:6144
    ds_write_b128 v5, v[232:235] offset:7168
    ds_write_b128 v5, v[236:239] offset:8192
    ds_write_b128 v5, v[240:243] offset:9216
    s_waitcnt lgkmcnt(0)
    s_barrier
    s_mul_i32 s55, s54, 81920
    s_mul_i32 s64, s16, 5242880
    s_add_u32 s55, s55, s64
    s_cmp_lg_u32 s91, 0
    s_cbranch_scc1 gk_w_135
    ds_read_b128 v[108:111], v6 offset:0
    ds_read_b128 v[112:115], v6 offset:10240
    ds_read_b128 v[116:119], v6 offset:20480
    ds_read_b128 v[120:123], v6 offset:30720
    ds_read_b128 v[124:127], v6 offset:4096
    ds_read_b128 v[128:131], v6 offset:14336
    ds_read_b128 v[132:135], v6 offset:24576
    ds_read_b128 v[136:139], v6 offset:34816
    ds_read_b128 v[140:143], v6 offset:8192
    ds_read_b128 v[144:147], v6 offset:18432
    ds_read_b128 v[148:151], v6 offset:28672
    ds_read_b128 v[152:155], v6 offset:38912
    s_waitcnt lgkmcnt(8)
    v_pk_add_f32 v[108:109], v[108:109], v[112:113]
    v_pk_add_f32 v[116:117], v[116:117], v[120:121]
    v_pk_add_f32 v[110:111], v[110:111], v[114:115]
    v_pk_add_f32 v[118:119], v[118:119], v[122:123]
    v_pk_add_f32 v[108:109], v[108:109], v[116:117]
    v_pk_add_f32 v[110:111], v[110:111], v[118:119]
    s_add_u32 s64, s55, 0
    buffer_store_dwordx4 v[108:111], v7, s[60:63], s64 offen
    s_waitcnt lgkmcnt(4)
    v_pk_add_f32 v[124:125], v[124:125], v[128:129]
    v_pk_add_f32 v[132:133], v[132:133], v[136:137]
    v_pk_add_f32 v[126:127], v[126:127], v[130:131]
    v_pk_add_f32 v[134:135], v[134:135], v[138:139]
    v_pk_add_f32 v[124:125], v[124:125], v[132:133]
    v_pk_add_f32 v[126:127], v[126:127], v[134:135]
    s_add_u32 s64, s55, 256
    buffer_store_dwordx4 v[124:127], v7, s[60:63], s64 offen
    s_waitcnt lgkmcnt(0)
    v_pk_add_f32 v[140:141], v[140:141], v[144:145]
    v_pk_add_f32 v[148:149], v[148:149], v[152:153]
    v_pk_add_f32 v[142:143], v[142:143], v[146:147]
    v_pk_add_f32 v[150:151], v[150:151], v[154:155]
    v_pk_add_f32 v[140:141], v[140:141], v[148:149]
    v_pk_add_f32 v[142:143], v[142:143], v[150:151]
    s_add_u32 s64, s55, 41152
    buffer_store_dwordx4 v[140:143], v7, s[60:63], s64 offen
    s_branch gk_rend_134
gk_w_135:
    s_cmp_lg_u32 s91, 1
    s_cbranch_scc1 gk_w_136
    ds_read_b128 v[108:111], v6 offset:1024
    ds_read_b128 v[112:115], v6 offset:11264
    ds_read_b128 v[116:119], v6 offset:21504
    ds_read_b128 v[120:123], v6 offset:31744
    ds_read_b128 v[124:127], v6 offset:5120
    ds_read_b128 v[128:131], v6 offset:15360
    ds_read_b128 v[132:135], v6 offset:25600
    ds_read_b128 v[136:139], v6 offset:35840
    ds_read_b128 v[140:143], v6 offset:9216
    ds_read_b128 v[144:147], v6 offset:19456
    ds_read_b128 v[148:151], v6 offset:29696
    ds_read_b128 v[152:155], v6 offset:39936
    s_waitcnt lgkmcnt(8)
    v_pk_add_f32 v[108:109], v[108:109], v[112:113]
    v_pk_add_f32 v[116:117], v[116:117], v[120:121]
    v_pk_add_f32 v[110:111], v[110:111], v[114:115]
    v_pk_add_f32 v[118:119], v[118:119], v[122:123]
    v_pk_add_f32 v[108:109], v[108:109], v[116:117]
    v_pk_add_f32 v[110:111], v[110:111], v[118:119]
    s_add_u32 s64, s55, 64
    buffer_store_dwordx4 v[108:111], v7, s[60:63], s64 offen
    s_waitcnt lgkmcnt(4)
    v_pk_add_f32 v[124:125], v[124:125], v[128:129]
    v_pk_add_f32 v[132:133], v[132:133], v[136:137]
    v_pk_add_f32 v[126:127], v[126:127], v[130:131]
    v_pk_add_f32 v[134:135], v[134:135], v[138:139]
    v_pk_add_f32 v[124:125], v[124:125], v[132:133]
    v_pk_add_f32 v[126:127], v[126:127], v[134:135]
    s_add_u32 s64, s55, 40960
    buffer_store_dwordx4 v[124:127], v7, s[60:63], s64 offen
    s_waitcnt lgkmcnt(0)
    v_pk_add_f32 v[140:141], v[140:141], v[144:145]
    v_pk_add_f32 v[148:149], v[148:149], v[152:153]
    v_pk_add_f32 v[142:143], v[142:143], v[146:147]
    v_pk_add_f32 v[150:151], v[150:151], v[154:155]
    v_pk_add_f32 v[140:141], v[140:141], v[148:149]
    v_pk_add_f32 v[142:143], v[142:143], v[150:151]
    s_add_u32 s64, s55, 41216
    buffer_store_dwordx4 v[140:143], v7, s[60:63], s64 offen
    s_branch gk_rend_134
gk_w_136:
    s_cmp_lg_u32 s91, 2
    s_cbranch_scc1 gk_w_137
    ds_read_b128 v[108:111], v6 offset:2048
    ds_read_b128 v[112:115], v6 offset:12288
    ds_read_b128 v[116:119], v6 offset:22528
    ds_read_b128 v[120:123], v6 offset:32768
    ds_read_b128 v[124:127], v6 offset:6144
    ds_read_b128 v[128:131], v6 offset:16384
    ds_read_b128 v[132:135], v6 offset:26624
    ds_read_b128 v[136:139], v6 offset:36864
    s_waitcnt lgkmcnt(4)
    v_pk_add_f32 v[108:109], v[108:109], v[112:113]
    v_pk_add_f32 v[116:117], v[116:117], v[120:121]
    v_pk_add_f32 v[110:111], v[110:111], v[114:115]
    v_pk_add_f32 v[118:119], v[118:119], v[122:123]
    v_pk_add_f32 v[108:109], v[108:109], v[116:117]
    v_pk_add_f32 v[110:111], v[110:111], v[118:119]
    s_add_u32 s64, s55, 128
    buffer_store_dwordx4 v[108:111], v7, s[60:63], s64 offen
    s_waitcnt lgkmcnt(0)
    v_pk_add_f32 v[124:125], v[124:125], v[128:129]
    v_pk_add_f32 v[132:133], v[132:133], v[136:137]
    v_pk_add_f32 v[126:127], v[126:127], v[130:131]
    v_pk_add_f32 v[134:135], v[134:135], v[138:139]
    v_pk_add_f32 v[124:125], v[124:125], v[132:133]
    v_pk_add_f32 v[126:127], v[126:127], v[134:135]
    s_add_u32 s64, s55, 41024
    buffer_store_dwordx4 v[124:127], v7, s[60:63], s64 offen
    s_branch gk_rend_134
gk_w_137:
    s_cmp_lg_u32 s91, 3
    s_cbranch_scc1 gk_w_138
    ds_read_b128 v[108:111], v6 offset:3072
    ds_read_b128 v[112:115], v6 offset:13312
    ds_read_b128 v[116:119], v6 offset:23552
    ds_read_b128 v[120:123], v6 offset:33792
    ds_read_b128 v[124:127], v6 offset:7168
    ds_read_b128 v[128:131], v6 offset:17408
    ds_read_b128 v[132:135], v6 offset:27648
    ds_read_b128 v[136:139], v6 offset:37888
    s_waitcnt lgkmcnt(4)
    v_pk_add_f32 v[108:109], v[108:109], v[112:113]
    v_pk_add_f32 v[116:117], v[116:117], v[120:121]
    v_pk_add_f32 v[110:111], v[110:111], v[114:115]
    v_pk_add_f32 v[118:119], v[118:119], v[122:123]
    v_pk_add_f32 v[108:109], v[108:109], v[116:117]
    v_pk_add_f32 v[110:111], v[110:111], v[118:119]
    s_add_u32 s64, s55, 192
    buffer_store_dwordx4 v[108:111], v7, s[60:63], s64 offen
    s_waitcnt lgkmcnt(0)
    v_pk_add_f32 v[124:125], v[124:125], v[128:129]
    v_pk_add_f32 v[132:133], v[132:133], v[136:137]
    v_pk_add_f32 v[126:127], v[126:127], v[130:131]
    v_pk_add_f32 v[134:135], v[134:135], v[138:139]
    v_pk_add_f32 v[124:125], v[124:125], v[132:133]
    v_pk_add_f32 v[126:127], v[126:127], v[134:135]
    s_add_u32 s64, s55, 41088
    buffer_store_dwordx4 v[124:127], v7, s[60:63], s64 offen
    s_branch gk_rend_134
gk_w_138:
gk_rend_134:
    s_barrier
    s_add_u32 s54, s54, s53
    s_cmp_ge_u32 s54, s52
    s_cbranch_scc1 gk_out_122
    s_branch gk_loop_121
gk_out_122:
    s_branch rc_kend_3
wk_f2_80:
    s_mov_b32 s16, 0
    s_and_b32 s17, s90, 7
    s_bfe_u32 s54, s90, 0x20003
    s_lshl_b32 s54, s54, 4
    s_mov_b32 s53, 1
    s_add_u32 s52, s54, 16
    s_mov_b32 s44, s24
    s_mov_b32 s45, s25
    s_mov_b32 s46, 0x001e0000
    s_mov_b32 s47, 0x00020000
    s_add_u32 s40, s14, 0x04c00000
    s_addc_u32 s41, s15, 0
    s_mov_b32 s42, 0x00600000
    s_mov_b32 s43, 0x00020000
    s_add_u32 s60, s14, 0x05200000
    s_addc_u32 s61, s15, 0
    s_mov_b32 s62, 0x00280000
    s_mov_b32 s63, 0x00020000
    s_mov_b32 s68, s26
    s_mov_b32 s69, s27
    s_mov_b32 s70, 0x00000500
    s_mov_b32 s71, 0x00020000
    s_mov_b32 s51, 1280
    s_lshl_b32 s65, s16, 2
    s_add_u32 s65, s65, s91
    s_mul_i32 s65, s65, 491520
    s_mul_i32 s66, s17, 160
    s_add_u32 s65, s65, s66
    s_mul_i32 s64, s91, 20480
    v_lshl_add_u32 v5, v3, 4, s64
    v_lshrrev_b32 v6, 2, v1
    v_lshl_add_u32 v7, v2, 3, v6
    v_lshlrev_b32 v7, 5, v7
    v_and_b32 v8, 3, v1
    v_lshl_add_u32 v7, v8, 3, v7
    v_add_u32 v7, s64, v7
    v_lshrrev_b32 v10, 1, v3
    v_mul_lo_u32 v10, v10, s51
    v_and_b32 v11, 1, v3
    v_lshl_add_u32 v10, v11, 4, v10
    s_lshl_b32 s66, s51, 5
    s_add_u32 s67, s65, 0
    buffer_load_dwordx4 v[12:15], v10, s[44:47], s67 offen
    s_add_u32 s67, s67, s66
    buffer_load_dwordx4 v[16:19], v10, s[44:47], s67 offen
    s_add_u32 s67, s67, s66
    buffer_load_dwordx4 v[20:23], v10, s[44:47], s67 offen
    s_add_u32 s67, s67, s66
    buffer_load_dwordx4 v[24:27], v10, s[44:47], s67 offen
    s_add_u32 s67, s67, s66
    buffer_load_dwordx4 v[28:31], v10, s[44:47], s67 offen
    s_add_u32 s67, s67, s66
    buffer_load_dwordx4 v[32:35], v10, s[44:47], s67 offen
    s_add_u32 s67, s67, s66
    buffer_load_dwordx4 v[36:39], v10, s[44:47], s67 offen
    s_add_u32 s67, s67, s66
    buffer_load_dwordx4 v[40:43], v10, s[44:47], s67 offen
    s_add_u32 s67, s67, s66
    buffer_load_dwordx4 v[44:47], v10, s[44:47], s67 offen
    s_add_u32 s67, s67, s66
    buffer_load_dwordx4 v[48:51], v10, s[44:47], s67 offen
    s_add_u32 s67, s67, s66
    buffer_load_dwordx4 v[52:55], v10, s[44:47], s67 offen
    s_add_u32 s67, s67, s66
    buffer_load_dwordx4 v[56:59], v10, s[44:47], s67 offen
    s_add_u32 s67, s67, s66
    s_add_u32 s67, s65, 32
    buffer_load_dwordx4 v[60:63], v10, s[44:47], s67 offen
    s_add_u32 s67, s67, s66
    buffer_load_dwordx4 v[64:67], v10, s[44:47], s67 offen
    s_add_u32 s67, s67, s66
    buffer_load_dwordx4 v[68:71], v10, s[44:47], s67 offen
    s_add_u32 s67, s67, s66
    buffer_load_dwordx4 v[72:75], v10, s[44:47], s67 offen
    s_add_u32 s67, s67, s66
    buffer_load_dwordx4 v[76:79], v10, s[44:47], s67 offen
    s_add_u32 s67, s67, s66
    buffer_load_dwordx4 v[80:83], v10, s[44:47], s67 offen
    s_add_u32 s67, s67, s66
    buffer_load_dwordx4 v[84:87], v10, s[44:47], s67 offen
    s_add_u32 s67, s67, s66
    buffer_load_dwordx4 v[88:91], v10, s[44:47], s67 offen
    s_add_u32 s67, s67, s66
    buffer_load_dwordx4 v[92:95], v10, s[44:47], s67 offen
    s_add_u32 s67, s67, s66
    buffer_load_dwordx4 v[96:99], v10, s[44:47], s67 offen
    s_add_u32 s67, s67, s66
    buffer_load_dwordx4 v[100:103], v10, s[44:47], s67 offen
    s_add_u32 s67, s67, s66
    buffer_load_dwordx4 v[104:107], v10, s[44:47], s67 offen
    s_add_u32 s67, s67, s66
    s_add_u32 s67, s65, 64
    buffer_load_dwordx4 v[108:111], v10, s[44:47], s67 offen
    s_add_u32 s67, s67, s66
    buffer_load_dwordx4 v[112:115], v10, s[44:47], s67 offen
    s_add_u32 s67, s67, s66
    buffer_load_dwordx4 v[116:119], v10, s[44:47], s67 offen
    s_add_u32 s67, s67, s66
    buffer_load_dwordx4 v[120:123], v10, s[44:47], s67 offen
    s_add_u32 s67, s67, s66
    buffer_load_dwordx4 v[124:127], v10, s[44:47], s67 offen
    s_add_u32 s67, s67, s66
    buffer_load_dwordx4 v[128:131], v10, s[44:47], s67 offen
    s_add_u32 s67, s67, s66
    buffer_load_dwordx4 v[132:135], v10, s[44:47], s67 offen
    s_add_u32 s67, s67, s66
    buffer_load_dwordx4 v[136:139], v10, s[44:47], s67 offen
    s_add_u32 s67, s67, s66
    buffer_load_dwordx4 v[140:143], v10, s[44:47], s67 offen
    s_add_u32 s67, s67, s66
    buffer_load_dwordx4 v[144:147], v10, s[44:47], s67 offen
    s_add_u32 s67, s67, s66
    buffer_load_dwordx4 v[148:151], v10, s[44:47], s67 offen
    s_add_u32 s67, s67, s66
    buffer_load_dwordx4 v[152:155], v10, s[44:47], s67 offen
    s_add_u32 s67, s67, s66
    s_add_u32 s67, s65, 96
    buffer_load_dwordx4 v[156:159], v10, s[44:47], s67 offen
    s_add_u32 s67, s67, s66
    buffer_load_dwordx4 v[160:163], v10, s[44:47], s67 offen
    s_add_u32 s67, s67, s66
    buffer_load_dwordx4 v[164:167], v10, s[44:47], s67 offen
    s_add_u32 s67, s67, s66
    buffer_load_dwordx4 v[168:171], v10, s[44:47], s67 offen
    s_add_u32 s67, s67, s66
    buffer_load_dwordx4 v[172:175], v10, s[44:47], s67 offen
    s_add_u32 s67, s67, s66
    buffer_load_dwordx4 v[176:179], v10, s[44:47], s67 offen
    s_add_u32 s67, s67, s66
    buffer_load_dwordx4 v[180:183], v10, s[44:47], s67 offen
    s_add_u32 s67, s67, s66
    buffer_load_dwordx4 v[184:187], v10, s[44:47], s67 offen
    s_add_u32 s67, s67, s66
    buffer_load_dwordx4 v[188:191], v10, s[44:47], s67 offen
    s_add_u32 s67, s67, s66
    buffer_load_dwordx4 v[192:195], v10, s[44:47], s67 offen
    s_add_u32 s67, s67, s66
    buffer_load_dwordx4 v[196:199], v10, s[44:47], s67 offen
    s_add_u32 s67, s67, s66
    buffer_load_dwordx4 v[200:203], v10, s[44:47], s67 offen
    s_add_u32 s67, s67, s66
    s_add_u32 s67, s65, 128
    buffer_load_dwordx4 v[204:207], v10, s[44:47], s67 offen
    s_add_u32 s67, s67, s66
    buffer_load_dwordx4 v[208:211], v10, s[44:47], s67 offen
    s_add_u32 s67, s67, s66
    buffer_load_dwordx4 v[212:215], v10, s[44:47], s67 offen
    s_add_u32 s67, s67, s66
    buffer_load_dwordx4 v[216:219], v10, s[44:47], s67 offen
    s_add_u32 s67, s67, s66
    buffer_load_dwordx4 v[220:223], v10, s[44:47], s67 offen
    s_add_u32 s67, s67, s66
    buffer_load_dwordx4 v[224:227], v10, s[44:47], s67 offen
    s_add_u32 s67, s67, s66
    buffer_load_dwordx4 v[228:231], v10, s[44:47], s67 offen
    s_add_u32 s67, s67, s66
    buffer_load_dwordx4 v[232:235], v10, s[44:47], s67 offen
    s_add_u32 s67, s67, s66
    buffer_load_dwordx4 v[236:239], v10, s[44:47], s67 offen
    s_add_u32 s67, s67, s66
    buffer_load_dwordx4 v[240:243], v10, s[44:47], s67 offen
    s_add_u32 s67, s67, s66
    buffer_load_dwordx4 v[244:247], v10, s[44:47], s67 offen
    s_add_u32 s67, s67, s66
    buffer_load_dwordx4 v[248:251], v10, s[44:47], s67 offen
    s_add_u32 s67, s67, s66
    s_waitcnt vmcnt(59)
    ds_write_b128 v5, v[12:15] offset:0
    s_waitcnt vmcnt(58)
    ds_write_b128 v5, v[16:19] offset:1024
    s_waitcnt vmcnt(57)
    ds_write_b128 v5, v[20:23] offset:2048
    s_waitcnt vmcnt(56)
    ds_write_b128 v5, v[24:27] offset:3072
    s_waitcnt vmcnt(55)
    ds_write_b128 v5, v[28:31] offset:4096
    s_waitcnt vmcnt(54)
    ds_write_b128 v5, v[32:35] offset:5120
    s_waitcnt vmcnt(53)
    ds_write_b128 v5, v[36:39] offset:6144
    s_waitcnt vmcnt(52)
    ds_write_b128 v5, v[40:43] offset:7168
    s_waitcnt vmcnt(51)
    ds_write_b128 v5, v[44:47] offset:8192
    s_waitcnt vmcnt(50)
    ds_write_b128 v5, v[48:51] offset:9216
    s_waitcnt vmcnt(49)
    ds_write_b128 v5, v[52:55] offset:10240
    s_waitcnt vmcnt(48)
    ds_write_b128 v5, v[56:59] offset:11264
    s_waitcnt lgkmcnt(0)
    s_waitcnt lgkmcnt(0)
    ds_read_b64_tr_b16 a[0:1], v7 offset:0
    ds_read_b64_tr_b16 a[2:3], v7 offset:128
    ds_read_b64_tr_b16 a[4:5], v7 offset:1024
    ds_read_b64_tr_b16 a[6:7], v7 offset:1152
    ds_read_b64_tr_b16 a[8:9], v7 offset:2048
    ds_read_b64_tr_b16 a[10:11], v7 offset:2176
    ds_read_b64_tr_b16 a[12:13], v7 offset:3072
    ds_read_b64_tr_b16 a[14:15], v7 offset:3200
    ds_read_b64_tr_b16 a[16:17], v7 offset:4096
    ds_read_b64_tr_b16 a[18:19], v7 offset:4224
    ds_read_b64_tr_b16 a[20:21], v7 offset:5120
    ds_read_b64_tr_b16 a[22:23], v7 offset:5248
    s_waitcnt lgkmcnt(0)
    ds_read_b64_tr_b16 a[24:25], v7 offset:6144
    ds_read_b64_tr_b16 a[26:27], v7 offset:6272
    ds_read_b64_tr_b16 a[28:29], v7 offset:7168
    ds_read_b64_tr_b16 a[30:31], v7 offset:7296
    ds_read_b64_tr_b16 a[32:33], v7 offset:8192
    ds_read_b64_tr_b16 a[34:35], v7 offset:8320
    ds_read_b64_tr_b16 a[36:37], v7 offset:9216
    ds_read_b64_tr_b16 a[38:39], v7 offset:9344
    ds_read_b64_tr_b16 a[40:41], v7 offset:10240
    ds_read_b64_tr_b16 a[42:43], v7 offset:10368
    ds_read_b64_tr_b16 a[44:45], v7 offset:11264
    ds_read_b64_tr_b16 a[46:47], v7 offset:11392
    s_waitcnt lgkmcnt(0)
    s_waitcnt lgkmcnt(0)
    s_waitcnt vmcnt(47)
    ds_write_b128 v5, v[60:63] offset:0
    s_waitcnt vmcnt(46)
    ds_write_b128 v5, v[64:67] offset:1024
    s_waitcnt vmcnt(45)
    ds_write_b128 v5, v[68:71] offset:2048
    s_waitcnt vmcnt(44)
    ds_write_b128 v5, v[72:75] offset:3072
    s_waitcnt vmcnt(43)
    ds_write_b128 v5, v[76:79] offset:4096
    s_waitcnt vmcnt(42)
    ds_write_b128 v5, v[80:83] offset:5120
    s_waitcnt vmcnt(41)
    ds_write_b128 v5, v[84:87] offset:6144
    s_waitcnt vmcnt(40)
    ds_write_b128 v5, v[88:91] offset:7168
    s_waitcnt vmcnt(39)
    ds_write_b128 v5, v[92:95] offset:8192
    s_waitcnt vmcnt(38)
    ds_write_b128 v5, v[96:99] offset:9216
    s_waitcnt vmcnt(37)
    ds_write_b128 v5, v[100:103] offset:10240
    s_waitcnt vmcnt(36)
    ds_write_b128 v5, v[104:107] offset:11264
    s_waitcnt lgkmcnt(0)
    s_waitcnt lgkmcnt(0)
    ds_read_b64_tr_b16 a[48:49], v7 offset:0
    ds_read_b64_tr_b16 a[50:51], v7 offset:128
    ds_read_b64_tr_b16 a[52:53], v7 offset:1024
    ds_read_b64_tr_b16 a[54:55], v7 offset:1152
    ds_read_b64_tr_b16 a[56:57], v7 offset:2048
    ds_read_b64_tr_b16 a[58:59], v7 offset:2176
    ds_read_b64_tr_b16 a[60:61], v7 offset:3072
    ds_read_b64_tr_b16 a[62:63], v7 offset:3200
    ds_read_b64_tr_b16 a[64:65], v7 offset:4096
    ds_read_b64_tr_b16 a[66:67], v7 offset:4224
    ds_read_b64_tr_b16 a[68:69], v7 offset:5120
    ds_read_b64_tr_b16 a[70:71], v7 offset:5248
    s_waitcnt lgkmcnt(0)
    ds_read_b64_tr_b16 a[72:73], v7 offset:6144
    ds_read_b64_tr_b16 a[74:75], v7 offset:6272
    ds_read_b64_tr_b16 a[76:77], v7 offset:7168
    ds_read_b64_tr_b16 a[78:79], v7 offset:7296
    ds_read_b64_tr_b16 a[80:81], v7 offset:8192
    ds_read_b64_tr_b16 a[82:83], v7 offset:8320
    ds_read_b64_tr_b16 a[84:85], v7 offset:9216
    ds_read_b64_tr_b16 a[86:87], v7 offset:9344
    ds_read_b64_tr_b16 a[88:89], v7 offset:10240
    ds_read_b64_tr_b16 a[90:91], v7 offset:10368
    ds_read_b64_tr_b16 a[92:93], v7 offset:11264
    ds_read_b64_tr_b16 a[94:95], v7 offset:11392
    s_waitcnt lgkmcnt(0)
    s_waitcnt lgkmcnt(0)
    s_waitcnt vmcnt(35)
    ds_write_b128 v5, v[108:111] offset:0
    s_waitcnt vmcnt(34)
    ds_write_b128 v5, v[112:115] offset:1024
    s_waitcnt vmcnt(33)
    ds_write_b128 v5, v[116:119] offset:2048
    s_waitcnt vmcnt(32)
    ds_write_b128 v5, v[120:123] offset:3072
    s_waitcnt vmcnt(31)
    ds_write_b128 v5, v[124:127] offset:4096
    s_waitcnt vmcnt(30)
    ds_write_b128 v5, v[128:131] offset:5120
    s_waitcnt vmcnt(29)
    ds_write_b128 v5, v[132:135] offset:6144
    s_waitcnt vmcnt(28)
    ds_write_b128 v5, v[136:139] offset:7168
    s_waitcnt vmcnt(27)
    ds_write_b128 v5, v[140:143] offset:8192
    s_waitcnt vmcnt(26)
    ds_write_b128 v5, v[144:147] offset:9216
    s_waitcnt vmcnt(25)
    ds_write_b128 v5, v[148:151] offset:10240
    s_waitcnt vmcnt(24)
    ds_write_b128 v5, v[152:155] offset:11264
    s_waitcnt lgkmcnt(0)
    s_waitcnt lgkmcnt(0)
    ds_read_b64_tr_b16 a[96:97], v7 offset:0
    ds_read_b64_tr_b16 a[98:99], v7 offset:128
    ds_read_b64_tr_b16 a[100:101], v7 offset:1024
    ds_read_b64_tr_b16 a[102:103], v7 offset:1152
    ds_read_b64_tr_b16 a[104:105], v7 offset:2048
    ds_read_b64_tr_b16 a[106:107], v7 offset:2176
    ds_read_b64_tr_b16 a[108:109], v7 offset:3072
    ds_read_b64_tr_b16 a[110:111], v7 offset:3200
    ds_read_b64_tr_b16 a[112:113], v7 offset:4096
    ds_read_b64_tr_b16 a[114:115], v7 offset:4224
    ds_read_b64_tr_b16 a[116:117], v7 offset:5120
    ds_read_b64_tr_b16 a[118:119], v7 offset:5248
    s_waitcnt lgkmcnt(0)
    ds_read_b64_tr_b16 a[120:121], v7 offset:6144
    ds_read_b64_tr_b16 a[122:123], v7 offset:6272
    ds_read_b64_tr_b16 a[124:125], v7 offset:7168
    ds_read_b64_tr_b16 a[126:127], v7 offset:7296
    ds_read_b64_tr_b16 a[128:129], v7 offset:8192
    ds_read_b64_tr_b16 a[130:131], v7 offset:8320
    ds_read_b64_tr_b16 a[132:133], v7 offset:9216
    ds_read_b64_tr_b16 a[134:135], v7 offset:9344
    ds_read_b64_tr_b16 a[136:137], v7 offset:10240
    ds_read_b64_tr_b16 a[138:139], v7 offset:10368
    ds_read_b64_tr_b16 a[140:141], v7 offset:11264
    ds_read_b64_tr_b16 a[142:143], v7 offset:11392
    s_waitcnt lgkmcnt(0)
    s_waitcnt lgkmcnt(0)
    s_waitcnt vmcnt(23)
    ds_write_b128 v5, v[156:159] offset:0
    s_waitcnt vmcnt(22)
    ds_write_b128 v5, v[160:163] offset:1024
    s_waitcnt vmcnt(21)
    ds_write_b128 v5, v[164:167] offset:2048
    s_waitcnt vmcnt(20)
    ds_write_b128 v5, v[168:171] offset:3072
    s_waitcnt vmcnt(19)
    ds_write_b128 v5, v[172:175] offset:4096
    s_waitcnt vmcnt(18)
    ds_write_b128 v5, v[176:179] offset:5120
    s_waitcnt vmcnt(17)
    ds_write_b128 v5, v[180:183] offset:6144
    s_waitcnt vmcnt(16)
    ds_write_b128 v5, v[184:187] offset:7168
    s_waitcnt vmcnt(15)
    ds_write_b128 v5, v[188:191] offset:8192
    s_waitcnt vmcnt(14)
    ds_write_b128 v5, v[192:195] offset:9216
    s_waitcnt vmcnt(13)
    ds_write_b128 v5, v[196:199] offset:10240
    s_waitcnt vmcnt(12)
    ds_write_b128 v5, v[200:203] offset:11264
    s_waitcnt lgkmcnt(0)
    s_waitcnt lgkmcnt(0)
    ds_read_b64_tr_b16 a[144:145], v7 offset:0
    ds_read_b64_tr_b16 a[146:147], v7 offset:128
    ds_read_b64_tr_b16 a[148:149], v7 offset:1024
    ds_read_b64_tr_b16 a[150:151], v7 offset:1152
    ds_read_b64_tr_b16 a[152:153], v7 offset:2048
    ds_read_b64_tr_b16 a[154:155], v7 offset:2176
    ds_read_b64_tr_b16 a[156:157], v7 offset:3072
    ds_read_b64_tr_b16 a[158:159], v7 offset:3200
    ds_read_b64_tr_b16 a[160:161], v7 offset:4096
    ds_read_b64_tr_b16 a[162:163], v7 offset:4224
    ds_read_b64_tr_b16 a[164:165], v7 offset:5120
    ds_read_b64_tr_b16 a[166:167], v7 offset:5248
    s_waitcnt lgkmcnt(0)
    ds_read_b64_tr_b16 a[168:169], v7 offset:6144
    ds_read_b64_tr_b16 a[170:171], v7 offset:6272
    ds_read_b64_tr_b16 a[172:173], v7 offset:7168
    ds_read_b64_tr_b16 a[174:175], v7 offset:7296
    ds_read_b64_tr_b16 a[176:177], v7 offset:8192
    ds_read_b64_tr_b16 a[178:179], v7 offset:8320
    ds_read_b64_tr_b16 a[180:181], v7 offset:9216
    ds_read_b64_tr_b16 a[182:183], v7 offset:9344
    ds_read_b64_tr_b16 a[184:185], v7 offset:10240
    ds_read_b64_tr_b16 a[186:187], v7 offset:10368
    ds_read_b64_tr_b16 a[188:189], v7 offset:11264
    ds_read_b64_tr_b16 a[190:191], v7 offset:11392
    s_waitcnt lgkmcnt(0)
    s_waitcnt lgkmcnt(0)
    s_waitcnt vmcnt(11)
    ds_write_b128 v5, v[204:207] offset:0
    s_waitcnt vmcnt(10)
    ds_write_b128 v5, v[208:211] offset:1024
    s_waitcnt vmcnt(9)
    ds_write_b128 v5, v[212:215] offset:2048
    s_waitcnt vmcnt(8)
    ds_write_b128 v5, v[216:219] offset:3072
    s_waitcnt vmcnt(7)
    ds_write_b128 v5, v[220:223] offset:4096
    s_waitcnt vmcnt(6)
    ds_write_b128 v5, v[224:227] offset:5120
    s_waitcnt vmcnt(5)
    ds_write_b128 v5, v[228:231] offset:6144
    s_waitcnt vmcnt(4)
    ds_write_b128 v5, v[232:235] offset:7168
    s_waitcnt vmcnt(3)
    ds_write_b128 v5, v[236:239] offset:8192
    s_waitcnt vmcnt(2)
    ds_write_b128 v5, v[240:243] offset:9216
    s_waitcnt vmcnt(1)
    ds_write_b128 v5, v[244:247] offset:10240
    s_waitcnt vmcnt(0)
    ds_write_b128 v5, v[248:251] offset:11264
    s_waitcnt lgkmcnt(0)
    s_waitcnt lgkmcnt(0)
    ds_read_b64_tr_b16 a[192:193], v7 offset:0
    ds_read_b64_tr_b16 a[194:195], v7 offset:128
    ds_read_b64_tr_b16 a[196:197], v7 offset:1024
    ds_read_b64_tr_b16 a[198:199], v7 offset:1152
    ds_read_b64_tr_b16 a[200:201], v7 offset:2048
    ds_read_b64_tr_b16 a[202:203], v7 offset:2176
    ds_read_b64_tr_b16 a[204:205], v7 offset:3072
    ds_read_b64_tr_b16 a[206:207], v7 offset:3200
    ds_read_b64_tr_b16 a[208:209], v7 offset:4096
    ds_read_b64_tr_b16 a[210:211], v7 offset:4224
    ds_read_b64_tr_b16 a[212:213], v7 offset:5120
    ds_read_b64_tr_b16 a[214:215], v7 offset:5248
    s_waitcnt lgkmcnt(0)
    ds_read_b64_tr_b16 a[216:217], v7 offset:6144
    ds_read_b64_tr_b16 a[218:219], v7 offset:6272
    ds_read_b64_tr_b16 a[220:221], v7 offset:7168
    ds_read_b64_tr_b16 a[222:223], v7 offset:7296
    ds_read_b64_tr_b16 a[224:225], v7 offset:8192
    ds_read_b64_tr_b16 a[226:227], v7 offset:8320
    ds_read_b64_tr_b16 a[228:229], v7 offset:9216
    ds_read_b64_tr_b16 a[230:231], v7 offset:9344
    ds_read_b64_tr_b16 a[232:233], v7 offset:10240
    ds_read_b64_tr_b16 a[234:235], v7 offset:10368
    ds_read_b64_tr_b16 a[236:237], v7 offset:11264
    ds_read_b64_tr_b16 a[238:239], v7 offset:11392
    s_waitcnt lgkmcnt(0)
    s_waitcnt lgkmcnt(0)
    v_lshlrev_b32 v4, 6, v1
    v_lshl_add_u32 v4, v2, 4, v4
    s_mul_i32 s64, s16, 48
    s_mul_i32 s65, s91, 12
    s_add_u32 s64, s64, s65
    s_lshl_b32 s50, s64, 11
    s_mul_i32 s64, s91, 10240
    v_lshl_add_u32 v5, v3, 4, s64
    v_lshlrev_b32 v6, 4, v3
    v_mul_u32_u24 v7, 1280, v1
    s_mul_i32 s64, s17, 160
    v_lshl_add_u32 v7, v2, 3, v7
    v_add_u32 v7, s64, v7
    s_barrier
    s_mul_i32 s49, s17, 160
    v_lshlrev_b32 v8, 2, v3
    buffer_load_dword v10, v8, s[68:71], s49 offen
    v_add_u32 v9, 49152, v8
    s_waitcnt vmcnt(0)
    ds_write_b32 v9, v10
    v_lshlrev_b32 v9, 3, v2
    v_add_u32 v9, 49152, v9
    s_waitcnt lgkmcnt(0)
    s_barrier
    s_add_u32 s93, s54, 128
    s_lshl_b32 s93, s93, 8
    v_mov_b32 v254, s93
wk_poll_139:
    buffer_load_dword v255, v254, s[28:31], 0 offen sc1
    s_waitcnt vmcnt(0)
    v_cmp_le_u32 vcc, 8, v255
    s_cbranch_vccnz wk_ok_140
    s_sleep 8
    s_add_u32 s92, s92, 1
    s_cmp_lt_u32 s92, 1048576
    s_cbranch_scc1 wk_poll_139
wk_ok_140:
    s_mul_i32 s48, s54, 98304
    s_add_u32 s48, s48, s50
    buffer_load_dwordx4 v[12:15], v4, s[40:43], s48 offen sc1
    s_add_u32 s48, s48, 1024
    buffer_load_dwordx4 v[16:19], v4, s[40:43], s48 offen sc1
    s_add_u32 s48, s48, 1024
    buffer_load_dwordx4 v[20:23], v4, s[40:43], s48 offen sc1
    s_add_u32 s48, s48, 1024
    buffer_load_dwordx4 v[24:27], v4, s[40:43], s48 offen sc1
    s_add_u32 s48, s48, 1024
    buffer_load_dwordx4 v[28:31], v4, s[40:43], s48 offen sc1
    s_add_u32 s48, s48, 1024
    buffer_load_dwordx4 v[32:35], v4, s[40:43], s48 offen sc1
    s_add_u32 s48, s48, 1024
    buffer_load_dwordx4 v[36:39], v4, s[40:43], s48 offen sc1
    s_add_u32 s48, s48, 1024
    buffer_load_dwordx4 v[40:43], v4, s[40:43], s48 offen sc1
    s_add_u32 s48, s48, 1024
    buffer_load_dwordx4 v[44:47], v4, s[40:43], s48 offen sc1
    s_add_u32 s48, s48, 1024
    buffer_load_dwordx4 v[48:51], v4, s[40:43], s48 offen sc1
    s_add_u32 s48, s48, 1024
    buffer_load_dwordx4 v[52:55], v4, s[40:43], s48 offen sc1
    s_add_u32 s48, s48, 1024
    buffer_load_dwordx4 v[56:59], v4, s[40:43], s48 offen sc1
    s_add_u32 s48, s48, 1024
    buffer_load_dwordx4 v[60:63], v4, s[40:43], s48 offen sc1
    s_add_u32 s48, s48, 1024
    buffer_load_dwordx4 v[64:67], v4, s[40:43], s48 offen sc1
    s_add_u32 s48, s48, 1024
    buffer_load_dwordx4 v[68:71], v4, s[40:43], s48 offen sc1
    s_add_u32 s48, s48, 1024
    buffer_load_dwordx4 v[72:75], v4, s[40:43], s48 offen sc1
    s_add_u32 s48, s48, 1024
    buffer_load_dwordx4 v[76:79], v4, s[40:43], s48 offen sc1
    s_add_u32 s48, s48, 1024
    buffer_load_dwordx4 v[80:83], v4, s[40:43], s48 offen sc1
    s_add_u32 s48, s48, 1024
    buffer_load_dwordx4 v[84:87], v4, s[40:43], s48 offen sc1
    s_add_u32 s48, s48, 1024
    buffer_load_dwordx4 v[88:91], v4, s[40:43], s48 offen sc1
    s_add_u32 s48, s48, 1024
    buffer_load_dwordx4 v[92:95], v4, s[40:43], s48 offen sc1
    s_add_u32 s48, s48, 1024
    buffer_load_dwordx4 v[96:99], v4, s[40:43], s48 offen sc1
    s_add_u32 s48, s48, 1024
    buffer_load_dwordx4 v[100:103], v4, s[40:43], s48 offen sc1
    s_add_u32 s48, s48, 1024
    buffer_load_dwordx4 v[104:107], v4, s[40:43], s48 offen sc1
    s_add_u32 s48, s48, 1024
gk_loop_141:
    s_waitcnt vmcnt(0)
    s_add_u32 s57, s54, s53
    s_cmp_ge_u32 s57, s52
    s_cbranch_scc1 gk_nf_143
    s_add_u32 s93, s57, 128
    s_lshl_b32 s93, s93, 8
    v_mov_b32 v254, s93
wk_poll_144:
    buffer_load_dword v255, v254, s[28:31], 0 offen sc1
    s_waitcnt vmcnt(0)
    v_cmp_le_u32 vcc, 8, v255
    s_cbranch_vccnz wk_ok_145
    s_sleep 8
    s_add_u32 s92, s92, 1
    s_cmp_lt_u32 s92, 1048576
    s_cbranch_scc1 wk_poll_144
wk_ok_145:
    s_mul_i32 s48, s57, 98304
    s_add_u32 s48, s48, s50
    buffer_load_dwordx4 v[108:111], v4, s[40:43], s48 offen sc1
    s_add_u32 s48, s48, 1024
    buffer_load_dwordx4 v[112:115], v4, s[40:43], s48 offen sc1
    s_add_u32 s48, s48, 1024
    buffer_load_dwordx4 v[116:119], v4, s[40:43], s48 offen sc1
    s_add_u32 s48, s48, 1024
    buffer_load_dwordx4 v[120:123], v4, s[40:43], s48 offen sc1
    s_add_u32 s48, s48, 1024
    buffer_load_dwordx4 v[124:127], v4, s[40:43], s48 offen sc1
    s_add_u32 s48, s48, 1024
    buffer_load_dwordx4 v[128:131], v4, s[40:43], s48 offen sc1
    s_add_u32 s48, s48, 1024
    buffer_load_dwordx4 v[132:135], v4, s[40:43], s48 offen sc1
    s_add_u32 s48, s48, 1024
    buffer_load_dwordx4 v[136:139], v4, s[40:43], s48 offen sc1
    s_add_u32 s48, s48, 1024
    buffer_load_dwordx4 v[140:143], v4, s[40:43], s48 offen sc1
    s_add_u32 s48, s48, 1024
    buffer_load_dwordx4 v[144:147], v4, s[40:43], s48 offen sc1
    s_add_u32 s48, s48, 1024
    buffer_load_dwordx4 v[148:151], v4, s[40:43], s48 offen sc1
    s_add_u32 s48, s48, 1024
    buffer_load_dwordx4 v[152:155], v4, s[40:43], s48 offen sc1
    s_add_u32 s48, s48, 1024
    buffer_load_dwordx4 v[156:159], v4, s[40:43], s48 offen sc1
    s_add_u32 s48, s48, 1024
    buffer_load_dwordx4 v[160:163], v4, s[40:43], s48 offen sc1
    s_add_u32 s48, s48, 1024
    buffer_load_dwordx4 v[164:167], v4, s[40:43], s48 offen sc1
    s_add_u32 s48, s48, 1024
    buffer_load_dwordx4 v[168:171], v4, s[40:43], s48 offen sc1
    s_add_u32 s48, s48, 1024
    buffer_load_dwordx4 v[172:175], v4, s[40:43], s48 offen sc1
    s_add_u32 s48, s48, 1024
    buffer_load_dwordx4 v[176:179], v4, s[40:43], s48 offen sc1
    s_add_u32 s48, s48, 1024
    buffer_load_dwordx4 v[180:183], v4, s[40:43], s48 offen sc1
    s_add_u32 s48, s48, 1024
    buffer_load_dwordx4 v[184:187], v4, s[40:43], s48 offen sc1
    s_add_u32 s48, s48, 1024
    buffer_load_dwordx4 v[188:191], v4, s[40:43], s48 offen sc1
    s_add_u32 s48, s48, 1024
    buffer_load_dwordx4 v[192:195], v4, s[40:43], s48 offen sc1
    s_add_u32 s48, s48, 1024
    buffer_load_dwordx4 v[196:199], v4, s[40:43], s48 offen sc1
    s_add_u32 s48, s48, 1024
    buffer_load_dwordx4 v[200:203], v4, s[40:43], s48 offen sc1
    s_add_u32 s48, s48, 1024
gk_nf_143:
    v_mfma_f32_16x16x32_bf16 v[204:207], a[0:3], v[12:15], 0
    v_mfma_f32_16x16x32_bf16 v[208:211], a[48:51], v[12:15], 0
    v_mfma_f32_16x16x32_bf16 v[212:215], a[96:99], v[12:15], 0
    v_mfma_f32_16x16x32_bf16 v[216:219], a[144:147], v[12:15], 0
    v_mfma_f32_16x16x32_bf16 v[220:223], a[192:195], v[12:15], 0
    v_mfma_f32_16x16x32_bf16 v[224:227], a[0:3], v[16:19], 0
    v_mfma_f32_16x16x32_bf16 v[228:231], a[48:51], v[16:19], 0
    v_mfma_f32_16x16x32_bf16 v[232:235], a[96:99], v[16:19], 0
    v_mfma_f32_16x16x32_bf16 v[236:239], a[144:147], v[16:19], 0
    v_mfma_f32_16x16x32_bf16 v[240:243], a[192:195], v[16:19], 0
    v_mfma_f32_16x16x32_bf16 v[204:207], a[4:7], v[20:23], v[204:207]
    v_mfma_f32_16x16x32_bf16 v[208:211], a[52:55], v[20:23], v[208:211]
    v_mfma_f32_16x16x32_bf16 v[212:215], a[100:103], v[20:23], v[212:215]
    v_mfma_f32_16x16x32_bf16 v[216:219], a[148:151], v[20:23], v[216:219]
    v_mfma_f32_16x16x32_bf16 v[220:223], a[196:199], v[20:23], v[220:223]
    v_mfma_f32_16x16x32_bf16 v[224:227], a[4:7], v[24:27], v[224:227]
    v_mfma_f32_16x16x32_bf16 v[228:231], a[52:55], v[24:27], v[228:231]
    v_mfma_f32_16x16x32_bf16 v[232:235], a[100:103], v[24:27], v[232:235]
    v_mfma_f32_16x16x32_bf16 v[236:239], a[148:151], v[24:27], v[236:239]
    v_mfma_f32_16x16x32_bf16 v[240:243], a[196:199], v[24:27], v[240:243]
    v_mfma_f32_16x16x32_bf16 v[204:207], a[8:11], v[28:31], v[204:207]
    v_mfma_f32_16x16x32_bf16 v[208:211], a[56:59], v[28:31], v[208:211]
    v_mfma_f32_16x16x32_bf16 v[212:215], a[104:107], v[28:31], v[212:215]
    v_mfma_f32_16x16x32_bf16 v[216:219], a[152:155], v[28:31], v[216:219]
    v_mfma_f32_16x16x32_bf16 v[220:223], a[200:203], v[28:31], v[220:223]
    v_mfma_f32_16x16x32_bf16 v[224:227], a[8:11], v[32:35], v[224:227]
    v_mfma_f32_16x16x32_bf16 v[228:231], a[56:59], v[32:35], v[228:231]
    v_mfma_f32_16x16x32_bf16 v[232:235], a[104:107], v[32:35], v[232:235]
    v_mfma_f32_16x16x32_bf16 v[236:239], a[152:155], v[32:35], v[236:239]
    v_mfma_f32_16x16x32_bf16 v[240:243], a[200:203], v[32:35], v[240:243]
    v_mfma_f32_16x16x32_bf16 v[204:207], a[12:15], v[36:39], v[204:207]
    v_mfma_f32_16x16x32_bf16 v[208:211], a[60:63], v[36:39], v[208:211]
    v_mfma_f32_16x16x32_bf16 v[212:215], a[108:111], v[36:39], v[212:215]
    v_mfma_f32_16x16x32_bf16 v[216:219], a[156:159], v[36:39], v[216:219]
    v_mfma_f32_16x16x32_bf16 v[220:223], a[204:207], v[36:39], v[220:223]
    v_mfma_f32_16x16x32_bf16 v[224:227], a[12:15], v[40:43], v[224:227]
    v_mfma_f32_16x16x32_bf16 v[228:231], a[60:63], v[40:43], v[228:231]
    v_mfma_f32_16x16x32_bf16 v[232:235], a[108:111], v[40:43], v[232:235]
    v_mfma_f32_16x16x32_bf16 v[236:239], a[156:159], v[40:43], v[236:239]
    v_mfma_f32_16x16x32_bf16 v[240:243], a[204:207], v[40:43], v[240:243]
    v_mfma_f32_16x16x32_bf16 v[204:207], a[16:19], v[44:47], v[204:207]
    v_mfma_f32_16x16x32_bf16 v[208:211], a[64:67], v[44:47], v[208:211]
    v_mfma_f32_16x16x32_bf16 v[212:215], a[112:115], v[44:47], v[212:215]
    v_mfma_f32_16x16x32_bf16 v[216:219], a[160:163], v[44:47], v[216:219]
    v_mfma_f32_16x16x32_bf16 v[220:223], a[208:211], v[44:47], v[220:223]
    v_mfma_f32_16x16x32_bf16 v[224:227], a[16:19], v[48:51], v[224:227]
    v_mfma_f32_16x16x32_bf16 v[228:231], a[64:67], v[48:51], v[228:231]
    v_mfma_f32_16x16x32_bf16 v[232:235], a[112:115], v[48:51], v[232:235]
    v_mfma_f32_16x16x32_bf16 v[236:239], a[160:163], v[48:51], v[236:239]
    v_mfma_f32_16x16x32_bf16 v[240:243], a[208:211], v[48:51], v[240:243]
    v_mfma_f32_16x16x32_bf16 v[204:207], a[20:23], v[52:55], v[204:207]
    v_mfma_f32_16x16x32_bf16 v[208:211], a[68:71], v[52:55], v[208:211]
    v_mfma_f32_16x16x32_bf16 v[212:215], a[116:119], v[52:55], v[212:215]
    v_mfma_f32_16x16x32_bf16 v[216:219], a[164:167], v[52:55], v[216:219]
    v_mfma_f32_16x16x32_bf16 v[220:223], a[212:215], v[52:55], v[220:223]
    v_mfma_f32_16x16x32_bf16 v[224:227], a[20:23], v[56:59], v[224:227]
    v_mfma_f32_16x16x32_bf16 v[228:231], a[68:71], v[56:59], v[228:231]
    v_mfma_f32_16x16x32_bf16 v[232:235], a[116:119], v[56:59], v[232:235]
    v_mfma_f32_16x16x32_bf16 v[236:239], a[164:167], v[56:59], v[236:239]
    v_mfma_f32_16x16x32_bf16 v[240:243], a[212:215], v[56:59], v[240:243]
    v_mfma_f32_16x16x32_bf16 v[204:207], a[24:27], v[60:63], v[204:207]
    v_mfma_f32_16x16x32_bf16 v[208:211], a[72:75], v[60:63], v[208:211]
    v_mfma_f32_16x16x32_bf16 v[212:215], a[120:123], v[60:63], v[212:215]
    v_mfma_f32_16x16x32_bf16 v[216:219], a[168:171], v[60:63], v[216:219]
    v_mfma_f32_16x16x32_bf16 v[220:223], a[216:219], v[60:63], v[220:223]
    v_mfma_f32_16x16x32_bf16 v[224:227], a[24:27], v[64:67], v[224:227]
    v_mfma_f32_16x16x32_bf16 v[228:231], a[72:75], v[64:67], v[228:231]
    v_mfma_f32_16x16x32_bf16 v[232:235], a[120:123], v[64:67], v[232:235]
    v_mfma_f32_16x16x32_bf16 v[236:239], a[168:171], v[64:67], v[236:239]
    v_mfma_f32_16x16x32_bf16 v[240:243], a[216:219], v[64:67], v[240:243]
    v_mfma_f32_16x16x32_bf16 v[204:207], a[28:31], v[68:71], v[204:207]
    v_mfma_f32_16x16x32_bf16 v[208:211], a[76:79], v[68:71], v[208:211]
    v_mfma_f32_16x16x32_bf16 v[212:215], a[124:127], v[68:71], v[212:215]
    v_mfma_f32_16x16x32_bf16 v[216:219], a[172:175], v[68:71], v[216:219]
    v_mfma_f32_16x16x32_bf16 v[220:223], a[220:223], v[68:71], v[220:223]
    v_mfma_f32_16x16x32_bf16 v[224:227], a[28:31], v[72:75], v[224:227]
    v_mfma_f32_16x16x32_bf16 v[228:231], a[76:79], v[72:75], v[228:231]
    v_mfma_f32_16x16x32_bf16 v[232:235], a[124:127], v[72:75], v[232:235]
    v_mfma_f32_16x16x32_bf16 v[236:239], a[172:175], v[72:75], v[236:239]
    v_mfma_f32_16x16x32_bf16 v[240:243], a[220:223], v[72:75], v[240:243]
    v_mfma_f32_16x16x32_bf16 v[204:207], a[32:35], v[76:79], v[204:207]
    v_mfma_f32_16x16x32_bf16 v[208:211], a[80:83], v[76:79], v[208:211]
    v_mfma_f32_16x16x32_bf16 v[212:215], a[128:131], v[76:79], v[212:215]
    v_mfma_f32_16x16x32_bf16 v[216:219], a[176:179], v[76:79], v[216:219]
    v_mfma_f32_16x16x32_bf16 v[220:223], a[224:227], v[76:79], v[220:223]
    v_mfma_f32_16x16x32_bf16 v[224:227], a[32:35], v[80:83], v[224:227]
    v_mfma_f32_16x16x32_bf16 v[228:231], a[80:83], v[80:83], v[228:231]
    v_mfma_f32_16x16x32_bf16 v[232:235], a[128:131], v[80:83], v[232:235]
    v_mfma_f32_16x16x32_bf16 v[236:239], a[176:179], v[80:83], v[236:239]
    v_mfma_f32_16x16x32_bf16 v[240:243], a[224:227], v[80:83], v[240:243]
    v_mfma_f32_16x16x32_bf16 v[204:207], a[36:39], v[84:87], v[204:207]
    v_mfma_f32_16x16x32_bf16 v[208:211], a[84:87], v[84:87], v[208:211]
    v_mfma_f32_16x16x32_bf16 v[212:215], a[132:135], v[84:87], v[212:215]
    v_mfma_f32_16x16x32_bf16 v[216:219], a[180:183], v[84:87], v[216:219]
    v_mfma_f32_16x16x32_bf16 v[220:223], a[228:231], v[84:87], v[220:223]
    v_mfma_f32_16x16x32_bf16 v[224:227], a[36:39], v[88:91], v[224:227]
    v_mfma_f32_16x16x32_bf16 v[228:231], a[84:87], v[88:91], v[228:231]
    v_mfma_f32_16x16x32_bf16 v[232:235], a[132:135], v[88:91], v[232:235]
    v_mfma_f32_16x16x32_bf16 v[236:239], a[180:183], v[88:91], v[236:239]
    v_mfma_f32_16x16x32_bf16 v[240:243], a[228:231], v[88:91], v[240:243]
    v_mfma_f32_16x16x32_bf16 v[204:207], a[40:43], v[92:95], v[204:207]
    v_mfma_f32_16x16x32_bf16 v[208:211], a[88:91], v[92:95], v[208:211]
    v_mfma_f32_16x16x32_bf16 v[212:215], a[136:139], v[92:95], v[212:215]
    v_mfma_f32_16x16x32_bf16 v[216:219], a[184:187], v[92:95], v[216:219]
    v_mfma_f32_16x16x32_bf16 v[220:223], a[232:235], v[92:95], v[220:223]
    v_mfma_f32_16x16x32_bf16 v[224:227], a[40:43], v[96:99], v[224:227]
    v_mfma_f32_16x16x32_bf16 v[228:231], a[88:91], v[96:99], v[228:231]
    v_mfma_f32_16x16x32_bf16 v[232:235], a[136:139], v[96:99], v[232:235]
    v_mfma_f32_16x16x32_bf16 v[236:239], a[184:187], v[96:99], v[236:239]
    v_mfma_f32_16x16x32_bf16 v[240:243], a[232:235], v[96:99], v[240:243]
    v_mfma_f32_16x16x32_bf16 v[204:207], a[44:47], v[100:103], v[204:207]
    v_mfma_f32_16x16x32_bf16 v[208:211], a[92:95], v[100:103], v[208:211]
    v_mfma_f32_16x16x32_bf16 v[212:215], a[140:143], v[100:103], v[212:215]
    v_mfma_f32_16x16x32_bf16 v[216:219], a[188:191], v[100:103], v[216:219]
    v_mfma_f32_16x16x32_bf16 v[220:223], a[236:239], v[100:103], v[220:223]
    v_mfma_f32_16x16x32_bf16 v[224:227], a[44:47], v[104:107], v[224:227]
    v_mfma_f32_16x16x32_bf16 v[228:231], a[92:95], v[104:107], v[228:231]
    v_mfma_f32_16x16x32_bf16 v[232:235], a[140:143], v[104:107], v[232:235]
    v_mfma_f32_16x16x32_bf16 v[236:239], a[188:191], v[104:107], v[236:239]
    v_mfma_f32_16x16x32_bf16 v[240:243], a[236:239], v[104:107], v[240:243]
    s_nop 7
    ds_write_b128 v5, v[204:207] offset:0
    ds_write_b128 v5, v[208:211] offset:1024
    ds_write_b128 v5, v[212:215] offset:2048
    ds_write_b128 v5, v[216:219] offset:3072
    ds_write_b128 v5, v[220:223] offset:4096
    ds_write_b128 v5, v[224:227] offset:5120
    ds_write_b128 v5, v[228:231] offset:6144
    ds_write_b128 v5, v[232:235] offset:7168
    ds_write_b128 v5, v[236:239] offset:8192
    ds_write_b128 v5, v[240:243] offset:9216
    s_waitcnt lgkmcnt(0)
    s_barrier
    s_mul_i32 s55, s54, 40960
    s_cmp_lg_u32 s91, 0
    s_cbranch_scc1 gk_w_147
    ds_read_b128 v[12:15], v6 offset:0
    ds_read_b128 v[16:19], v6 offset:10240
    ds_read_b128 v[20:23], v6 offset:20480
    ds_read_b128 v[24:27], v6 offset:30720
    ds_read_b128 v[28:31], v6 offset:4096
    ds_read_b128 v[32:35], v6 offset:14336
    ds_read_b128 v[36:39], v6 offset:24576
    ds_read_b128 v[40:43], v6 offset:34816
    ds_read_b128 v[44:47], v6 offset:8192
    ds_read_b128 v[48:51], v6 offset:18432
    ds_read_b128 v[52:55], v6 offset:28672
    ds_read_b128 v[56:59], v6 offset:38912
    s_waitcnt lgkmcnt(8)
    v_pk_add_f32 v[12:13], v[12:13], v[16:17]
    v_pk_add_f32 v[20:21], v[20:21], v[24:25]
    v_pk_add_f32 v[14:15], v[14:15], v[18:19]
    v_pk_add_f32 v[22:23], v[22:23], v[26:27]
    v_pk_add_f32 v[12:13], v[12:13], v[20:21]
    v_pk_add_f32 v[14:15], v[14:15], v[22:23]
    s_add_u32 s64, s55, 0
    ds_read_b64 v[248:249], v9 offset:0
    s_waitcnt lgkmcnt(0)
    v_and_b32 v245, 0xffff0000, v248
    v_lshlrev_b32 v244, 16, v248
    v_and_b32 v247, 0xffff0000, v249
    v_lshlrev_b32 v246, 16, v249
    v_cvt_pk_bf16_f32 v16, v12, v13
    v_and_b32 v13, 0xffff0000, v16
    v_lshlrev_b32 v12, 16, v16
    v_add_f32 v12, v12, v244
    v_add_f32 v13, v13, v245
    v_cvt_pk_bf16_f32 v16, v12, v13
    v_and_b32 v13, 0xffff0000, v16
    v_lshlrev_b32 v12, 16, v16
    v_mul_f32 v17, 0xbfb8aa3b, v12
    v_exp_f32 v17, v17
    v_mul_f32 v18, 0xbfb8aa3b, v13
    v_exp_f32 v18, v18
    s_nop 0
    v_add_f32 v17, 1.0, v17
    v_rcp_f32 v17, v17
    v_add_f32 v18, 1.0, v18
    v_rcp_f32 v18, v18
    s_nop 0
    v_mul_f32 v12, v12, v17
    v_mul_f32 v13, v13, v18
    v_cvt_pk_bf16_f32 v16, v12, v13
    v_cvt_pk_bf16_f32 v20, v14, v15
    v_and_b32 v15, 0xffff0000, v20
    v_lshlrev_b32 v14, 16, v20
    v_add_f32 v14, v14, v246
    v_add_f32 v15, v15, v247
    v_cvt_pk_bf16_f32 v20, v14, v15
    v_and_b32 v15, 0xffff0000, v20
    v_lshlrev_b32 v14, 16, v20
    v_mul_f32 v21, 0xbfb8aa3b, v14
    v_exp_f32 v21, v21
    v_mul_f32 v22, 0xbfb8aa3b, v15
    v_exp_f32 v22, v22
    s_nop 0
    v_add_f32 v21, 1.0, v21
    v_rcp_f32 v21, v21
    v_add_f32 v22, 1.0, v22
    v_rcp_f32 v22, v22
    s_nop 0
    v_mul_f32 v14, v14, v21
    v_mul_f32 v15, v15, v22
    v_cvt_pk_bf16_f32 v20, v14, v15
    v_mov_b32 v17, v20
    buffer_store_dwordx2 v[16:17], v7, s[60:63], s64 offen
    s_waitcnt lgkmcnt(4)
    v_pk_add_f32 v[28:29], v[28:29], v[32:33]
    v_pk_add_f32 v[36:37], v[36:37], v[40:41]
    v_pk_add_f32 v[30:31], v[30:31], v[34:35]
    v_pk_add_f32 v[38:39], v[38:39], v[42:43]
    v_pk_add_f32 v[28:29], v[28:29], v[36:37]
    v_pk_add_f32 v[30:31], v[30:31], v[38:39]
    s_add_u32 s64, s55, 128
    ds_read_b64 v[248:249], v9 offset:128
    s_waitcnt lgkmcnt(0)
    v_and_b32 v245, 0xffff0000, v248
    v_lshlrev_b32 v244, 16, v248
    v_and_b32 v247, 0xffff0000, v249
    v_lshlrev_b32 v246, 16, v249
    v_cvt_pk_bf16_f32 v32, v28, v29
    v_and_b32 v29, 0xffff0000, v32
    v_lshlrev_b32 v28, 16, v32
    v_add_f32 v28, v28, v244
    v_add_f32 v29, v29, v245
    v_cvt_pk_bf16_f32 v32, v28, v29
    v_and_b32 v29, 0xffff0000, v32
    v_lshlrev_b32 v28, 16, v32
    v_mul_f32 v33, 0xbfb8aa3b, v28
    v_exp_f32 v33, v33
    v_mul_f32 v34, 0xbfb8aa3b, v29
    v_exp_f32 v34, v34
    s_nop 0
    v_add_f32 v33, 1.0, v33
    v_rcp_f32 v33, v33
    v_add_f32 v34, 1.0, v34
    v_rcp_f32 v34, v34
    s_nop 0
    v_mul_f32 v28, v28, v33
    v_mul_f32 v29, v29, v34
    v_cvt_pk_bf16_f32 v32, v28, v29
    v_cvt_pk_bf16_f32 v36, v30, v31
    v_and_b32 v31, 0xffff0000, v36
    v_lshlrev_b32 v30, 16, v36
    v_add_f32 v30, v30, v246
    v_add_f32 v31, v31, v247
    v_cvt_pk_bf16_f32 v36, v30, v31
    v_and_b32 v31, 0xffff0000, v36
    v_lshlrev_b32 v30, 16, v36
    v_mul_f32 v37, 0xbfb8aa3b, v30
    v_exp_f32 v37, v37
    v_mul_f32 v38, 0xbfb8aa3b, v31
    v_exp_f32 v38, v38
    s_nop 0
    v_add_f32 v37, 1.0, v37
    v_rcp_f32 v37, v37
    v_add_f32 v38, 1.0, v38
    v_rcp_f32 v38, v38
    s_nop 0
    v_mul_f32 v30, v30, v37
    v_mul_f32 v31, v31, v38
    v_cvt_pk_bf16_f32 v36, v30, v31
    v_mov_b32 v33, v36
    buffer_store_dwordx2 v[32:33], v7, s[60:63], s64 offen
    s_waitcnt lgkmcnt(0)
    v_pk_add_f32 v[44:45], v[44:45], v[48:49]
    v_pk_add_f32 v[52:53], v[52:53], v[56:57]
    v_pk_add_f32 v[46:47], v[46:47], v[50:51]
    v_pk_add_f32 v[54:55], v[54:55], v[58:59]
    v_pk_add_f32 v[44:45], v[44:45], v[52:53]
    v_pk_add_f32 v[46:47], v[46:47], v[54:55]
    s_add_u32 s64, s55, 20576
    ds_read_b64 v[248:249], v9 offset:96
    s_waitcnt lgkmcnt(0)
    v_and_b32 v245, 0xffff0000, v248
    v_lshlrev_b32 v244, 16, v248
    v_and_b32 v247, 0xffff0000, v249
    v_lshlrev_b32 v246, 16, v249
    v_cvt_pk_bf16_f32 v48, v44, v45
    v_and_b32 v45, 0xffff0000, v48
    v_lshlrev_b32 v44, 16, v48
    v_add_f32 v44, v44, v244
    v_add_f32 v45, v45, v245
    v_cvt_pk_bf16_f32 v48, v44, v45
    v_and_b32 v45, 0xffff0000, v48
    v_lshlrev_b32 v44, 16, v48
    v_mul_f32 v49, 0xbfb8aa3b, v44
    v_exp_f32 v49, v49
    v_mul_f32 v50, 0xbfb8aa3b, v45
    v_exp_f32 v50, v50
    s_nop 0
    v_add_f32 v49, 1.0, v49
    v_rcp_f32 v49, v49
    v_add_f32 v50, 1.0, v50
    v_rcp_f32 v50, v50
    s_nop 0
    v_mul_f32 v44, v44, v49
    v_mul_f32 v45, v45, v50
    v_cvt_pk_bf16_f32 v48, v44, v45
    v_cvt_pk_bf16_f32 v52, v46, v47
    v_and_b32 v47, 0xffff0000, v52
    v_lshlrev_b32 v46, 16, v52
    v_add_f32 v46, v46, v246
    v_add_f32 v47, v47, v247
    v_cvt_pk_bf16_f32 v52, v46, v47
    v_and_b32 v47, 0xffff0000, v52
    v_lshlrev_b32 v46, 16, v52
    v_mul_f32 v53, 0xbfb8aa3b, v46
    v_exp_f32 v53, v53
    v_mul_f32 v54, 0xbfb8aa3b, v47
    v_exp_f32 v54, v54
    s_nop 0
    v_add_f32 v53, 1.0, v53
    v_rcp_f32 v53, v53
    v_add_f32 v54, 1.0, v54
    v_rcp_f32 v54, v54
    s_nop 0
    v_mul_f32 v46, v46, v53
    v_mul_f32 v47, v47, v54
    v_cvt_pk_bf16_f32 v52, v46, v47
    v_mov_b32 v49, v52
    buffer_store_dwordx2 v[48:49], v7, s[60:63], s64 offen
    s_branch gk_rend_146
gk_w_147:
    s_cmp_lg_u32 s91, 1
    s_cbranch_scc1 gk_w_148
    ds_read_b128 v[12:15], v6 offset:1024
    ds_read_b128 v[16:19], v6 offset:11264
    ds_read_b128 v[20:23], v6 offset:21504
    ds_read_b128 v[24:27], v6 offset:31744
    ds_read_b128 v[28:31], v6 offset:5120
    ds_read_b128 v[32:35], v6 offset:15360
    ds_read_b128 v[36:39], v6 offset:25600
    ds_read_b128 v[40:43], v6 offset:35840
    ds_read_b128 v[44:47], v6 offset:9216
    ds_read_b128 v[48:51], v6 offset:19456
    ds_read_b128 v[52:55], v6 offset:29696
    ds_read_b128 v[56:59], v6 offset:39936
    s_waitcnt lgkmcnt(8)
    v_pk_add_f32 v[12:13], v[12:13], v[16:17]
    v_pk_add_f32 v[20:21], v[20:21], v[24:25]
    v_pk_add_f32 v[14:15], v[14:15], v[18:19]
    v_pk_add_f32 v[22:23], v[22:23], v[26:27]
    v_pk_add_f32 v[12:13], v[12:13], v[20:21]
    v_pk_add_f32 v[14:15], v[14:15], v[22:23]
    s_add_u32 s64, s55, 32
    ds_read_b64 v[248:249], v9 offset:32
    s_waitcnt lgkmcnt(0)
    v_and_b32 v245, 0xffff0000, v248
    v_lshlrev_b32 v244, 16, v248
    v_and_b32 v247, 0xffff0000, v249
    v_lshlrev_b32 v246, 16, v249
    v_cvt_pk_bf16_f32 v16, v12, v13
    v_and_b32 v13, 0xffff0000, v16
    v_lshlrev_b32 v12, 16, v16
    v_add_f32 v12, v12, v244
    v_add_f32 v13, v13, v245
    v_cvt_pk_bf16_f32 v16, v12, v13
    v_and_b32 v13, 0xffff0000, v16
    v_lshlrev_b32 v12, 16, v16
    v_mul_f32 v17, 0xbfb8aa3b, v12
    v_exp_f32 v17, v17
    v_mul_f32 v18, 0xbfb8aa3b, v13
    v_exp_f32 v18, v18
    s_nop 0
    v_add_f32 v17, 1.0, v17
    v_rcp_f32 v17, v17
    v_add_f32 v18, 1.0, v18
    v_rcp_f32 v18, v18
    s_nop 0
    v_mul_f32 v12, v12, v17
    v_mul_f32 v13, v13, v18
    v_cvt_pk_bf16_f32 v16, v12, v13
    v_cvt_pk_bf16_f32 v20, v14, v15
    v_and_b32 v15, 0xffff0000, v20
    v_lshlrev_b32 v14, 16, v20
    v_add_f32 v14, v14, v246
    v_add_f32 v15, v15, v247
    v_cvt_pk_bf16_f32 v20, v14, v15
    v_and_b32 v15, 0xffff0000, v20
    v_lshlrev_b32 v14, 16, v20
    v_mul_f32 v21, 0xbfb8aa3b, v14
    v_exp_f32 v21, v21
    v_mul_f32 v22, 0xbfb8aa3b, v15
    v_exp_f32 v22, v22
    s_nop 0
    v_add_f32 v21, 1.0, v21
    v_rcp_f32 v21, v21
    v_add_f32 v22, 1.0, v22
    v_rcp_f32 v22, v22
    s_nop 0
    v_mul_f32 v14, v14, v21
    v_mul_f32 v15, v15, v22
    v_cvt_pk_bf16_f32 v20, v14, v15
    v_mov_b32 v17, v20
    buffer_store_dwordx2 v[16:17], v7, s[60:63], s64 offen
    s_waitcnt lgkmcnt(4)
    v_pk_add_f32 v[28:29], v[28:29], v[32:33]
    v_pk_add_f32 v[36:37], v[36:37], v[40:41]
    v_pk_add_f32 v[30:31], v[30:31], v[34:35]
    v_pk_add_f32 v[38:39], v[38:39], v[42:43]
    v_pk_add_f32 v[28:29], v[28:29], v[36:37]
    v_pk_add_f32 v[30:31], v[30:31], v[38:39]
    s_add_u32 s64, s55, 20480
    ds_read_b64 v[248:249], v9 offset:0
    s_waitcnt lgkmcnt(0)
    v_and_b32 v245, 0xffff0000, v248
    v_lshlrev_b32 v244, 16, v248
    v_and_b32 v247, 0xffff0000, v249
    v_lshlrev_b32 v246, 16, v249
    v_cvt_pk_bf16_f32 v32, v28, v29
    v_and_b32 v29, 0xffff0000, v32
    v_lshlrev_b32 v28, 16, v32
    v_add_f32 v28, v28, v244
    v_add_f32 v29, v29, v245
    v_cvt_pk_bf16_f32 v32, v28, v29
    v_and_b32 v29, 0xffff0000, v32
    v_lshlrev_b32 v28, 16, v32
    v_mul_f32 v33, 0xbfb8aa3b, v28
    v_exp_f32 v33, v33
    v_mul_f32 v34, 0xbfb8aa3b, v29
    v_exp_f32 v34, v34
    s_nop 0
    v_add_f32 v33, 1.0, v33
    v_rcp_f32 v33, v33
    v_add_f32 v34, 1.0, v34
    v_rcp_f32 v34, v34
    s_nop 0
    v_mul_f32 v28, v28, v33
    v_mul_f32 v29, v29, v34
    v_cvt_pk_bf16_f32 v32, v28, v29
    v_cvt_pk_bf16_f32 v36, v30, v31
    v_and_b32 v31, 0xffff0000, v36
    v_lshlrev_b32 v30, 16, v36
    v_add_f32 v30, v30, v246
    v_add_f32 v31, v31, v247
    v_cvt_pk_bf16_f32 v36, v30, v31
    v_and_b32 v31, 0xffff0000, v36
    v_lshlrev_b32 v30, 16, v36
    v_mul_f32 v37, 0xbfb8aa3b, v30
    v_exp_f32 v37, v37
    v_mul_f32 v38, 0xbfb8aa3b, v31
    v_exp_f32 v38, v38
    s_nop 0
    v_add_f32 v37, 1.0, v37
    v_rcp_f32 v37, v37
    v_add_f32 v38, 1.0, v38
    v_rcp_f32 v38, v38
    s_nop 0
    v_mul_f32 v30, v30, v37
    v_mul_f32 v31, v31, v38
    v_cvt_pk_bf16_f32 v36, v30, v31
    v_mov_b32 v33, v36
    buffer_store_dwordx2 v[32:33], v7, s[60:63], s64 offen
    s_waitcnt lgkmcnt(0)
    v_pk_add_f32 v[44:45], v[44:45], v[48:49]
    v_pk_add_f32 v[52:53], v[52:53], v[56:57]
    v_pk_add_f32 v[46:47], v[46:47], v[50:51]
    v_pk_add_f32 v[54:55], v[54:55], v[58:59]
    v_pk_add_f32 v[44:45], v[44:45], v[52:53]
    v_pk_add_f32 v[46:47], v[46:47], v[54:55]
    s_add_u32 s64, s55, 20608
    ds_read_b64 v[248:249], v9 offset:128
    s_waitcnt lgkmcnt(0)
    v_and_b32 v245, 0xffff0000, v248
    v_lshlrev_b32 v244, 16, v248
    v_and_b32 v247, 0xffff0000, v249
    v_lshlrev_b32 v246, 16, v249
    v_cvt_pk_bf16_f32 v48, v44, v45
    v_and_b32 v45, 0xffff0000, v48
    v_lshlrev_b32 v44, 16, v48
    v_add_f32 v44, v44, v244
    v_add_f32 v45, v45, v245
    v_cvt_pk_bf16_f32 v48, v44, v45
    v_and_b32 v45, 0xffff0000, v48
    v_lshlrev_b32 v44, 16, v48
    v_mul_f32 v49, 0xbfb8aa3b, v44
    v_exp_f32 v49, v49
    v_mul_f32 v50, 0xbfb8aa3b, v45
    v_exp_f32 v50, v50
    s_nop 0
    v_add_f32 v49, 1.0, v49
    v_rcp_f32 v49, v49
    v_add_f32 v50, 1.0, v50
    v_rcp_f32 v50, v50
    s_nop 0
    v_mul_f32 v44, v44, v49
    v_mul_f32 v45, v45, v50
    v_cvt_pk_bf16_f32 v48, v44, v45
    v_cvt_pk_bf16_f32 v52, v46, v47
    v_and_b32 v47, 0xffff0000, v52
    v_lshlrev_b32 v46, 16, v52
    v_add_f32 v46, v46, v246
    v_add_f32 v47, v47, v247
    v_cvt_pk_bf16_f32 v52, v46, v47
    v_and_b32 v47, 0xffff0000, v52
    v_lshlrev_b32 v46, 16, v52
    v_mul_f32 v53, 0xbfb8aa3b, v46
    v_exp_f32 v53, v53
    v_mul_f32 v54, 0xbfb8aa3b, v47
    v_exp_f32 v54, v54
    s_nop 0
    v_add_f32 v53, 1.0, v53
    v_rcp_f32 v53, v53
    v_add_f32 v54, 1.0, v54
    v_rcp_f32 v54, v54
    s_nop 0
    v_mul_f32 v46, v46, v53
    v_mul_f32 v47, v47, v54
    v_cvt_pk_bf16_f32 v52, v46, v47
    v_mov_b32 v49, v52
    buffer_store_dwordx2 v[48:49], v7, s[60:63], s64 offen
    s_branch gk_rend_146
gk_w_148:
    s_cmp_lg_u32 s91, 2
    s_cbranch_scc1 gk_w_149
    ds_read_b128 v[12:15], v6 offset:2048
    ds_read_b128 v[16:19], v6 offset:12288
    ds_read_b128 v[20:23], v6 offset:22528
    ds_read_b128 v[24:27], v6 offset:32768
    ds_read_b128 v[28:31], v6 offset:6144
    ds_read_b128 v[32:35], v6 offset:16384
    ds_read_b128 v[36:39], v6 offset:26624
    ds_read_b128 v[40:43], v6 offset:36864
    s_waitcnt lgkmcnt(4)
    v_pk_add_f32 v[12:13], v[12:13], v[16:17]
    v_pk_add_f32 v[20:21], v[20:21], v[24:25]
    v_pk_add_f32 v[14:15], v[14:15], v[18:19]
    v_pk_add_f32 v[22:23], v[22:23], v[26:27]
    v_pk_add_f32 v[12:13], v[12:13], v[20:21]
    v_pk_add_f32 v[14:15], v[14:15], v[22:23]
    s_add_u32 s64, s55, 64
    ds_read_b64 v[248:249], v9 offset:64
    s_waitcnt lgkmcnt(0)
    v_and_b32 v245, 0xffff0000, v248
    v_lshlrev_b32 v244, 16, v248
    v_and_b32 v247, 0xffff0000, v249
    v_lshlrev_b32 v246, 16, v249
    v_cvt_pk_bf16_f32 v16, v12, v13
    v_and_b32 v13, 0xffff0000, v16
    v_lshlrev_b32 v12, 16, v16
    v_add_f32 v12, v12, v244
    v_add_f32 v13, v13, v245
    v_cvt_pk_bf16_f32 v16, v12, v13
    v_and_b32 v13, 0xffff0000, v16
    v_lshlrev_b32 v12, 16, v16
    v_mul_f32 v17, 0xbfb8aa3b, v12
    v_exp_f32 v17, v17
    v_mul_f32 v18, 0xbfb8aa3b, v13
    v_exp_f32 v18, v18
    s_nop 0
    v_add_f32 v17, 1.0, v17
    v_rcp_f32 v17, v17
    v_add_f32 v18, 1.0, v18
    v_rcp_f32 v18, v18
    s_nop 0
    v_mul_f32 v12, v12, v17
    v_mul_f32 v13, v13, v18
    v_cvt_pk_bf16_f32 v16, v12, v13
    v_cvt_pk_bf16_f32 v20, v14, v15
    v_and_b32 v15, 0xffff0000, v20
    v_lshlrev_b32 v14, 16, v20
    v_add_f32 v14, v14, v246
    v_add_f32 v15, v15, v247
    v_cvt_pk_bf16_f32 v20, v14, v15
    v_and_b32 v15, 0xffff0000, v20
    v_lshlrev_b32 v14, 16, v20
    v_mul_f32 v21, 0xbfb8aa3b, v14
    v_exp_f32 v21, v21
    v_mul_f32 v22, 0xbfb8aa3b, v15
    v_exp_f32 v22, v22
    s_nop 0
    v_add_f32 v21, 1.0, v21
    v_rcp_f32 v21, v21
    v_add_f32 v22, 1.0, v22
    v_rcp_f32 v22, v22
    s_nop 0
    v_mul_f32 v14, v14, v21
    v_mul_f32 v15, v15, v22
    v_cvt_pk_bf16_f32 v20, v14, v15
    v_mov_b32 v17, v20
    buffer_store_dwordx2 v[16:17], v7, s[60:63], s64 offen
    s_waitcnt lgkmcnt(0)
    v_pk_add_f32 v[28:29], v[28:29], v[32:33]
    v_pk_add_f32 v[36:37], v[36:37], v[40:41]
    v_pk_add_f32 v[30:31], v[30:31], v[34:35]
    v_pk_add_f32 v[38:39], v[38:39], v[42:43]
    v_pk_add_f32 v[28:29], v[28:29], v[36:37]
    v_pk_add_f32 v[30:31], v[30:31], v[38:39]
    s_add_u32 s64, s55, 20512
    ds_read_b64 v[248:249], v9 offset:32
    s_waitcnt lgkmcnt(0)
    v_and_b32 v245, 0xffff0000, v248
    v_lshlrev_b32 v244, 16, v248
    v_and_b32 v247, 0xffff0000, v249
    v_lshlrev_b32 v246, 16, v249
    v_cvt_pk_bf16_f32 v32, v28, v29
    v_and_b32 v29, 0xffff0000, v32
    v_lshlrev_b32 v28, 16, v32
    v_add_f32 v28, v28, v244
    v_add_f32 v29, v29, v245
    v_cvt_pk_bf16_f32 v32, v28, v29
    v_and_b32 v29, 0xffff0000, v32
    v_lshlrev_b32 v28, 16, v32
    v_mul_f32 v33, 0xbfb8aa3b, v28
    v_exp_f32 v33, v33
    v_mul_f32 v34, 0xbfb8aa3b, v29
    v_exp_f32 v34, v34
    s_nop 0
    v_add_f32 v33, 1.0, v33
    v_rcp_f32 v33, v33
    v_add_f32 v34, 1.0, v34
    v_rcp_f32 v34, v34
    s_nop 0
    v_mul_f32 v28, v28, v33
    v_mul_f32 v29, v29, v34
    v_cvt_pk_bf16_f32 v32, v28, v29
    v_cvt_pk_bf16_f32 v36, v30, v31
    v_and_b32 v31, 0xffff0000, v36
    v_lshlrev_b32 v30, 16, v36
    v_add_f32 v30, v30, v246
    v_add_f32 v31, v31, v247
    v_cvt_pk_bf16_f32 v36, v30, v31
    v_and_b32 v31, 0xffff0000, v36
    v_lshlrev_b32 v30, 16, v36
    v_mul_f32 v37, 0xbfb8aa3b, v30
    v_exp_f32 v37, v37
    v_mul_f32 v38, 0xbfb8aa3b, v31
    v_exp_f32 v38, v38
    s_nop 0
    v_add_f32 v37, 1.0, v37
    v_rcp_f32 v37, v37
    v_add_f32 v38, 1.0, v38
    v_rcp_f32 v38, v38
    s_nop 0
    v_mul_f32 v30, v30, v37
    v_mul_f32 v31, v31, v38
    v_cvt_pk_bf16_f32 v36, v30, v31
    v_mov_b32 v33, v36
    buffer_store_dwordx2 v[32:33], v7, s[60:63], s64 offen
    s_branch gk_rend_146
gk_w_149:
    s_cmp_lg_u32 s91, 3
    s_cbranch_scc1 gk_w_150
    ds_read_b128 v[12:15], v6 offset:3072
    ds_read_b128 v[16:19], v6 offset:13312
    ds_read_b128 v[20:23], v6 offset:23552
    ds_read_b128 v[24:27], v6 offset:33792
    ds_read_b128 v[28:31], v6 offset:7168
    ds_read_b128 v[32:35], v6 offset:17408
    ds_read_b128 v[36:39], v6 offset:27648
    ds_read_b128 v[40:43], v6 offset:37888
    s_waitcnt lgkmcnt(4)
    v_pk_add_f32 v[12:13], v[12:13], v[16:17]
    v_pk_add_f32 v[20:21], v[20:21], v[24:25]
    v_pk_add_f32 v[14:15], v[14:15], v[18:19]
    v_pk_add_f32 v[22:23], v[22:23], v[26:27]
    v_pk_add_f32 v[12:13], v[12:13], v[20:21]
    v_pk_add_f32 v[14:15], v[14:15], v[22:23]
    s_add_u32 s64, s55, 96
    ds_read_b64 v[248:249], v9 offset:96
    s_waitcnt lgkmcnt(0)
    v_and_b32 v245, 0xffff0000, v248
    v_lshlrev_b32 v244, 16, v248
    v_and_b32 v247, 0xffff0000, v249
    v_lshlrev_b32 v246, 16, v249
    v_cvt_pk_bf16_f32 v16, v12, v13
    v_and_b32 v13, 0xffff0000, v16
    v_lshlrev_b32 v12, 16, v16
    v_add_f32 v12, v12, v244
    v_add_f32 v13, v13, v245
    v_cvt_pk_bf16_f32 v16, v12, v13
    v_and_b32 v13, 0xffff0000, v16
    v_lshlrev_b32 v12, 16, v16
    v_mul_f32 v17, 0xbfb8aa3b, v12
    v_exp_f32 v17, v17
    v_mul_f32 v18, 0xbfb8aa3b, v13
    v_exp_f32 v18, v18
    s_nop 0
    v_add_f32 v17, 1.0, v17
    v_rcp_f32 v17, v17
    v_add_f32 v18, 1.0, v18
    v_rcp_f32 v18, v18
    s_nop 0
    v_mul_f32 v12, v12, v17
    v_mul_f32 v13, v13, v18
    v_cvt_pk_bf16_f32 v16, v12, v13
    v_cvt_pk_bf16_f32 v20, v14, v15
    v_and_b32 v15, 0xffff0000, v20
    v_lshlrev_b32 v14, 16, v20
    v_add_f32 v14, v14, v246
    v_add_f32 v15, v15, v247
    v_cvt_pk_bf16_f32 v20, v14, v15
    v_and_b32 v15, 0xffff0000, v20
    v_lshlrev_b32 v14, 16, v20
    v_mul_f32 v21, 0xbfb8aa3b, v14
    v_exp_f32 v21, v21
    v_mul_f32 v22, 0xbfb8aa3b, v15
    v_exp_f32 v22, v22
    s_nop 0
    v_add_f32 v21, 1.0, v21
    v_rcp_f32 v21, v21
    v_add_f32 v22, 1.0, v22
    v_rcp_f32 v22, v22
    s_nop 0
    v_mul_f32 v14, v14, v21
    v_mul_f32 v15, v15, v22
    v_cvt_pk_bf16_f32 v20, v14, v15
    v_mov_b32 v17, v20
    buffer_store_dwordx2 v[16:17], v7, s[60:63], s64 offen
    s_waitcnt lgkmcnt(0)
    v_pk_add_f32 v[28:29], v[28:29], v[32:33]
    v_pk_add_f32 v[36:37], v[36:37], v[40:41]
    v_pk_add_f32 v[30:31], v[30:31], v[34:35]
    v_pk_add_f32 v[38:39], v[38:39], v[42:43]
    v_pk_add_f32 v[28:29], v[28:29], v[36:37]
    v_pk_add_f32 v[30:31], v[30:31], v[38:39]
    s_add_u32 s64, s55, 20544
    ds_read_b64 v[248:249], v9 offset:64
    s_waitcnt lgkmcnt(0)
    v_and_b32 v245, 0xffff0000, v248
    v_lshlrev_b32 v244, 16, v248
    v_and_b32 v247, 0xffff0000, v249
    v_lshlrev_b32 v246, 16, v249
    v_cvt_pk_bf16_f32 v32, v28, v29
    v_and_b32 v29, 0xffff0000, v32
    v_lshlrev_b32 v28, 16, v32
    v_add_f32 v28, v28, v244
    v_add_f32 v29, v29, v245
    v_cvt_pk_bf16_f32 v32, v28, v29
    v_and_b32 v29, 0xffff0000, v32
    v_lshlrev_b32 v28, 16, v32
    v_mul_f32 v33, 0xbfb8aa3b, v28
    v_exp_f32 v33, v33
    v_mul_f32 v34, 0xbfb8aa3b, v29
    v_exp_f32 v34, v34
    s_nop 0
    v_add_f32 v33, 1.0, v33
    v_rcp_f32 v33, v33
    v_add_f32 v34, 1.0, v34
    v_rcp_f32 v34, v34
    s_nop 0
    v_mul_f32 v28, v28, v33
    v_mul_f32 v29, v29, v34
    v_cvt_pk_bf16_f32 v32, v28, v29
    v_cvt_pk_bf16_f32 v36, v30, v31
    v_and_b32 v31, 0xffff0000, v36
    v_lshlrev_b32 v30, 16, v36
    v_add_f32 v30, v30, v246
    v_add_f32 v31, v31, v247
    v_cvt_pk_bf16_f32 v36, v30, v31
    v_and_b32 v31, 0xffff0000, v36
    v_lshlrev_b32 v30, 16, v36
    v_mul_f32 v37, 0xbfb8aa3b, v30
    v_exp_f32 v37, v37
    v_mul_f32 v38, 0xbfb8aa3b, v31
    v_exp_f32 v38, v38
    s_nop 0
    v_add_f32 v37, 1.0, v37
    v_rcp_f32 v37, v37
    v_add_f32 v38, 1.0, v38
    v_rcp_f32 v38, v38
    s_nop 0
    v_mul_f32 v30, v30, v37
    v_mul_f32 v31, v31, v38
    v_cvt_pk_bf16_f32 v36, v30, v31
    v_mov_b32 v33, v36
    buffer_store_dwordx2 v[32:33], v7, s[60:63], s64 offen
    s_branch gk_rend_146
gk_w_150:
gk_rend_146:
    s_barrier
    s_add_u32 s54, s54, s53
    s_cmp_ge_u32 s54, s52
    s_cbranch_scc1 gk_out_142
    s_waitcnt vmcnt(0)
    s_add_u32 s57, s54, s53
    s_cmp_ge_u32 s57, s52
    s_cbranch_scc1 gk_nf_151
    s_add_u32 s93, s57, 128
    s_lshl_b32 s93, s93, 8
    v_mov_b32 v254, s93
wk_poll_152:
    buffer_load_dword v255, v254, s[28:31], 0 offen sc1
    s_waitcnt vmcnt(0)
    v_cmp_le_u32 vcc, 8, v255
    s_cbranch_vccnz wk_ok_153
    s_sleep 8
    s_add_u32 s92, s92, 1
    s_cmp_lt_u32 s92, 1048576
    s_cbranch_scc1 wk_poll_152
wk_ok_153:
    s_mul_i32 s48, s57, 98304
    s_add_u32 s48, s48, s50
    buffer_load_dwordx4 v[12:15], v4, s[40:43], s48 offen sc1
    s_add_u32 s48, s48, 1024
    buffer_load_dwordx4 v[16:19], v4, s[40:43], s48 offen sc1
    s_add_u32 s48, s48, 1024
    buffer_load_dwordx4 v[20:23], v4, s[40:43], s48 offen sc1
    s_add_u32 s48, s48, 1024
    buffer_load_dwordx4 v[24:27], v4, s[40:43], s48 offen sc1
    s_add_u32 s48, s48, 1024
    buffer_load_dwordx4 v[28:31], v4, s[40:43], s48 offen sc1
    s_add_u32 s48, s48, 1024
    buffer_load_dwordx4 v[32:35], v4, s[40:43], s48 offen sc1
    s_add_u32 s48, s48, 1024
    buffer_load_dwordx4 v[36:39], v4, s[40:43], s48 offen sc1
    s_add_u32 s48, s48, 1024
    buffer_load_dwordx4 v[40:43], v4, s[40:43], s48 offen sc1
    s_add_u32 s48, s48, 1024
    buffer_load_dwordx4 v[44:47], v4, s[40:43], s48 offen sc1
    s_add_u32 s48, s48, 1024
    buffer_load_dwordx4 v[48:51], v4, s[40:43], s48 offen sc1
    s_add_u32 s48, s48, 1024
    buffer_load_dwordx4 v[52:55], v4, s[40:43], s48 offen sc1
    s_add_u32 s48, s48, 1024
    buffer_load_dwordx4 v[56:59], v4, s[40:43], s48 offen sc1
    s_add_u32 s48, s48, 1024
    buffer_load_dwordx4 v[60:63], v4, s[40:43], s48 offen sc1
    s_add_u32 s48, s48, 1024
    buffer_load_dwordx4 v[64:67], v4, s[40:43], s48 offen sc1
    s_add_u32 s48, s48, 1024
    buffer_load_dwordx4 v[68:71], v4, s[40:43], s48 offen sc1
    s_add_u32 s48, s48, 1024
    buffer_load_dwordx4 v[72:75], v4, s[40:43], s48 offen sc1
    s_add_u32 s48, s48, 1024
    buffer_load_dwordx4 v[76:79], v4, s[40:43], s48 offen sc1
    s_add_u32 s48, s48, 1024
    buffer_load_dwordx4 v[80:83], v4, s[40:43], s48 offen sc1
    s_add_u32 s48, s48, 1024
    buffer_load_dwordx4 v[84:87], v4, s[40:43], s48 offen sc1
    s_add_u32 s48, s48, 1024
    buffer_load_dwordx4 v[88:91], v4, s[40:43], s48 offen sc1
    s_add_u32 s48, s48, 1024
    buffer_load_dwordx4 v[92:95], v4, s[40:43], s48 offen sc1
    s_add_u32 s48, s48, 1024
    buffer_load_dwordx4 v[96:99], v4, s[40:43], s48 offen sc1
    s_add_u32 s48, s48, 1024
    buffer_load_dwordx4 v[100:103], v4, s[40:43], s48 offen sc1
    s_add_u32 s48, s48, 1024
    buffer_load_dwordx4 v[104:107], v4, s[40:43], s48 offen sc1
    s_add_u32 s48, s48, 1024
gk_nf_151:
    v_mfma_f32_16x16x32_bf16 v[204:207], a[0:3], v[108:111], 0
    v_mfma_f32_16x16x32_bf16 v[208:211], a[48:51], v[108:111], 0
    v_mfma_f32_16x16x32_bf16 v[212:215], a[96:99], v[108:111], 0
    v_mfma_f32_16x16x32_bf16 v[216:219], a[144:147], v[108:111], 0
    v_mfma_f32_16x16x32_bf16 v[220:223], a[192:195], v[108:111], 0
    v_mfma_f32_16x16x32_bf16 v[224:227], a[0:3], v[112:115], 0
    v_mfma_f32_16x16x32_bf16 v[228:231], a[48:51], v[112:115], 0
    v_mfma_f32_16x16x32_bf16 v[232:235], a[96:99], v[112:115], 0
    v_mfma_f32_16x16x32_bf16 v[236:239], a[144:147], v[112:115], 0
    v_mfma_f32_16x16x32_bf16 v[240:243], a[192:195], v[112:115], 0
    v_mfma_f32_16x16x32_bf16 v[204:207], a[4:7], v[116:119], v[204:207]
    v_mfma_f32_16x16x32_bf16 v[208:211], a[52:55], v[116:119], v[208:211]
    v_mfma_f32_16x16x32_bf16 v[212:215], a[100:103], v[116:119], v[212:215]
    v_mfma_f32_16x16x32_bf16 v[216:219], a[148:151], v[116:119], v[216:219]
    v_mfma_f32_16x16x32_bf16 v[220:223], a[196:199], v[116:119], v[220:223]
    v_mfma_f32_16x16x32_bf16 v[224:227], a[4:7], v[120:123], v[224:227]
    v_mfma_f32_16x16x32_bf16 v[228:231], a[52:55], v[120:123], v[228:231]
    v_mfma_f32_16x16x32_bf16 v[232:235], a[100:103], v[120:123], v[232:235]
    v_mfma_f32_16x16x32_bf16 v[236:239], a[148:151], v[120:123], v[236:239]
    v_mfma_f32_16x16x32_bf16 v[240:243], a[196:199], v[120:123], v[240:243]
    v_mfma_f32_16x16x32_bf16 v[204:207], a[8:11], v[124:127], v[204:207]
    v_mfma_f32_16x16x32_bf16 v[208:211], a[56:59], v[124:127], v[208:211]
    v_mfma_f32_16x16x32_bf16 v[212:215], a[104:107], v[124:127], v[212:215]
    v_mfma_f32_16x16x32_bf16 v[216:219], a[152:155], v[124:127], v[216:219]
    v_mfma_f32_16x16x32_bf16 v[220:223], a[200:203], v[124:127], v[220:223]
    v_mfma_f32_16x16x32_bf16 v[224:227], a[8:11], v[128:131], v[224:227]
    v_mfma_f32_16x16x32_bf16 v[228:231], a[56:59], v[128:131], v[228:231]
    v_mfma_f32_16x16x32_bf16 v[232:235], a[104:107], v[128:131], v[232:235]
    v_mfma_f32_16x16x32_bf16 v[236:239], a[152:155], v[128:131], v[236:239]
    v_mfma_f32_16x16x32_bf16 v[240:243], a[200:203], v[128:131], v[240:243]
    v_mfma_f32_16x16x32_bf16 v[204:207], a[12:15], v[132:135], v[204:207]
    v_mfma_f32_16x16x32_bf16 v[208:211], a[60:63], v[132:135], v[208:211]
    v_mfma_f32_16x16x32_bf16 v[212:215], a[108:111], v[132:135], v[212:215]
    v_mfma_f32_16x16x32_bf16 v[216:219], a[156:159], v[132:135], v[216:219]
    v_mfma_f32_16x16x32_bf16 v[220:223], a[204:207], v[132:135], v[220:223]
    v_mfma_f32_16x16x32_bf16 v[224:227], a[12:15], v[136:139], v[224:227]
    v_mfma_f32_16x16x32_bf16 v[228:231], a[60:63], v[136:139], v[228:231]
    v_mfma_f32_16x16x32_bf16 v[232:235], a[108:111], v[136:139], v[232:235]
    v_mfma_f32_16x16x32_bf16 v[236:239], a[156:159], v[136:139], v[236:239]
    v_mfma_f32_16x16x32_bf16 v[240:243], a[204:207], v[136:139], v[240:243]
    v_mfma_f32_16x16x32_bf16 v[204:207], a[16:19], v[140:143], v[204:207]
    v_mfma_f32_16x16x32_bf16 v[208:211], a[64:67], v[140:143], v[208:211]
    v_mfma_f32_16x16x32_bf16 v[212:215], a[112:115], v[140:143], v[212:215]
    v_mfma_f32_16x16x32_bf16 v[216:219], a[160:163], v[140:143], v[216:219]
    v_mfma_f32_16x16x32_bf16 v[220:223], a[208:211], v[140:143], v[220:223]
    v_mfma_f32_16x16x32_bf16 v[224:227], a[16:19], v[144:147], v[224:227]
    v_mfma_f32_16x16x32_bf16 v[228:231], a[64:67], v[144:147], v[228:231]
    v_mfma_f32_16x16x32_bf16 v[232:235], a[112:115], v[144:147], v[232:235]
    v_mfma_f32_16x16x32_bf16 v[236:239], a[160:163], v[144:147], v[236:239]
    v_mfma_f32_16x16x32_bf16 v[240:243], a[208:211], v[144:147], v[240:243]
    v_mfma_f32_16x16x32_bf16 v[204:207], a[20:23], v[148:151], v[204:207]
    v_mfma_f32_16x16x32_bf16 v[208:211], a[68:71], v[148:151], v[208:211]
    v_mfma_f32_16x16x32_bf16 v[212:215], a[116:119], v[148:151], v[212:215]
    v_mfma_f32_16x16x32_bf16 v[216:219], a[164:167], v[148:151], v[216:219]
    v_mfma_f32_16x16x32_bf16 v[220:223], a[212:215], v[148:151], v[220:223]
    v_mfma_f32_16x16x32_bf16 v[224:227], a[20:23], v[152:155], v[224:227]
    v_mfma_f32_16x16x32_bf16 v[228:231], a[68:71], v[152:155], v[228:231]
    v_mfma_f32_16x16x32_bf16 v[232:235], a[116:119], v[152:155], v[232:235]
    v_mfma_f32_16x16x32_bf16 v[236:239], a[164:167], v[152:155], v[236:239]
    v_mfma_f32_16x16x32_bf16 v[240:243], a[212:215], v[152:155], v[240:243]
    v_mfma_f32_16x16x32_bf16 v[204:207], a[24:27], v[156:159], v[204:207]
    v_mfma_f32_16x16x32_bf16 v[208:211], a[72:75], v[156:159], v[208:211]
    v_mfma_f32_16x16x32_bf16 v[212:215], a[120:123], v[156:159], v[212:215]
    v_mfma_f32_16x16x32_bf16 v[216:219], a[168:171], v[156:159], v[216:219]
    v_mfma_f32_16x16x32_bf16 v[220:223], a[216:219], v[156:159], v[220:223]
    v_mfma_f32_16x16x32_bf16 v[224:227], a[24:27], v[160:163], v[224:227]
    v_mfma_f32_16x16x32_bf16 v[228:231], a[72:75], v[160:163], v[228:231]
    v_mfma_f32_16x16x32_bf16 v[232:235], a[120:123], v[160:163], v[232:235]
    v_mfma_f32_16x16x32_bf16 v[236:239], a[168:171], v[160:163], v[236:239]
    v_mfma_f32_16x16x32_bf16 v[240:243], a[216:219], v[160:163], v[240:243]
    v_mfma_f32_16x16x32_bf16 v[204:207], a[28:31], v[164:167], v[204:207]
    v_mfma_f32_16x16x32_bf16 v[208:211], a[76:79], v[164:167], v[208:211]
    v_mfma_f32_16x16x32_bf16 v[212:215], a[124:127], v[164:167], v[212:215]
    v_mfma_f32_16x16x32_bf16 v[216:219], a[172:175], v[164:167], v[216:219]
    v_mfma_f32_16x16x32_bf16 v[220:223], a[220:223], v[164:167], v[220:223]
    v_mfma_f32_16x16x32_bf16 v[224:227], a[28:31], v[168:171], v[224:227]
    v_mfma_f32_16x16x32_bf16 v[228:231], a[76:79], v[168:171], v[228:231]
    v_mfma_f32_16x16x32_bf16 v[232:235], a[124:127], v[168:171], v[232:235]
    v_mfma_f32_16x16x32_bf16 v[236:239], a[172:175], v[168:171], v[236:239]
    v_mfma_f32_16x16x32_bf16 v[240:243], a[220:223], v[168:171], v[240:243]
    v_mfma_f32_16x16x32_bf16 v[204:207], a[32:35], v[172:175], v[204:207]
    v_mfma_f32_16x16x32_bf16 v[208:211], a[80:83], v[172:175], v[208:211]
    v_mfma_f32_16x16x32_bf16 v[212:215], a[128:131], v[172:175], v[212:215]
    v_mfma_f32_16x16x32_bf16 v[216:219], a[176:179], v[172:175], v[216:219]
    v_mfma_f32_16x16x32_bf16 v[220:223], a[224:227], v[172:175], v[220:223]
    v_mfma_f32_16x16x32_bf16 v[224:227], a[32:35], v[176:179], v[224:227]
    v_mfma_f32_16x16x32_bf16 v[228:231], a[80:83], v[176:179], v[228:231]
    v_mfma_f32_16x16x32_bf16 v[232:235], a[128:131], v[176:179], v[232:235]
    v_mfma_f32_16x16x32_bf16 v[236:239], a[176:179], v[176:179], v[236:239]
    v_mfma_f32_16x16x32_bf16 v[240:243], a[224:227], v[176:179], v[240:243]
    v_mfma_f32_16x16x32_bf16 v[204:207], a[36:39], v[180:183], v[204:207]
    v_mfma_f32_16x16x32_bf16 v[208:211], a[84:87], v[180:183], v[208:211]
    v_mfma_f32_16x16x32_bf16 v[212:215], a[132:135], v[180:183], v[212:215]
    v_mfma_f32_16x16x32_bf16 v[216:219], a[180:183], v[180:183], v[216:219]
    v_mfma_f32_16x16x32_bf16 v[220:223], a[228:231], v[180:183], v[220:223]
    v_mfma_f32_16x16x32_bf16 v[224:227], a[36:39], v[184:187], v[224:227]
    v_mfma_f32_16x16x32_bf16 v[228:231], a[84:87], v[184:187], v[228:231]
    v_mfma_f32_16x16x32_bf16 v[232:235], a[132:135], v[184:187], v[232:235]
    v_mfma_f32_16x16x32_bf16 v[236:239], a[180:183], v[184:187], v[236:239]
    v_mfma_f32_16x16x32_bf16 v[240:243], a[228:231], v[184:187], v[240:243]
    v_mfma_f32_16x16x32_bf16 v[204:207], a[40:43], v[188:191], v[204:207]
    v_mfma_f32_16x16x32_bf16 v[208:211], a[88:91], v[188:191], v[208:211]
    v_mfma_f32_16x16x32_bf16 v[212:215], a[136:139], v[188:191], v[212:215]
    v_mfma_f32_16x16x32_bf16 v[216:219], a[184:187], v[188:191], v[216:219]
    v_mfma_f32_16x16x32_bf16 v[220:223], a[232:235], v[188:191], v[220:223]
    v_mfma_f32_16x16x32_bf16 v[224:227], a[40:43], v[192:195], v[224:227]
    v_mfma_f32_16x16x32_bf16 v[228:231], a[88:91], v[192:195], v[228:231]
    v_mfma_f32_16x16x32_bf16 v[232:235], a[136:139], v[192:195], v[232:235]
    v_mfma_f32_16x16x32_bf16 v[236:239], a[184:187], v[192:195], v[236:239]
    v_mfma_f32_16x16x32_bf16 v[240:243], a[232:235], v[192:195], v[240:243]
    v_mfma_f32_16x16x32_bf16 v[204:207], a[44:47], v[196:199], v[204:207]
    v_mfma_f32_16x16x32_bf16 v[208:211], a[92:95], v[196:199], v[208:211]
    v_mfma_f32_16x16x32_bf16 v[212:215], a[140:143], v[196:199], v[212:215]
    v_mfma_f32_16x16x32_bf16 v[216:219], a[188:191], v[196:199], v[216:219]
    v_mfma_f32_16x16x32_bf16 v[220:223], a[236:239], v[196:199], v[220:223]
    v_mfma_f32_16x16x32_bf16 v[224:227], a[44:47], v[200:203], v[224:227]
    v_mfma_f32_16x16x32_bf16 v[228:231], a[92:95], v[200:203], v[228:231]
    v_mfma_f32_16x16x32_bf16 v[232:235], a[140:143], v[200:203], v[232:235]
    v_mfma_f32_16x16x32_bf16 v[236:239], a[188:191], v[200:203], v[236:239]
    v_mfma_f32_16x16x32_bf16 v[240:243], a[236:239], v[200:203], v[240:243]
    s_nop 7
    ds_write_b128 v5, v[204:207] offset:0
    ds_write_b128 v5, v[208:211] offset:1024
    ds_write_b128 v5, v[212:215] offset:2048
    ds_write_b128 v5, v[216:219] offset:3072
    ds_write_b128 v5, v[220:223] offset:4096
    ds_write_b128 v5, v[224:227] offset:5120
    ds_write_b128 v5, v[228:231] offset:6144
    ds_write_b128 v5, v[232:235] offset:7168
    ds_write_b128 v5, v[236:239] offset:8192
    ds_write_b128 v5, v[240:243] offset:9216
    s_waitcnt lgkmcnt(0)
    s_barrier
    s_mul_i32 s55, s54, 40960
    s_cmp_lg_u32 s91, 0
    s_cbranch_scc1 gk_w_155
    ds_read_b128 v[108:111], v6 offset:0
    ds_read_b128 v[112:115], v6 offset:10240
    ds_read_b128 v[116:119], v6 offset:20480
    ds_read_b128 v[120:123], v6 offset:30720
    ds_read_b128 v[124:127], v6 offset:4096
    ds_read_b128 v[128:131], v6 offset:14336
    ds_read_b128 v[132:135], v6 offset:24576
    ds_read_b128 v[136:139], v6 offset:34816
    ds_read_b128 v[140:143], v6 offset:8192
    ds_read_b128 v[144:147], v6 offset:18432
    ds_read_b128 v[148:151], v6 offset:28672
    ds_read_b128 v[152:155], v6 offset:38912
    s_waitcnt lgkmcnt(8)
    v_pk_add_f32 v[108:109], v[108:109], v[112:113]
    v_pk_add_f32 v[116:117], v[116:117], v[120:121]
    v_pk_add_f32 v[110:111], v[110:111], v[114:115]
    v_pk_add_f32 v[118:119], v[118:119], v[122:123]
    v_pk_add_f32 v[108:109], v[108:109], v[116:117]
    v_pk_add_f32 v[110:111], v[110:111], v[118:119]
    s_add_u32 s64, s55, 0
    ds_read_b64 v[248:249], v9 offset:0
    s_waitcnt lgkmcnt(0)
    v_and_b32 v245, 0xffff0000, v248
    v_lshlrev_b32 v244, 16, v248
    v_and_b32 v247, 0xffff0000, v249
    v_lshlrev_b32 v246, 16, v249
    v_cvt_pk_bf16_f32 v112, v108, v109
    v_and_b32 v109, 0xffff0000, v112
    v_lshlrev_b32 v108, 16, v112
    v_add_f32 v108, v108, v244
    v_add_f32 v109, v109, v245
    v_cvt_pk_bf16_f32 v112, v108, v109
    v_and_b32 v109, 0xffff0000, v112
    v_lshlrev_b32 v108, 16, v112
    v_mul_f32 v113, 0xbfb8aa3b, v108
    v_exp_f32 v113, v113
    v_mul_f32 v114, 0xbfb8aa3b, v109
    v_exp_f32 v114, v114
    s_nop 0
    v_add_f32 v113, 1.0, v113
    v_rcp_f32 v113, v113
    v_add_f32 v114, 1.0, v114
    v_rcp_f32 v114, v114
    s_nop 0
    v_mul_f32 v108, v108, v113
    v_mul_f32 v109, v109, v114
    v_cvt_pk_bf16_f32 v112, v108, v109
    v_cvt_pk_bf16_f32 v116, v110, v111
    v_and_b32 v111, 0xffff0000, v116
    v_lshlrev_b32 v110, 16, v116
    v_add_f32 v110, v110, v246
    v_add_f32 v111, v111, v247
    v_cvt_pk_bf16_f32 v116, v110, v111
    v_and_b32 v111, 0xffff0000, v116
    v_lshlrev_b32 v110, 16, v116
    v_mul_f32 v117, 0xbfb8aa3b, v110
    v_exp_f32 v117, v117
    v_mul_f32 v118, 0xbfb8aa3b, v111
    v_exp_f32 v118, v118
    s_nop 0
    v_add_f32 v117, 1.0, v117
    v_rcp_f32 v117, v117
    v_add_f32 v118, 1.0, v118
    v_rcp_f32 v118, v118
    s_nop 0
    v_mul_f32 v110, v110, v117
    v_mul_f32 v111, v111, v118
    v_cvt_pk_bf16_f32 v116, v110, v111
    v_mov_b32 v113, v116
    buffer_store_dwordx2 v[112:113], v7, s[60:63], s64 offen
    s_waitcnt lgkmcnt(4)
    v_pk_add_f32 v[124:125], v[124:125], v[128:129]
    v_pk_add_f32 v[132:133], v[132:133], v[136:137]
    v_pk_add_f32 v[126:127], v[126:127], v[130:131]
    v_pk_add_f32 v[134:135], v[134:135], v[138:139]
    v_pk_add_f32 v[124:125], v[124:125], v[132:133]
    v_pk_add_f32 v[126:127], v[126:127], v[134:135]
    s_add_u32 s64, s55, 128
    ds_read_b64 v[248:249], v9 offset:128
    s_waitcnt lgkmcnt(0)
    v_and_b32 v245, 0xffff0000, v248
    v_lshlrev_b32 v244, 16, v248
    v_and_b32 v247, 0xffff0000, v249
    v_lshlrev_b32 v246, 16, v249
    v_cvt_pk_bf16_f32 v128, v124, v125
    v_and_b32 v125, 0xffff0000, v128
    v_lshlrev_b32 v124, 16, v128
    v_add_f32 v124, v124, v244
    v_add_f32 v125, v125, v245
    v_cvt_pk_bf16_f32 v128, v124, v125
    v_and_b32 v125, 0xffff0000, v128
    v_lshlrev_b32 v124, 16, v128
    v_mul_f32 v129, 0xbfb8aa3b, v124
    v_exp_f32 v129, v129
    v_mul_f32 v130, 0xbfb8aa3b, v125
    v_exp_f32 v130, v130
    s_nop 0
    v_add_f32 v129, 1.0, v129
    v_rcp_f32 v129, v129
    v_add_f32 v130, 1.0, v130
    v_rcp_f32 v130, v130
    s_nop 0
    v_mul_f32 v124, v124, v129
    v_mul_f32 v125, v125, v130
    v_cvt_pk_bf16_f32 v128, v124, v125
    v_cvt_pk_bf16_f32 v132, v126, v127
    v_and_b32 v127, 0xffff0000, v132
    v_lshlrev_b32 v126, 16, v132
    v_add_f32 v126, v126, v246
    v_add_f32 v127, v127, v247
    v_cvt_pk_bf16_f32 v132, v126, v127
    v_and_b32 v127, 0xffff0000, v132
    v_lshlrev_b32 v126, 16, v132
    v_mul_f32 v133, 0xbfb8aa3b, v126
    v_exp_f32 v133, v133
    v_mul_f32 v134, 0xbfb8aa3b, v127
    v_exp_f32 v134, v134
    s_nop 0
    v_add_f32 v133, 1.0, v133
    v_rcp_f32 v133, v133
    v_add_f32 v134, 1.0, v134
    v_rcp_f32 v134, v134
    s_nop 0
    v_mul_f32 v126, v126, v133
    v_mul_f32 v127, v127, v134
    v_cvt_pk_bf16_f32 v132, v126, v127
    v_mov_b32 v129, v132
    buffer_store_dwordx2 v[128:129], v7, s[60:63], s64 offen
    s_waitcnt lgkmcnt(0)
    v_pk_add_f32 v[140:141], v[140:141], v[144:145]
    v_pk_add_f32 v[148:149], v[148:149], v[152:153]
    v_pk_add_f32 v[142:143], v[142:143], v[146:147]
    v_pk_add_f32 v[150:151], v[150:151], v[154:155]
    v_pk_add_f32 v[140:141], v[140:141], v[148:149]
    v_pk_add_f32 v[142:143], v[142:143], v[150:151]
    s_add_u32 s64, s55, 20576
    ds_read_b64 v[248:249], v9 offset:96
    s_waitcnt lgkmcnt(0)
    v_and_b32 v245, 0xffff0000, v248
    v_lshlrev_b32 v244, 16, v248
    v_and_b32 v247, 0xffff0000, v249
    v_lshlrev_b32 v246, 16, v249
    v_cvt_pk_bf16_f32 v144, v140, v141
    v_and_b32 v141, 0xffff0000, v144
    v_lshlrev_b32 v140, 16, v144
    v_add_f32 v140, v140, v244
    v_add_f32 v141, v141, v245
    v_cvt_pk_bf16_f32 v144, v140, v141
    v_and_b32 v141, 0xffff0000, v144
    v_lshlrev_b32 v140, 16, v144
    v_mul_f32 v145, 0xbfb8aa3b, v140
    v_exp_f32 v145, v145
    v_mul_f32 v146, 0xbfb8aa3b, v141
    v_exp_f32 v146, v146
    s_nop 0
    v_add_f32 v145, 1.0, v145
    v_rcp_f32 v145, v145
    v_add_f32 v146, 1.0, v146
    v_rcp_f32 v146, v146
    s_nop 0
    v_mul_f32 v140, v140, v145
    v_mul_f32 v141, v141, v146
    v_cvt_pk_bf16_f32 v144, v140, v141
    v_cvt_pk_bf16_f32 v148, v142, v143
    v_and_b32 v143, 0xffff0000, v148
    v_lshlrev_b32 v142, 16, v148
    v_add_f32 v142, v142, v246
    v_add_f32 v143, v143, v247
    v_cvt_pk_bf16_f32 v148, v142, v143
    v_and_b32 v143, 0xffff0000, v148
    v_lshlrev_b32 v142, 16, v148
    v_mul_f32 v149, 0xbfb8aa3b, v142
    v_exp_f32 v149, v149
    v_mul_f32 v150, 0xbfb8aa3b, v143
    v_exp_f32 v150, v150
    s_nop 0
    v_add_f32 v149, 1.0, v149
    v_rcp_f32 v149, v149
    v_add_f32 v150, 1.0, v150
    v_rcp_f32 v150, v150
    s_nop 0
    v_mul_f32 v142, v142, v149
    v_mul_f32 v143, v143, v150
    v_cvt_pk_bf16_f32 v148, v142, v143
    v_mov_b32 v145, v148
    buffer_store_dwordx2 v[144:145], v7, s[60:63], s64 offen
    s_branch gk_rend_154
gk_w_155:
    s_cmp_lg_u32 s91, 1
    s_cbranch_scc1 gk_w_156
    ds_read_b128 v[108:111], v6 offset:1024
    ds_read_b128 v[112:115], v6 offset:11264
    ds_read_b128 v[116:119], v6 offset:21504
    ds_read_b128 v[120:123], v6 offset:31744
    ds_read_b128 v[124:127], v6 offset:5120
    ds_read_b128 v[128:131], v6 offset:15360
    ds_read_b128 v[132:135], v6 offset:25600
    ds_read_b128 v[136:139], v6 offset:35840
    ds_read_b128 v[140:143], v6 offset:9216
    ds_read_b128 v[144:147], v6 offset:19456
    ds_read_b128 v[148:151], v6 offset:29696
    ds_read_b128 v[152:155], v6 offset:39936
    s_waitcnt lgkmcnt(8)
    v_pk_add_f32 v[108:109], v[108:109], v[112:113]
    v_pk_add_f32 v[116:117], v[116:117], v[120:121]
    v_pk_add_f32 v[110:111], v[110:111], v[114:115]
    v_pk_add_f32 v[118:119], v[118:119], v[122:123]
    v_pk_add_f32 v[108:109], v[108:109], v[116:117]
    v_pk_add_f32 v[110:111], v[110:111], v[118:119]
    s_add_u32 s64, s55, 32
    ds_read_b64 v[248:249], v9 offset:32
    s_waitcnt lgkmcnt(0)
    v_and_b32 v245, 0xffff0000, v248
    v_lshlrev_b32 v244, 16, v248
    v_and_b32 v247, 0xffff0000, v249
    v_lshlrev_b32 v246, 16, v249
    v_cvt_pk_bf16_f32 v112, v108, v109
    v_and_b32 v109, 0xffff0000, v112
    v_lshlrev_b32 v108, 16, v112
    v_add_f32 v108, v108, v244
    v_add_f32 v109, v109, v245
    v_cvt_pk_bf16_f32 v112, v108, v109
    v_and_b32 v109, 0xffff0000, v112
    v_lshlrev_b32 v108, 16, v112
    v_mul_f32 v113, 0xbfb8aa3b, v108
    v_exp_f32 v113, v113
    v_mul_f32 v114, 0xbfb8aa3b, v109
    v_exp_f32 v114, v114
    s_nop 0
    v_add_f32 v113, 1.0, v113
    v_rcp_f32 v113, v113
    v_add_f32 v114, 1.0, v114
    v_rcp_f32 v114, v114
    s_nop 0
    v_mul_f32 v108, v108, v113
    v_mul_f32 v109, v109, v114
    v_cvt_pk_bf16_f32 v112, v108, v109
    v_cvt_pk_bf16_f32 v116, v110, v111
    v_and_b32 v111, 0xffff0000, v116
    v_lshlrev_b32 v110, 16, v116
    v_add_f32 v110, v110, v246
    v_add_f32 v111, v111, v247
    v_cvt_pk_bf16_f32 v116, v110, v111
    v_and_b32 v111, 0xffff0000, v116
    v_lshlrev_b32 v110, 16, v116
    v_mul_f32 v117, 0xbfb8aa3b, v110
    v_exp_f32 v117, v117
    v_mul_f32 v118, 0xbfb8aa3b, v111
    v_exp_f32 v118, v118
    s_nop 0
    v_add_f32 v117, 1.0, v117
    v_rcp_f32 v117, v117
    v_add_f32 v118, 1.0, v118
    v_rcp_f32 v118, v118
    s_nop 0
    v_mul_f32 v110, v110, v117
    v_mul_f32 v111, v111, v118
    v_cvt_pk_bf16_f32 v116, v110, v111
    v_mov_b32 v113, v116
    buffer_store_dwordx2 v[112:113], v7, s[60:63], s64 offen
    s_waitcnt lgkmcnt(4)
    v_pk_add_f32 v[124:125], v[124:125], v[128:129]
    v_pk_add_f32 v[132:133], v[132:133], v[136:137]
    v_pk_add_f32 v[126:127], v[126:127], v[130:131]
    v_pk_add_f32 v[134:135], v[134:135], v[138:139]
    v_pk_add_f32 v[124:125], v[124:125], v[132:133]
    v_pk_add_f32 v[126:127], v[126:127], v[134:135]
    s_add_u32 s64, s55, 20480
    ds_read_b64 v[248:249], v9 offset:0
    s_waitcnt lgkmcnt(0)
    v_and_b32 v245, 0xffff0000, v248
    v_lshlrev_b32 v244, 16, v248
    v_and_b32 v247, 0xffff0000, v249
    v_lshlrev_b32 v246, 16, v249
    v_cvt_pk_bf16_f32 v128, v124, v125
    v_and_b32 v125, 0xffff0000, v128
    v_lshlrev_b32 v124, 16, v128
    v_add_f32 v124, v124, v244
    v_add_f32 v125, v125, v245
    v_cvt_pk_bf16_f32 v128, v124, v125
    v_and_b32 v125, 0xffff0000, v128
    v_lshlrev_b32 v124, 16, v128
    v_mul_f32 v129, 0xbfb8aa3b, v124
    v_exp_f32 v129, v129
    v_mul_f32 v130, 0xbfb8aa3b, v125
    v_exp_f32 v130, v130
    s_nop 0
    v_add_f32 v129, 1.0, v129
    v_rcp_f32 v129, v129
    v_add_f32 v130, 1.0, v130
    v_rcp_f32 v130, v130
    s_nop 0
    v_mul_f32 v124, v124, v129
    v_mul_f32 v125, v125, v130
    v_cvt_pk_bf16_f32 v128, v124, v125
    v_cvt_pk_bf16_f32 v132, v126, v127
    v_and_b32 v127, 0xffff0000, v132
    v_lshlrev_b32 v126, 16, v132
    v_add_f32 v126, v126, v246
    v_add_f32 v127, v127, v247
    v_cvt_pk_bf16_f32 v132, v126, v127
    v_and_b32 v127, 0xffff0000, v132
    v_lshlrev_b32 v126, 16, v132
    v_mul_f32 v133, 0xbfb8aa3b, v126
    v_exp_f32 v133, v133
    v_mul_f32 v134, 0xbfb8aa3b, v127
    v_exp_f32 v134, v134
    s_nop 0
    v_add_f32 v133, 1.0, v133
    v_rcp_f32 v133, v133
    v_add_f32 v134, 1.0, v134
    v_rcp_f32 v134, v134
    s_nop 0
    v_mul_f32 v126, v126, v133
    v_mul_f32 v127, v127, v134
    v_cvt_pk_bf16_f32 v132, v126, v127
    v_mov_b32 v129, v132
    buffer_store_dwordx2 v[128:129], v7, s[60:63], s64 offen
    s_waitcnt lgkmcnt(0)
    v_pk_add_f32 v[140:141], v[140:141], v[144:145]
    v_pk_add_f32 v[148:149], v[148:149], v[152:153]
    v_pk_add_f32 v[142:143], v[142:143], v[146:147]
    v_pk_add_f32 v[150:151], v[150:151], v[154:155]
    v_pk_add_f32 v[140:141], v[140:141], v[148:149]
    v_pk_add_f32 v[142:143], v[142:143], v[150:151]
    s_add_u32 s64, s55, 20608
    ds_read_b64 v[248:249], v9 offset:128
    s_waitcnt lgkmcnt(0)
    v_and_b32 v245, 0xffff0000, v248
    v_lshlrev_b32 v244, 16, v248
    v_and_b32 v247, 0xffff0000, v249
    v_lshlrev_b32 v246, 16, v249
    v_cvt_pk_bf16_f32 v144, v140, v141
    v_and_b32 v141, 0xffff0000, v144
    v_lshlrev_b32 v140, 16, v144
    v_add_f32 v140, v140, v244
    v_add_f32 v141, v141, v245
    v_cvt_pk_bf16_f32 v144, v140, v141
    v_and_b32 v141, 0xffff0000, v144
    v_lshlrev_b32 v140, 16, v144
    v_mul_f32 v145, 0xbfb8aa3b, v140
    v_exp_f32 v145, v145
    v_mul_f32 v146, 0xbfb8aa3b, v141
    v_exp_f32 v146, v146
    s_nop 0
    v_add_f32 v145, 1.0, v145
    v_rcp_f32 v145, v145
    v_add_f32 v146, 1.0, v146
    v_rcp_f32 v146, v146
    s_nop 0
    v_mul_f32 v140, v140, v145
    v_mul_f32 v141, v141, v146
    v_cvt_pk_bf16_f32 v144, v140, v141
    v_cvt_pk_bf16_f32 v148, v142, v143
    v_and_b32 v143, 0xffff0000, v148
    v_lshlrev_b32 v142, 16, v148
    v_add_f32 v142, v142, v246
    v_add_f32 v143, v143, v247
    v_cvt_pk_bf16_f32 v148, v142, v143
    v_and_b32 v143, 0xffff0000, v148
    v_lshlrev_b32 v142, 16, v148
    v_mul_f32 v149, 0xbfb8aa3b, v142
    v_exp_f32 v149, v149
    v_mul_f32 v150, 0xbfb8aa3b, v143
    v_exp_f32 v150, v150
    s_nop 0
    v_add_f32 v149, 1.0, v149
    v_rcp_f32 v149, v149
    v_add_f32 v150, 1.0, v150
    v_rcp_f32 v150, v150
    s_nop 0
    v_mul_f32 v142, v142, v149
    v_mul_f32 v143, v143, v150
    v_cvt_pk_bf16_f32 v148, v142, v143
    v_mov_b32 v145, v148
    buffer_store_dwordx2 v[144:145], v7, s[60:63], s64 offen
    s_branch gk_rend_154
gk_w_156:
    s_cmp_lg_u32 s91, 2
    s_cbranch_scc1 gk_w_157
    ds_read_b128 v[108:111], v6 offset:2048
    ds_read_b128 v[112:115], v6 offset:12288
    ds_read_b128 v[116:119], v6 offset:22528
    ds_read_b128 v[120:123], v6 offset:32768
    ds_read_b128 v[124:127], v6 offset:6144
    ds_read_b128 v[128:131], v6 offset:16384
    ds_read_b128 v[132:135], v6 offset:26624
    ds_read_b128 v[136:139], v6 offset:36864
    s_waitcnt lgkmcnt(4)
    v_pk_add_f32 v[108:109], v[108:109], v[112:113]
    v_pk_add_f32 v[116:117], v[116:117], v[120:121]
    v_pk_add_f32 v[110:111], v[110:111], v[114:115]
    v_pk_add_f32 v[118:119], v[118:119], v[122:123]
    v_pk_add_f32 v[108:109], v[108:109], v[116:117]
    v_pk_add_f32 v[110:111], v[110:111], v[118:119]
    s_add_u32 s64, s55, 64
    ds_read_b64 v[248:249], v9 offset:64
    s_waitcnt lgkmcnt(0)
    v_and_b32 v245, 0xffff0000, v248
    v_lshlrev_b32 v244, 16, v248
    v_and_b32 v247, 0xffff0000, v249
    v_lshlrev_b32 v246, 16, v249
    v_cvt_pk_bf16_f32 v112, v108, v109
    v_and_b32 v109, 0xffff0000, v112
    v_lshlrev_b32 v108, 16, v112
    v_add_f32 v108, v108, v244
    v_add_f32 v109, v109, v245
    v_cvt_pk_bf16_f32 v112, v108, v109
    v_and_b32 v109, 0xffff0000, v112
    v_lshlrev_b32 v108, 16, v112
    v_mul_f32 v113, 0xbfb8aa3b, v108
    v_exp_f32 v113, v113
    v_mul_f32 v114, 0xbfb8aa3b, v109
    v_exp_f32 v114, v114
    s_nop 0
    v_add_f32 v113, 1.0, v113
    v_rcp_f32 v113, v113
    v_add_f32 v114, 1.0, v114
    v_rcp_f32 v114, v114
    s_nop 0
    v_mul_f32 v108, v108, v113
    v_mul_f32 v109, v109, v114
    v_cvt_pk_bf16_f32 v112, v108, v109
    v_cvt_pk_bf16_f32 v116, v110, v111
    v_and_b32 v111, 0xffff0000, v116
    v_lshlrev_b32 v110, 16, v116
    v_add_f32 v110, v110, v246
    v_add_f32 v111, v111, v247
    v_cvt_pk_bf16_f32 v116, v110, v111
    v_and_b32 v111, 0xffff0000, v116
    v_lshlrev_b32 v110, 16, v116
    v_mul_f32 v117, 0xbfb8aa3b, v110
    v_exp_f32 v117, v117
    v_mul_f32 v118, 0xbfb8aa3b, v111
    v_exp_f32 v118, v118
    s_nop 0
    v_add_f32 v117, 1.0, v117
    v_rcp_f32 v117, v117
    v_add_f32 v118, 1.0, v118
    v_rcp_f32 v118, v118
    s_nop 0
    v_mul_f32 v110, v110, v117
    v_mul_f32 v111, v111, v118
    v_cvt_pk_bf16_f32 v116, v110, v111
    v_mov_b32 v113, v116
    buffer_store_dwordx2 v[112:113], v7, s[60:63], s64 offen
    s_waitcnt lgkmcnt(0)
    v_pk_add_f32 v[124:125], v[124:125], v[128:129]
    v_pk_add_f32 v[132:133], v[132:133], v[136:137]
    v_pk_add_f32 v[126:127], v[126:127], v[130:131]
    v_pk_add_f32 v[134:135], v[134:135], v[138:139]
    v_pk_add_f32 v[124:125], v[124:125], v[132:133]
    v_pk_add_f32 v[126:127], v[126:127], v[134:135]
    s_add_u32 s64, s55, 20512
    ds_read_b64 v[248:249], v9 offset:32
    s_waitcnt lgkmcnt(0)
    v_and_b32 v245, 0xffff0000, v248
    v_lshlrev_b32 v244, 16, v248
    v_and_b32 v247, 0xffff0000, v249
    v_lshlrev_b32 v246, 16, v249
    v_cvt_pk_bf16_f32 v128, v124, v125
    v_and_b32 v125, 0xffff0000, v128
    v_lshlrev_b32 v124, 16, v128
    v_add_f32 v124, v124, v244
    v_add_f32 v125, v125, v245
    v_cvt_pk_bf16_f32 v128, v124, v125
    v_and_b32 v125, 0xffff0000, v128
    v_lshlrev_b32 v124, 16, v128
    v_mul_f32 v129, 0xbfb8aa3b, v124
    v_exp_f32 v129, v129
    v_mul_f32 v130, 0xbfb8aa3b, v125
    v_exp_f32 v130, v130
    s_nop 0
    v_add_f32 v129, 1.0, v129
    v_rcp_f32 v129, v129
    v_add_f32 v130, 1.0, v130
    v_rcp_f32 v130, v130
    s_nop 0
    v_mul_f32 v124, v124, v129
    v_mul_f32 v125, v125, v130
    v_cvt_pk_bf16_f32 v128, v124, v125
    v_cvt_pk_bf16_f32 v132, v126, v127
    v_and_b32 v127, 0xffff0000, v132
    v_lshlrev_b32 v126, 16, v132
    v_add_f32 v126, v126, v246
    v_add_f32 v127, v127, v247
    v_cvt_pk_bf16_f32 v132, v126, v127
    v_and_b32 v127, 0xffff0000, v132
    v_lshlrev_b32 v126, 16, v132
    v_mul_f32 v133, 0xbfb8aa3b, v126
    v_exp_f32 v133, v133
    v_mul_f32 v134, 0xbfb8aa3b, v127
    v_exp_f32 v134, v134
    s_nop 0
    v_add_f32 v133, 1.0, v133
    v_rcp_f32 v133, v133
    v_add_f32 v134, 1.0, v134
    v_rcp_f32 v134, v134
    s_nop 0
    v_mul_f32 v126, v126, v133
    v_mul_f32 v127, v127, v134
    v_cvt_pk_bf16_f32 v132, v126, v127
    v_mov_b32 v129, v132
    buffer_store_dwordx2 v[128:129], v7, s[60:63], s64 offen
    s_branch gk_rend_154
gk_w_157:
    s_cmp_lg_u32 s91, 3
    s_cbranch_scc1 gk_w_158
    ds_read_b128 v[108:111], v6 offset:3072
    ds_read_b128 v[112:115], v6 offset:13312
    ds_read_b128 v[116:119], v6 offset:23552
    ds_read_b128 v[120:123], v6 offset:33792
    ds_read_b128 v[124:127], v6 offset:7168
    ds_read_b128 v[128:131], v6 offset:17408
    ds_read_b128 v[132:135], v6 offset:27648
    ds_read_b128 v[136:139], v6 offset:37888
    s_waitcnt lgkmcnt(4)
    v_pk_add_f32 v[108:109], v[108:109], v[112:113]
    v_pk_add_f32 v[116:117], v[116:117], v[120:121]
    v_pk_add_f32 v[110:111], v[110:111], v[114:115]
    v_pk_add_f32 v[118:119], v[118:119], v[122:123]
    v_pk_add_f32 v[108:109], v[108:109], v[116:117]
    v_pk_add_f32 v[110:111], v[110:111], v[118:119]
    s_add_u32 s64, s55, 96
    ds_read_b64 v[248:249], v9 offset:96
    s_waitcnt lgkmcnt(0)
    v_and_b32 v245, 0xffff0000, v248
    v_lshlrev_b32 v244, 16, v248
    v_and_b32 v247, 0xffff0000, v249
    v_lshlrev_b32 v246, 16, v249
    v_cvt_pk_bf16_f32 v112, v108, v109
    v_and_b32 v109, 0xffff0000, v112
    v_lshlrev_b32 v108, 16, v112
    v_add_f32 v108, v108, v244
    v_add_f32 v109, v109, v245
    v_cvt_pk_bf16_f32 v112, v108, v109
    v_and_b32 v109, 0xffff0000, v112
    v_lshlrev_b32 v108, 16, v112
    v_mul_f32 v113, 0xbfb8aa3b, v108
    v_exp_f32 v113, v113
    v_mul_f32 v114, 0xbfb8aa3b, v109
    v_exp_f32 v114, v114
    s_nop 0
    v_add_f32 v113, 1.0, v113
    v_rcp_f32 v113, v113
    v_add_f32 v114, 1.0, v114
    v_rcp_f32 v114, v114
    s_nop 0
    v_mul_f32 v108, v108, v113
    v_mul_f32 v109, v109, v114
    v_cvt_pk_bf16_f32 v112, v108, v109
    v_cvt_pk_bf16_f32 v116, v110, v111
    v_and_b32 v111, 0xffff0000, v116
    v_lshlrev_b32 v110, 16, v116
    v_add_f32 v110, v110, v246
    v_add_f32 v111, v111, v247
    v_cvt_pk_bf16_f32 v116, v110, v111
    v_and_b32 v111, 0xffff0000, v116
    v_lshlrev_b32 v110, 16, v116
    v_mul_f32 v117, 0xbfb8aa3b, v110
    v_exp_f32 v117, v117
    v_mul_f32 v118, 0xbfb8aa3b, v111
    v_exp_f32 v118, v118
    s_nop 0
    v_add_f32 v117, 1.0, v117
    v_rcp_f32 v117, v117
    v_add_f32 v118, 1.0, v118
    v_rcp_f32 v118, v118
    s_nop 0
    v_mul_f32 v110, v110, v117
    v_mul_f32 v111, v111, v118
    v_cvt_pk_bf16_f32 v116, v110, v111
    v_mov_b32 v113, v116
    buffer_store_dwordx2 v[112:113], v7, s[60:63], s64 offen
    s_waitcnt lgkmcnt(0)
    v_pk_add_f32 v[124:125], v[124:125], v[128:129]
    v_pk_add_f32 v[132:133], v[132:133], v[136:137]
    v_pk_add_f32 v[126:127], v[126:127], v[130:131]
    v_pk_add_f32 v[134:135], v[134:135], v[138:139]
    v_pk_add_f32 v[124:125], v[124:125], v[132:133]
    v_pk_add_f32 v[126:127], v[126:127], v[134:135]
    s_add_u32 s64, s55, 20544
    ds_read_b64 v[248:249], v9 offset:64
    s_waitcnt lgkmcnt(0)
    v_and_b32 v245, 0xffff0000, v248
    v_lshlrev_b32 v244, 16, v248
    v_and_b32 v247, 0xffff0000, v249
    v_lshlrev_b32 v246, 16, v249
    v_cvt_pk_bf16_f32 v128, v124, v125
    v_and_b32 v125, 0xffff0000, v128
    v_lshlrev_b32 v124, 16, v128
    v_add_f32 v124, v124, v244
    v_add_f32 v125, v125, v245
    v_cvt_pk_bf16_f32 v128, v124, v125
    v_and_b32 v125, 0xffff0000, v128
    v_lshlrev_b32 v124, 16, v128
    v_mul_f32 v129, 0xbfb8aa3b, v124
    v_exp_f32 v129, v129
    v_mul_f32 v130, 0xbfb8aa3b, v125
    v_exp_f32 v130, v130
    s_nop 0
    v_add_f32 v129, 1.0, v129
    v_rcp_f32 v129, v129
    v_add_f32 v130, 1.0, v130
    v_rcp_f32 v130, v130
    s_nop 0
    v_mul_f32 v124, v124, v129
    v_mul_f32 v125, v125, v130
    v_cvt_pk_bf16_f32 v128, v124, v125
    v_cvt_pk_bf16_f32 v132, v126, v127
    v_and_b32 v127, 0xffff0000, v132
    v_lshlrev_b32 v126, 16, v132
    v_add_f32 v126, v126, v246
    v_add_f32 v127, v127, v247
    v_cvt_pk_bf16_f32 v132, v126, v127
    v_and_b32 v127, 0xffff0000, v132
    v_lshlrev_b32 v126, 16, v132
    v_mul_f32 v133, 0xbfb8aa3b, v126
    v_exp_f32 v133, v133
    v_mul_f32 v134, 0xbfb8aa3b, v127
    v_exp_f32 v134, v134
    s_nop 0
    v_add_f32 v133, 1.0, v133
    v_rcp_f32 v133, v133
    v_add_f32 v134, 1.0, v134
    v_rcp_f32 v134, v134
    s_nop 0
    v_mul_f32 v126, v126, v133
    v_mul_f32 v127, v127, v134
    v_cvt_pk_bf16_f32 v132, v126, v127
    v_mov_b32 v129, v132
    buffer_store_dwordx2 v[128:129], v7, s[60:63], s64 offen
    s_branch gk_rend_154
gk_w_158:
gk_rend_154:
    s_barrier
    s_add_u32 s54, s54, s53
    s_cmp_ge_u32 s54, s52
    s_cbranch_scc1 gk_out_142
    s_branch gk_loop_141
gk_out_142:
    s_branch wk_att_79
wk_att0_81:
    v_mov_b32 v254, 68
    s_mov_b32 s93, 0
wi_p_159:
    buffer_load_dword v255, v254, s[32:35], 0 offen sc1
    s_waitcnt vmcnt(0)
    v_cmp_le_u32 vcc, 256, v255
    s_cbranch_vccnz wi_ok_160
    s_sleep 4
    s_add_u32 s93, s93, 1
    s_cmp_lt_u32 s93, 1048576
    s_cbranch_scc1 wi_p_159
wi_ok_160:
    s_cmp_lg_u32 s58, 0
    s_cbranch_scc1 cm_ok_161
    v_and_b32 v254, 7, v0
    v_lshlrev_b32 v254, 2, v254
    buffer_load_dword v255, v254, s[32:35], 0 offen sc1
    s_waitcnt vmcnt(0)
    v_cmp_ne_u32 vcc, 32, v255
    s_cbranch_vccz cm_ok_161
    s_mov_b32 s58, 1
    s_lshr_b32 s56, s88, 5
    s_and_b32 s57, s88, 31
    s_barrier
    s_branch rc_restart_8
cm_ok_161:
    s_add_u32 s40, s14, 0x05600000
    s_addc_u32 s41, s15, 0
    s_mov_b32 s42, 0x00c00000
    s_mov_b32 s43, 0x00020000
    s_sub_u32 s16, s90, 104
    v_lshlrev_b32 v4, 4, v0
    v_mov_b32 v8, -1
    v_mov_b32 v9, -1
    v_mov_b32 v10, -1
    v_mov_b32 v11, -1
wk_fill_162:
    s_mul_i32 s17, s16, 98304
    s_add_u32 s18, s17, 6291456
    buffer_store_dwordx4 v[8:11], v4, s[40:43], s17 offen sc1
    buffer_store_dwordx4 v[8:11], v4, s[40:43], s18 offen sc1
    s_add_u32 s17, s17, 4096
    s_add_u32 s18, s18, 4096
    buffer_store_dwordx4 v[8:11], v4, s[40:43], s17 offen sc1
    buffer_store_dwordx4 v[8:11], v4, s[40:43], s18 offen sc1
    s_add_u32 s17, s17, 4096
    s_add_u32 s18, s18, 4096
    buffer_store_dwordx4 v[8:11], v4, s[40:43], s17 offen sc1
    buffer_store_dwordx4 v[8:11], v4, s[40:43], s18 offen sc1
    s_add_u32 s17, s17, 4096
    s_add_u32 s18, s18, 4096
    buffer_store_dwordx4 v[8:11], v4, s[40:43], s17 offen sc1
    buffer_store_dwordx4 v[8:11], v4, s[40:43], s18 offen sc1
    s_add_u32 s17, s17, 4096
    s_add_u32 s18, s18, 4096
    buffer_store_dwordx4 v[8:11], v4, s[40:43], s17 offen sc1
    buffer_store_dwordx4 v[8:11], v4, s[40:43], s18 offen sc1
    s_add_u32 s17, s17, 4096
    s_add_u32 s18, s18, 4096
    buffer_store_dwordx4 v[8:11], v4, s[40:43], s17 offen sc1
    buffer_store_dwordx4 v[8:11], v4, s[40:43], s18 offen sc1
    s_add_u32 s17, s17, 4096
    s_add_u32 s18, s18, 4096
    buffer_store_dwordx4 v[8:11], v4, s[40:43], s17 offen sc1
    buffer_store_dwordx4 v[8:11], v4, s[40:43], s18 offen sc1
    s_add_u32 s17, s17, 4096
    s_add_u32 s18, s18, 4096
    buffer_store_dwordx4 v[8:11], v4, s[40:43], s17 offen sc1
    buffer_store_dwordx4 v[8:11], v4, s[40:43], s18 offen sc1
    s_add_u32 s17, s17, 4096
    s_add_u32 s18, s18, 4096
    buffer_store_dwordx4 v[8:11], v4, s[40:43], s17 offen sc1
    buffer_store_dwordx4 v[8:11], v4, s[40:43], s18 offen sc1
    s_add_u32 s17, s17, 4096
    s_add_u32 s18, s18, 4096
    buffer_store_dwordx4 v[8:11], v4, s[40:43], s17 offen sc1
    buffer_store_dwordx4 v[8:11], v4, s[40:43], s18 offen sc1
    s_add_u32 s17, s17, 4096
    s_add_u32 s18, s18, 4096
    buffer_store_dwordx4 v[8:11], v4, s[40:43], s17 offen sc1
    buffer_store_dwordx4 v[8:11], v4, s[40:43], s18 offen sc1
    s_add_u32 s17, s17, 4096
    s_add_u32 s18, s18, 4096
    buffer_store_dwordx4 v[8:11], v4, s[40:43], s17 offen sc1
    buffer_store_dwordx4 v[8:11], v4, s[40:43], s18 offen sc1
    s_add_u32 s17, s17, 4096
    s_add_u32 s18, s18, 4096
    buffer_store_dwordx4 v[8:11], v4, s[40:43], s17 offen sc1
    buffer_store_dwordx4 v[8:11], v4, s[40:43], s18 offen sc1
    s_add_u32 s17, s17, 4096
    s_add_u32 s18, s18, 4096
    buffer_store_dwordx4 v[8:11], v4, s[40:43], s17 offen sc1
    buffer_store_dwordx4 v[8:11], v4, s[40:43], s18 offen sc1
    s_add_u32 s17, s17, 4096
    s_add_u32 s18, s18, 4096
    buffer_store_dwordx4 v[8:11], v4, s[40:43], s17 offen sc1
    buffer_store_dwordx4 v[8:11], v4, s[40:43], s18 offen sc1
    s_add_u32 s17, s17, 4096
    s_add_u32 s18, s18, 4096
    buffer_store_dwordx4 v[8:11], v4, s[40:43], s17 offen sc1
    buffer_store_dwordx4 v[8:11], v4, s[40:43], s18 offen sc1
    s_add_u32 s17, s17, 4096
    s_add_u32 s18, s18, 4096
    buffer_store_dwordx4 v[8:11], v4, s[40:43], s17 offen sc1
    buffer_store_dwordx4 v[8:11], v4, s[40:43], s18 offen sc1
    s_add_u32 s17, s17, 4096
    s_add_u32 s18, s18, 4096
    buffer_store_dwordx4 v[8:11], v4, s[40:43], s17 offen sc1
    buffer_store_dwordx4 v[8:11], v4, s[40:43], s18 offen sc1
    s_add_u32 s17, s17, 4096
    s_add_u32 s18, s18, 4096
    buffer_store_dwordx4 v[8:11], v4, s[40:43], s17 offen sc1
    buffer_store_dwordx4 v[8:11], v4, s[40:43], s18 offen sc1
    s_add_u32 s17, s17, 4096
    s_add_u32 s18, s18, 4096
    buffer_store_dwordx4 v[8:11], v4, s[40:43], s17 offen sc1
    buffer_store_dwordx4 v[8:11], v4, s[40:43], s18 offen sc1
    s_add_u32 s17, s17, 4096
    s_add_u32 s18, s18, 4096
    buffer_store_dwordx4 v[8:11], v4, s[40:43], s17 offen sc1
    buffer_store_dwordx4 v[8:11], v4, s[40:43], s18 offen sc1
    s_add_u32 s17, s17, 4096
    s_add_u32 s18, s18, 4096
    buffer_store_dwordx4 v[8:11], v4, s[40:43], s17 offen sc1
    buffer_store_dwordx4 v[8:11], v4, s[40:43], s18 offen sc1
    s_add_u32 s17, s17, 4096
    s_add_u32 s18, s18, 4096
    buffer_store_dwordx4 v[8:11], v4, s[40:43], s17 offen sc1
    buffer_store_dwordx4 v[8:11], v4, s[40:43], s18 offen sc1
    s_add_u32 s17, s17, 4096
    s_add_u32 s18, s18, 4096
    buffer_store_dwordx4 v[8:11], v4, s[40:43], s17 offen sc1
    buffer_store_dwordx4 v[8:11], v4, s[40:43], s18 offen sc1
    s_add_u32 s17, s17, 4096
    s_add_u32 s18, s18, 4096
    s_waitcnt vmcnt(0)
    s_barrier
    s_cmp_lg_u32 s91, 0
    s_cbranch_scc1 wk_fs_163
    s_add_u32 s93, s16, 64
    s_lshl_b32 s93, s93, 8
    v_mov_b32 v254, s93
    v_mov_b32 v255, 1
    s_mov_b64 s[94:95], exec
    s_mov_b64 exec, 1
    buffer_atomic_add v255, v254, s[28:31], 0 offen
    s_mov_b64 exec, s[94:95]
wk_fs_163:
    s_add_u32 s16, s16, 24
    s_cmp_lt_u32 s16, 64
    s_cbranch_scc1 wk_fill_162
wk_att_79:
    s_add_u32 s40, s14, 0x00400000
    s_addc_u32 s41, s15, 0
    s_mov_b32 s42, 0x01800000
    s_mov_b32 s43, 0x00020000
    s_add_u32 s44, s14, 0x01c00000
    s_addc_u32 s45, s15, 0
    s_mov_b32 s46, 0x01800000
    s_mov_b32 s47, 0x00020000
    s_add_u32 s48, s14, 0x03400000
    s_addc_u32 s49, s15, 0
    s_mov_b32 s50, 0x01800000
    s_mov_b32 s51, 0x00020000
    s_add_u32 s52, s14, 0x05600000
    s_addc_u32 s53, s15, 0
    s_mov_b32 s54, 0x00600000
    s_mov_b32 s55, 0x00020000
    s_add_u32 s60, s14, 0x05c00000
    s_addc_u32 s61, s15, 0
    s_mov_b32 s62, 0x00600000
    s_mov_b32 s63, 0x00020000
    s_add_u32 s64, s14, 0x06200000
    s_addc_u32 s65, s15, 0
    s_mov_b32 s66, 0x01800000
    s_mov_b32 s67, 0x00020000
at_loop_164:
    s_cmp_lg_u32 s91, 0
    s_cbranch_scc1 at_nt_166
    v_mov_b32 v254, 65536
    v_mov_b32 v255, 1
    s_mov_b64 s[94:95], exec
    s_mov_b64 exec, 1
    buffer_atomic_add v255, v254, s[28:31], 0 offen sc0
    s_waitcnt vmcnt(0)
    v_mov_b32 v254, 0
    ds_write_b32 v254, v255
    s_waitcnt lgkmcnt(0)
    s_mov_b64 exec, s[94:95]
at_nt_166:
    s_barrier
    v_mov_b32 v254, 0
    ds_read_b32 v255, v254
    s_waitcnt lgkmcnt(0)
    v_readfirstlane_b32 s17, v255
    s_barrier
    s_cmp_ge_u32 s17, 512
    s_cbranch_scc1 at_end_165
    s_lshr_b32 s16, s17, 3
    s_lshr_b32 s19, s17, 5
    s_add_u32 s93, s16, 0
    s_lshl_b32 s93, s93, 8
    v_mov_b32 v254, s93
wk_poll_167:
    buffer_load_dword v255, v254, s[28:31], 0 offen sc1
    s_waitcnt vmcnt(0)
    v_cmp_le_u32 vcc, 32, v255
    s_cbranch_vccnz wk_ok_168
    s_sleep 8
    s_add_u32 s92, s92, 1
    s_cmp_lt_u32 s92, 1048576
    s_cbranch_scc1 wk_poll_167
wk_ok_168:
    s_add_u32 s93, s16, 64
    s_lshl_b32 s93, s93, 8
    v_mov_b32 v254, s93
wk_poll_169:
    buffer_load_dword v255, v254, s[28:31], 0 offen sc1
    s_waitcnt vmcnt(0)
    v_cmp_le_u32 vcc, 65, v255
    s_cbranch_vccnz wk_ok_170
    s_sleep 8
    s_add_u32 s92, s92, 1
    s_cmp_lt_u32 s92, 1048576
    s_cbranch_scc1 wk_poll_169
wk_ok_170:
    s_lshl_b32 s18, s17, 2
    s_add_u32 s18, s18, s91
    v_mov_b32 v1, s18
    v_and_b32 v2, 31, v0
    v_bfe_u32 v3, v0, 5, 1
    v_mul_u32_u24 v4, 12288, v1
    v_lshl_add_u32 v5, v2, 5, v4
    v_lshl_add_u32 v5, v3, 4, v5
    v_add_u32 v14, 4096, v5
    v_add_u32 v15, 8192, v5
    v_mul_u32_u24 v6, 3072, v1
    v_and_b32 v7, 7, v2
    v_lshl_add_u32 v7, v7, 5, v6
    v_lshl_add_u32 v7, v3, 4, v7
    v_lshl_add_u32 v8, v2, 6, v4
    v_lshl_add_u32 v8, v3, 4, v8
    v_add_u32 v9, 4096, v8
    v_add_u32 v10, 8192, v8
    v_lshl_add_u32 v11, v2, 4, v6
    v_lshl_add_u32 v11, v3, 3, v11
    buffer_load_dwordx4 v[16:19], v5, s[40:43], 0 offen offset:0 sc1
    buffer_load_dwordx4 v[64:67], v5, s[44:47], 0 offen offset:0 sc1
    buffer_load_dwordx4 v[20:23], v5, s[40:43], 0 offen offset:1024 sc1
    buffer_load_dwordx4 v[68:71], v5, s[44:47], 0 offen offset:1024 sc1
    buffer_load_dwordx4 v[24:27], v5, s[40:43], 0 offen offset:2048 sc1
    buffer_load_dwordx4 v[72:75], v5, s[44:47], 0 offen offset:2048 sc1
    buffer_load_dwordx4 v[28:31], v5, s[40:43], 0 offen offset:3072 sc1
    buffer_load_dwordx4 v[76:79], v5, s[44:47], 0 offen offset:3072 sc1
    buffer_load_dwordx4 v[32:35], v14, s[40:43], 0 offen offset:0 sc1
    buffer_load_dwordx4 v[80:83], v14, s[44:47], 0 offen offset:0 sc1
    buffer_load_dwordx4 v[36:39], v14, s[40:43], 0 offen offset:1024 sc1
    buffer_load_dwordx4 v[84:87], v14, s[44:47], 0 offen offset:1024 sc1
    buffer_load_dwordx4 v[40:43], v14, s[40:43], 0 offen offset:2048 sc1
    buffer_load_dwordx4 v[88:91], v14, s[44:47], 0 offen offset:2048 sc1
    buffer_load_dwordx4 v[44:47], v14, s[40:43], 0 offen offset:3072 sc1
    buffer_load_dwordx4 v[92:95], v14, s[44:47], 0 offen offset:3072 sc1
    buffer_load_dwordx4 v[48:51], v15, s[40:43], 0 offen offset:0 sc1
    buffer_load_dwordx4 v[96:99], v15, s[44:47], 0 offen offset:0 sc1
    buffer_load_dwordx4 v[52:55], v15, s[40:43], 0 offen offset:1024 sc1
    buffer_load_dwordx4 v[100:103], v15, s[44:47], 0 offen offset:1024 sc1
    buffer_load_dwordx4 v[56:59], v15, s[40:43], 0 offen offset:2048 sc1
    buffer_load_dwordx4 v[104:107], v15, s[44:47], 0 offen offset:2048 sc1
    buffer_load_dwordx4 v[60:63], v15, s[40:43], 0 offen offset:3072 sc1
    buffer_load_dwordx4 v[108:111], v15, s[44:47], 0 offen offset:3072 sc1
    buffer_load_dwordx4 v[160:163], v8, s[48:51], 0 offen offset:0 sc1
    buffer_load_dwordx4 v[164:167], v8, s[48:51], 0 offen offset:32 sc1
    buffer_load_dwordx4 v[168:171], v8, s[48:51], 0 offen offset:2048 sc1
    buffer_load_dwordx4 v[172:175], v8, s[48:51], 0 offen offset:2080 sc1
    buffer_load_dwordx4 v[176:179], v9, s[48:51], 0 offen offset:0 sc1
    buffer_load_dwordx4 v[180:183], v9, s[48:51], 0 offen offset:32 sc1
    buffer_load_dwordx4 v[184:187], v9, s[48:51], 0 offen offset:2048 sc1
    buffer_load_dwordx4 v[188:191], v9, s[48:51], 0 offen offset:2080 sc1
    buffer_load_dwordx4 v[192:195], v10, s[48:51], 0 offen offset:0 sc1
    buffer_load_dwordx4 v[196:199], v10, s[48:51], 0 offen offset:32 sc1
    buffer_load_dwordx4 v[200:203], v10, s[48:51], 0 offen offset:2048 sc1
    buffer_load_dwordx4 v[204:207], v10, s[48:51], 0 offen offset:2080 sc1
    s_waitcnt vmcnt(34)
    v_mfma_f32_32x32x16_bf16 v[220:235], v[64:67], v[16:19], 0
    s_waitcnt vmcnt(32)
    v_mfma_f32_32x32x16_bf16 v[220:235], v[68:71], v[20:23], v[220:235]
    s_waitcnt vmcnt(30)
    v_mfma_f32_32x32x16_bf16 v[220:235], v[72:75], v[24:27], v[220:235]
    s_waitcnt vmcnt(28)
    v_mfma_f32_32x32x16_bf16 v[220:235], v[76:79], v[28:31], v[220:235]
    s_waitcnt vmcnt(26)
    v_mfma_f32_32x32x16_bf16 v[220:235], v[80:83], v[32:35], v[220:235]
    s_waitcnt vmcnt(24)
    v_mfma_f32_32x32x16_bf16 v[220:235], v[84:87], v[36:39], v[220:235]
    s_waitcnt vmcnt(22)
    v_mfma_f32_32x32x16_bf16 v[220:235], v[88:91], v[40:43], v[220:235]
    s_waitcnt vmcnt(20)
    v_mfma_f32_32x32x16_bf16 v[220:235], v[92:95], v[44:47], v[220:235]
    s_waitcnt vmcnt(18)
    v_mfma_f32_32x32x16_bf16 v[220:235], v[96:99], v[48:51], v[220:235]
    s_waitcnt vmcnt(16)
    v_mfma_f32_32x32x16_bf16 v[220:235], v[100:103], v[52:55], v[220:235]
    s_waitcnt vmcnt(14)
    v_mfma_f32_32x32x16_bf16 v[220:235], v[104:107], v[56:59], v[220:235]
    s_waitcnt vmcnt(12)
    v_mfma_f32_32x32x16_bf16 v[220:235], v[108:111], v[60:63], v[220:235]
at_pm_171:
    buffer_load_dwordx2 v[208:209], v11, s[60:63], 0 offen offset:0 sc1
    buffer_load_dwordx2 v[210:211], v11, s[60:63], 0 offen offset:512 sc1
    buffer_load_dwordx2 v[212:213], v11, s[60:63], 0 offen offset:1024 sc1
    buffer_load_dwordx2 v[214:215], v11, s[60:63], 0 offen offset:1536 sc1
    buffer_load_dwordx2 v[216:217], v11, s[60:63], 0 offen offset:2048 sc1
    buffer_load_dwordx2 v[218:219], v11, s[60:63], 0 offen offset:2560 sc1
    buffer_load_dwordx4 v[112:115], v7, s[52:55], 0 offen offset:0 sc1
    buffer_load_dwordx4 v[116:119], v7, s[52:55], 0 offen offset:256 sc1
    buffer_load_dwordx4 v[120:123], v7, s[52:55], 0 offen offset:512 sc1
    buffer_load_dwordx4 v[124:127], v7, s[52:55], 0 offen offset:768 sc1
    buffer_load_dwordx4 v[128:131], v7, s[52:55], 0 offen offset:1024 sc1
    buffer_load_dwordx4 v[132:135], v7, s[52:55], 0 offen offset:1280 sc1
    buffer_load_dwordx4 v[136:139], v7, s[52:55], 0 offen offset:1536 sc1
    buffer_load_dwordx4 v[140:143], v7, s[52:55], 0 offen offset:1792 sc1
    buffer_load_dwordx4 v[144:147], v7, s[52:55], 0 offen offset:2048 sc1
    buffer_load_dwordx4 v[148:151], v7, s[52:55], 0 offen offset:2304 sc1
    buffer_load_dwordx4 v[152:155], v7, s[52:55], 0 offen offset:2560 sc1
    buffer_load_dwordx4 v[156:159], v7, s[52:55], 0 offen offset:2816 sc1
    s_waitcnt vmcnt(0)
    v_max3_u32 v12, v208, v209, v210
    v_max3_u32 v12, v12, v211, v212
    v_max3_u32 v12, v12, v213, v214
    v_max3_u32 v12, v12, v215, v216
    v_max3_u32 v12, v12, v217, v218
    v_max3_u32 v12, v12, v219, v112
    v_max3_u32 v12, v12, v113, v114
    v_max3_u32 v12, v12, v115, v116
    v_max3_u32 v12, v12, v117, v118
    v_max3_u32 v12, v12, v119, v120
    v_max3_u32 v12, v12, v121, v122
    v_max3_u32 v12, v12, v123, v124
    v_max3_u32 v12, v12, v125, v126
    v_max3_u32 v12, v12, v127, v128
    v_max3_u32 v12, v12, v129, v130
    v_max3_u32 v12, v12, v131, v132
    v_max3_u32 v12, v12, v133, v134
    v_max3_u32 v12, v12, v135, v136
    v_max3_u32 v12, v12, v137, v138
    v_max3_u32 v12, v12, v139, v140
    v_max3_u32 v12, v12, v141, v142
    v_max3_u32 v12, v12, v143, v144
    v_max3_u32 v12, v12, v145, v146
    v_max3_u32 v12, v12, v147, v148
    v_max3_u32 v12, v12, v149, v150
    v_max3_u32 v12, v12, v151, v152
    v_max3_u32 v12, v12, v153, v154
    v_max3_u32 v12, v12, v155, v156
    v_max3_u32 v12, v12, v157, v158
    v_max_u32 v12, v12, v159
    v_cmp_eq_u32 vcc, -1, v12
    s_cbranch_vccz at_pok_172
    s_sleep 6
    s_add_u32 s92, s92, 1
    s_cmp_lt_u32 s92, 1048576
    s_cbranch_scc1 at_pm_171
at_pok_172:
    v_mfma_f32_32x32x16_bf16 v[236:251], v[112:115], v[16:19], 0
    v_mfma_f32_32x32x16_bf16 v[236:251], v[116:119], v[20:23], v[236:251]
    v_mfma_f32_32x32x16_bf16 v[236:251], v[120:123], v[24:27], v[236:251]
    v_mfma_f32_32x32x16_bf16 v[236:251], v[124:127], v[28:31], v[236:251]
    v_mfma_f32_32x32x16_bf16 v[236:251], v[128:131], v[32:35], v[236:251]
    v_mfma_f32_32x32x16_bf16 v[236:251], v[132:135], v[36:39], v[236:251]
    v_mfma_f32_32x32x16_bf16 v[236:251], v[136:139], v[40:43], v[236:251]
    v_mfma_f32_32x32x16_bf16 v[236:251], v[140:143], v[44:47], v[236:251]
    v_mfma_f32_32x32x16_bf16 v[236:251], v[144:147], v[48:51], v[236:251]
    v_mfma_f32_32x32x16_bf16 v[236:251], v[148:151], v[52:55], v[236:251]
    v_mfma_f32_32x32x16_bf16 v[236:251], v[152:155], v[56:59], v[236:251]
    v_mfma_f32_32x32x16_bf16 v[236:251], v[156:159], v[60:63], v[236:251]
    v_lshlrev_b32 v12, 2, v3
    v_sub_u32 v12, v2, v12
    v_mov_b32 v13, 0xce6e6b28
    s_mov_b32 s56, 0x3d93cd3a
    s_nop 15
    s_nop 3
    v_cvt_pk_bf16_f32 v14, v220, v221
    v_and_b32 v221, 0xffff0000, v14
    v_lshlrev_b32 v220, 16, v14
    v_mul_f32 v220, s56, v220
    v_mul_f32 v221, s56, v221
    v_cvt_pk_bf16_f32 v14, v220, v221
    v_and_b32 v221, 0xffff0000, v14
    v_lshlrev_b32 v220, 16, v14
    v_cvt_pk_bf16_f32 v14, v222, v223
    v_and_b32 v223, 0xffff0000, v14
    v_lshlrev_b32 v222, 16, v14
    v_mul_f32 v222, s56, v222
    v_mul_f32 v223, s56, v223
    v_cvt_pk_bf16_f32 v14, v222, v223
    v_and_b32 v223, 0xffff0000, v14
    v_lshlrev_b32 v222, 16, v14
    v_cvt_pk_bf16_f32 v14, v224, v225
    v_and_b32 v225, 0xffff0000, v14
    v_lshlrev_b32 v224, 16, v14
    v_mul_f32 v224, s56, v224
    v_mul_f32 v225, s56, v225
    v_cvt_pk_bf16_f32 v14, v224, v225
    v_and_b32 v225, 0xffff0000, v14
    v_lshlrev_b32 v224, 16, v14
    v_cvt_pk_bf16_f32 v14, v226, v227
    v_and_b32 v227, 0xffff0000, v14
    v_lshlrev_b32 v226, 16, v14
    v_mul_f32 v226, s56, v226
    v_mul_f32 v227, s56, v227
    v_cvt_pk_bf16_f32 v14, v226, v227
    v_and_b32 v227, 0xffff0000, v14
    v_lshlrev_b32 v226, 16, v14
    v_cvt_pk_bf16_f32 v14, v228, v229
    v_and_b32 v229, 0xffff0000, v14
    v_lshlrev_b32 v228, 16, v14
    v_mul_f32 v228, s56, v228
    v_mul_f32 v229, s56, v229
    v_cvt_pk_bf16_f32 v14, v228, v229
    v_and_b32 v229, 0xffff0000, v14
    v_lshlrev_b32 v228, 16, v14
    v_cvt_pk_bf16_f32 v14, v230, v231
    v_and_b32 v231, 0xffff0000, v14
    v_lshlrev_b32 v230, 16, v14
    v_mul_f32 v230, s56, v230
    v_mul_f32 v231, s56, v231
    v_cvt_pk_bf16_f32 v14, v230, v231
    v_and_b32 v231, 0xffff0000, v14
    v_lshlrev_b32 v230, 16, v14
    v_cvt_pk_bf16_f32 v14, v232, v233
    v_and_b32 v233, 0xffff0000, v14
    v_lshlrev_b32 v232, 16, v14
    v_mul_f32 v232, s56, v232
    v_mul_f32 v233, s56, v233
    v_cvt_pk_bf16_f32 v14, v232, v233
    v_and_b32 v233, 0xffff0000, v14
    v_lshlrev_b32 v232, 16, v14
    v_cvt_pk_bf16_f32 v14, v234, v235
    v_and_b32 v235, 0xffff0000, v14
    v_lshlrev_b32 v234, 16, v14
    v_mul_f32 v234, s56, v234
    v_mul_f32 v235, s56, v235
    v_cvt_pk_bf16_f32 v14, v234, v235
    v_and_b32 v235, 0xffff0000, v14
    v_lshlrev_b32 v234, 16, v14
    v_cvt_pk_bf16_f32 v14, v236, v237
    v_and_b32 v237, 0xffff0000, v14
    v_lshlrev_b32 v236, 16, v14
    v_mul_f32 v236, s56, v236
    v_mul_f32 v237, s56, v237
    v_cvt_pk_bf16_f32 v14, v236, v237
    v_and_b32 v237, 0xffff0000, v14
    v_lshlrev_b32 v236, 16, v14
    v_cvt_pk_bf16_f32 v14, v238, v239
    v_and_b32 v239, 0xffff0000, v14
    v_lshlrev_b32 v238, 16, v14
    v_mul_f32 v238, s56, v238
    v_mul_f32 v239, s56, v239
    v_cvt_pk_bf16_f32 v14, v238, v239
    v_and_b32 v239, 0xffff0000, v14
    v_lshlrev_b32 v238, 16, v14
    v_cmp_le_i32 vcc, 0, v12
    s_nop 1
    v_cndmask_b32 v220, v13, v220, vcc
    v_cmp_le_i32 vcc, 1, v12
    s_nop 1
    v_cndmask_b32 v221, v13, v221, vcc
    v_cmp_le_i32 vcc, 2, v12
    s_nop 1
    v_cndmask_b32 v222, v13, v222, vcc
    v_cmp_le_i32 vcc, 3, v12
    s_nop 1
    v_cndmask_b32 v223, v13, v223, vcc
    v_cmp_le_i32 vcc, 8, v12
    s_nop 1
    v_cndmask_b32 v224, v13, v224, vcc
    v_cmp_le_i32 vcc, 9, v12
    s_nop 1
    v_cndmask_b32 v225, v13, v225, vcc
    v_cmp_le_i32 vcc, 10, v12
    s_nop 1
    v_cndmask_b32 v226, v13, v226, vcc
    v_cmp_le_i32 vcc, 11, v12
    s_nop 1
    v_cndmask_b32 v227, v13, v227, vcc
    v_cmp_le_i32 vcc, 16, v12
    s_nop 1
    v_cndmask_b32 v228, v13, v228, vcc
    v_cmp_le_i32 vcc, 17, v12
    s_nop 1
    v_cndmask_b32 v229, v13, v229, vcc
    v_cmp_le_i32 vcc, 18, v12
    s_nop 1
    v_cndmask_b32 v230, v13, v230, vcc
    v_cmp_le_i32 vcc, 19, v12
    s_nop 1
    v_cndmask_b32 v231, v13, v231, vcc
    v_cmp_le_i32 vcc, 24, v12
    s_nop 1
    v_cndmask_b32 v232, v13, v232, vcc
    v_cmp_le_i32 vcc, 25, v12
    s_nop 1
    v_cndmask_b32 v233, v13, v233, vcc
    v_cmp_le_i32 vcc, 26, v12
    s_nop 1
    v_cndmask_b32 v234, v13, v234, vcc
    v_cmp_le_i32 vcc, 27, v12
    s_nop 1
    v_cndmask_b32 v235, v13, v235, vcc
    v_max3_f32 v14, v220, v221, v222
    v_max3_f32 v14, v14, v223, v224
    v_max3_f32 v14, v14, v225, v226
    v_max3_f32 v14, v14, v227, v228
    v_max3_f32 v14, v14, v229, v230
    v_max3_f32 v14, v14, v231, v232
    v_max3_f32 v14, v14, v233, v234
    v_max3_f32 v14, v14, v235, v236
    v_max3_f32 v14, v14, v237, v238
    v_max_f32 v14, v14, v239
    v_mov_b32 v15, v14
    s_nop 1
    v_permlane32_swap_b32 v14, v15
    s_nop 1
    v_max_f32 v14, v14, v15
    v_mul_f32 v14, 0xbfb8aa3b, v14
    s_mov_b32 s57, 0x3fb8aa3b
    v_fma_f32 v220, v220, s57, v14
    v_exp_f32 v220, v220
    v_fma_f32 v221, v221, s57, v14
    v_exp_f32 v221, v221
    v_fma_f32 v222, v222, s57, v14
    v_exp_f32 v222, v222
    v_fma_f32 v223, v223, s57, v14
    v_exp_f32 v223, v223
    v_fma_f32 v224, v224, s57, v14
    v_exp_f32 v224, v224
    v_fma_f32 v225, v225, s57, v14
    v_exp_f32 v225, v225
    v_fma_f32 v226, v226, s57, v14
    v_exp_f32 v226, v226
    v_fma_f32 v227, v227, s57, v14
    v_exp_f32 v227, v227
    v_fma_f32 v228, v228, s57, v14
    v_exp_f32 v228, v228
    v_fma_f32 v229, v229, s57, v14
    v_exp_f32 v229, v229
    v_fma_f32 v230, v230, s57, v14
    v_exp_f32 v230, v230
    v_fma_f32 v231, v231, s57, v14
    v_exp_f32 v231, v231
    v_fma_f32 v232, v232, s57, v14
    v_exp_f32 v232, v232
    v_fma_f32 v233, v233, s57, v14
    v_exp_f32 v233, v233
    v_fma_f32 v234, v234, s57, v14
    v_exp_f32 v234, v234
    v_fma_f32 v235, v235, s57, v14
    v_exp_f32 v235, v235
    v_fma_f32 v236, v236, s57, v14
    v_exp_f32 v236, v236
    v_fma_f32 v237, v237, s57, v14
    v_exp_f32 v237, v237
    v_fma_f32 v238, v238, s57, v14
    v_exp_f32 v238, v238
    v_fma_f32 v239, v239, s57, v14
    v_exp_f32 v239, v239
    s_nop 0
    v_add_f32 v14, v220, v221
    v_add_f32 v14, v14, v222
    v_add_f32 v14, v14, v223
    v_add_f32 v14, v14, v224
    v_add_f32 v14, v14, v225
    v_add_f32 v14, v14, v226
    v_add_f32 v14, v14, v227
    v_add_f32 v14, v14, v228
    v_add_f32 v14, v14, v229
    v_add_f32 v14, v14, v230
    v_add_f32 v14, v14, v231
    v_add_f32 v14, v14, v232
    v_add_f32 v14, v14, v233
    v_add_f32 v14, v14, v234
    v_add_f32 v14, v14, v235
    v_add_f32 v14, v14, v236
    v_add_f32 v14, v14, v237
    v_add_f32 v14, v14, v238
    v_add_f32 v14, v14, v239
    v_mov_b32 v15, v14
    s_nop 1
    v_permlane32_swap_b32 v14, v15
    s_nop 1
    v_add_f32 v14, v14, v15
    v_rcp_f32 v14, v14
    s_nop 0
    v_mul_f32 v220, v220, v14
    v_mul_f32 v221, v221, v14
    v_mul_f32 v222, v222, v14
    v_mul_f32 v223, v223, v14
    v_mul_f32 v224, v224, v14
    v_mul_f32 v225, v225, v14
    v_mul_f32 v226, v226, v14
    v_mul_f32 v227, v227, v14
    v_mul_f32 v228, v228, v14
    v_mul_f32 v229, v229, v14
    v_mul_f32 v230, v230, v14
    v_mul_f32 v231, v231, v14
    v_mul_f32 v232, v232, v14
    v_mul_f32 v233, v233, v14
    v_mul_f32 v234, v234, v14
    v_mul_f32 v235, v235, v14
    v_mul_f32 v236, v236, v14
    v_mul_f32 v237, v237, v14
    v_mul_f32 v238, v238, v14
    v_mul_f32 v239, v239, v14
    v_cvt_pk_bf16_f32 v112, v220, v221
    v_cvt_pk_bf16_f32 v113, v222, v223
    v_cvt_pk_bf16_f32 v114, v224, v225
    v_cvt_pk_bf16_f32 v115, v226, v227
    v_cvt_pk_bf16_f32 v116, v228, v229
    v_cvt_pk_bf16_f32 v117, v230, v231
    v_cvt_pk_bf16_f32 v118, v232, v233
    v_cvt_pk_bf16_f32 v119, v234, v235
    v_cvt_pk_bf16_f32 v120, v236, v237
    v_cvt_pk_bf16_f32 v121, v238, v239
    s_nop 1
    v_mfma_f32_32x32x16_bf16 v[16:31], v[160:163], v[112:115], 0
    v_mfma_f32_32x32x16_bf16 v[16:31], v[164:167], v[116:119], v[16:31]
    v_mfma_f32_32x32x16_bf16 v[32:47], v[168:171], v[112:115], 0
    v_mfma_f32_32x32x16_bf16 v[32:47], v[172:175], v[116:119], v[32:47]
    v_mfma_f32_32x32x16_bf16 v[48:63], v[176:179], v[112:115], 0
    v_mfma_f32_32x32x16_bf16 v[48:63], v[180:183], v[116:119], v[48:63]
    v_mfma_f32_32x32x16_bf16 v[64:79], v[184:187], v[112:115], 0
    v_mfma_f32_32x32x16_bf16 v[64:79], v[188:191], v[116:119], v[64:79]
    v_mfma_f32_32x32x16_bf16 v[80:95], v[192:195], v[112:115], 0
    v_mfma_f32_32x32x16_bf16 v[80:95], v[196:199], v[116:119], v[80:95]
    v_mfma_f32_32x32x16_bf16 v[96:111], v[200:203], v[112:115], 0
    v_mfma_f32_32x32x16_bf16 v[96:111], v[204:207], v[116:119], v[96:111]
    s_nop 11
    v_mfma_f32_32x32x8_bf16 v[16:31], v[208:209], v[120:121], v[16:31]
    v_mfma_f32_32x32x8_bf16 v[32:47], v[210:211], v[120:121], v[32:47]
    v_mfma_f32_32x32x8_bf16 v[48:63], v[212:213], v[120:121], v[48:63]
    v_mfma_f32_32x32x8_bf16 v[64:79], v[214:215], v[120:121], v[64:79]
    v_mfma_f32_32x32x8_bf16 v[80:95], v[216:217], v[120:121], v[80:95]
    v_mfma_f32_32x32x8_bf16 v[96:111], v[218:219], v[120:121], v[96:111]
    v_mul_u32_u24 v4, 12288, v1
    v_lshl_add_u32 v4, v2, 6, v4
    v_lshl_add_u32 v4, v3, 4, v4
    v_add_u32 v5, 4096, v4
    v_add_u32 v6, 8192, v4
    s_nop 15
    s_nop 3
    v_cvt_pk_bf16_f32 v128, v16, v17
    v_cvt_pk_bf16_f32 v129, v18, v19
    v_cvt_pk_bf16_f32 v130, v20, v21
    v_cvt_pk_bf16_f32 v131, v22, v23
    s_nop 1
    v_permlane32_swap_b32 v128, v130
    v_permlane32_swap_b32 v129, v131
    buffer_store_dwordx4 v[128:131], v4, s[64:67], 0 offen offset:0 sc1
    v_cvt_pk_bf16_f32 v132, v24, v25
    v_cvt_pk_bf16_f32 v133, v26, v27
    v_cvt_pk_bf16_f32 v134, v28, v29
    v_cvt_pk_bf16_f32 v135, v30, v31
    s_nop 1
    v_permlane32_swap_b32 v132, v134
    v_permlane32_swap_b32 v133, v135
    buffer_store_dwordx4 v[132:135], v4, s[64:67], 0 offen offset:32 sc1
    v_cvt_pk_bf16_f32 v136, v32, v33
    v_cvt_pk_bf16_f32 v137, v34, v35
    v_cvt_pk_bf16_f32 v138, v36, v37
    v_cvt_pk_bf16_f32 v139, v38, v39
    s_nop 1
    v_permlane32_swap_b32 v136, v138
    v_permlane32_swap_b32 v137, v139
    buffer_store_dwordx4 v[136:139], v4, s[64:67], 0 offen offset:2048 sc1
    v_cvt_pk_bf16_f32 v140, v40, v41
    v_cvt_pk_bf16_f32 v141, v42, v43
    v_cvt_pk_bf16_f32 v142, v44, v45
    v_cvt_pk_bf16_f32 v143, v46, v47
    s_nop 1
    v_permlane32_swap_b32 v140, v142
    v_permlane32_swap_b32 v141, v143
    buffer_store_dwordx4 v[140:143], v4, s[64:67], 0 offen offset:2080 sc1
    v_cvt_pk_bf16_f32 v128, v48, v49
    v_cvt_pk_bf16_f32 v129, v50, v51
    v_cvt_pk_bf16_f32 v130, v52, v53
    v_cvt_pk_bf16_f32 v131, v54, v55
    s_nop 1
    v_permlane32_swap_b32 v128, v130
    v_permlane32_swap_b32 v129, v131
    buffer_store_dwordx4 v[128:131], v5, s[64:67], 0 offen offset:0 sc1
    v_cvt_pk_bf16_f32 v132, v56, v57
    v_cvt_pk_bf16_f32 v133, v58, v59
    v_cvt_pk_bf16_f32 v134, v60, v61
    v_cvt_pk_bf16_f32 v135, v62, v63
    s_nop 1
    v_permlane32_swap_b32 v132, v134
    v_permlane32_swap_b32 v133, v135
    buffer_store_dwordx4 v[132:135], v5, s[64:67], 0 offen offset:32 sc1
    v_cvt_pk_bf16_f32 v136, v64, v65
    v_cvt_pk_bf16_f32 v137, v66, v67
    v_cvt_pk_bf16_f32 v138, v68, v69
    v_cvt_pk_bf16_f32 v139, v70, v71
    s_nop 1
    v_permlane32_swap_b32 v136, v138
    v_permlane32_swap_b32 v137, v139
    buffer_store_dwordx4 v[136:139], v5, s[64:67], 0 offen offset:2048 sc1
    v_cvt_pk_bf16_f32 v140, v72, v73
    v_cvt_pk_bf16_f32 v141, v74, v75
    v_cvt_pk_bf16_f32 v142, v76, v77
    v_cvt_pk_bf16_f32 v143, v78, v79
    s_nop 1
    v_permlane32_swap_b32 v140, v142
    v_permlane32_swap_b32 v141, v143
    buffer_store_dwordx4 v[140:143], v5, s[64:67], 0 offen offset:2080 sc1
    v_cvt_pk_bf16_f32 v128, v80, v81
    v_cvt_pk_bf16_f32 v129, v82, v83
    v_cvt_pk_bf16_f32 v130, v84, v85
    v_cvt_pk_bf16_f32 v131, v86, v87
    s_nop 1
    v_permlane32_swap_b32 v128, v130
    v_permlane32_swap_b32 v129, v131
    buffer_store_dwordx4 v[128:131], v6, s[64:67], 0 offen offset:0 sc1
    v_cvt_pk_bf16_f32 v132, v88, v89
    v_cvt_pk_bf16_f32 v133, v90, v91
    v_cvt_pk_bf16_f32 v134, v92, v93
    v_cvt_pk_bf16_f32 v135, v94, v95
    s_nop 1
    v_permlane32_swap_b32 v132, v134
    v_permlane32_swap_b32 v133, v135
    buffer_store_dwordx4 v[132:135], v6, s[64:67], 0 offen offset:32 sc1
    v_cvt_pk_bf16_f32 v136, v96, v97
    v_cvt_pk_bf16_f32 v137, v98, v99
    v_cvt_pk_bf16_f32 v138, v100, v101
    v_cvt_pk_bf16_f32 v139, v102, v103
    s_nop 1
    v_permlane32_swap_b32 v136, v138
    v_permlane32_swap_b32 v137, v139
    buffer_store_dwordx4 v[136:139], v6, s[64:67], 0 offen offset:2048 sc1
    v_cvt_pk_bf16_f32 v140, v104, v105
    v_cvt_pk_bf16_f32 v141, v106, v107
    v_cvt_pk_bf16_f32 v142, v108, v109
    v_cvt_pk_bf16_f32 v143, v110, v111
    s_nop 1
    v_permlane32_swap_b32 v140, v142
    v_permlane32_swap_b32 v141, v143
    buffer_store_dwordx4 v[140:143], v6, s[64:67], 0 offen offset:2080 sc1
    s_waitcnt vmcnt(0)
    s_barrier
    s_cmp_lg_u32 s91, 0
    s_cbranch_scc1 at_sg_173
    s_add_u32 s93, s16, 192
    s_lshl_b32 s93, s93, 8
    v_mov_b32 v254, s93
    v_mov_b32 v255, 1
    s_mov_b64 s[94:95], exec
    s_mov_b64 exec, 1
    buffer_atomic_add v255, v254, s[28:31], 0 offen
    s_mov_b64 exec, s[94:95]
at_sg_173:
    s_branch at_loop_164
at_end_165:
    s_branch rc_kend_3
rc_kend_3:
    s_endpgm
.p2align 8
.globl final_kernel
.type final_kernel,@function
final_kernel:
    s_cmp_ge_u32 s2, 640
    s_cbranch_scc1 fin_done_174
    s_load_dwordx2 s[4:5], s[0:1], 0
    s_load_dwordx2 s[6:7], s[0:1], 96
    s_load_dwordx2 s[8:9], s[0:1], 112
    s_waitcnt lgkmcnt(0)
    s_mov_b32 s12, s4
    s_mov_b32 s13, s5
    s_mov_b32 s14, 0x00280000
    s_mov_b32 s15, 0x00020000
    s_mov_b32 s16, s6
    s_mov_b32 s17, s7
    s_mov_b32 s18, 0x00280000
    s_mov_b32 s19, 0x00020000
    s_add_u32 s20, s8, 0x05200000
    s_addc_u32 s21, s9, 0
    s_mov_b32 s22, 0x00280000
    s_mov_b32 s23, 0x00020000
    s_add_u32 s24, s8, 0x08000000
    s_addc_u32 s25, s9, 0
    s_mov_b32 s26, 0x01400000
    s_mov_b32 s27, 0x00020000
    s_lshl_b32 s3, s2, 8
    v_add_u32 v1, s3, v0
    v_lshlrev_b32 v2, 5, v1
    v_lshlrev_b32 v1, 4, v1
    s_mov_b32 s28, 0x00500000
    s_mov_b32 s29, 0x00a00000
    s_mov_b32 s30, 0x00f00000
    buffer_load_dwordx4 v[44:47], v2, s[24:27], s30 offen
    buffer_load_dwordx4 v[48:51], v2, s[24:27], s30 offen offset:16
    buffer_load_dwordx4 v[4:7], v2, s[24:27], 0 offen
    buffer_load_dwordx4 v[8:11], v2, s[24:27], 0 offen offset:16
    buffer_load_dwordx4 v[12:15], v2, s[24:27], s28 offen
    buffer_load_dwordx4 v[16:19], v2, s[24:27], s28 offen offset:16
    buffer_load_dwordx4 v[20:23], v2, s[24:27], s29 offen
    buffer_load_dwordx4 v[24:27], v2, s[24:27], s29 offen offset:16
    buffer_load_dwordx4 v[28:31], v1, s[12:15], 0 offen
    buffer_load_dwordx4 v[32:35], v1, s[20:23], 0 offen
    s_waitcnt vmcnt(0)
    v_add_f32 v4, v4, v12
    v_add_f32 v20, v20, v44
    v_add_f32 v4, v4, v20
    v_add_f32 v5, v5, v13
    v_add_f32 v21, v21, v45
    v_add_f32 v5, v5, v21
    v_add_f32 v6, v6, v14
    v_add_f32 v22, v22, v46
    v_add_f32 v6, v6, v22
    v_add_f32 v7, v7, v15
    v_add_f32 v23, v23, v47
    v_add_f32 v7, v7, v23
    v_add_f32 v8, v8, v16
    v_add_f32 v24, v24, v48
    v_add_f32 v8, v8, v24
    v_add_f32 v9, v9, v17
    v_add_f32 v25, v25, v49
    v_add_f32 v9, v9, v25
    v_add_f32 v10, v10, v18
    v_add_f32 v26, v26, v50
    v_add_f32 v10, v10, v26
    v_add_f32 v11, v11, v19
    v_add_f32 v27, v27, v51
    v_add_f32 v11, v11, v27
    v_cvt_pk_bf16_f32 v36, v4, v5
    v_and_b32 v5, 0xffff0000, v36
    v_lshlrev_b32 v4, 16, v36
    v_and_b32 v38, 0xffff0000, v32
    v_lshlrev_b32 v37, 16, v32
    v_mul_f32 v4, v4, v37
    v_mul_f32 v5, v5, v38
    v_cvt_pk_bf16_f32 v36, v4, v5
    v_and_b32 v5, 0xffff0000, v36
    v_lshlrev_b32 v4, 16, v36
    v_and_b32 v38, 0xffff0000, v28
    v_lshlrev_b32 v37, 16, v28
    v_add_f32 v4, v4, v37
    v_add_f32 v5, v5, v38
    v_cvt_pk_bf16_f32 v40, v4, v5
    v_cvt_pk_bf16_f32 v36, v6, v7
    v_and_b32 v7, 0xffff0000, v36
    v_lshlrev_b32 v6, 16, v36
    v_and_b32 v38, 0xffff0000, v33
    v_lshlrev_b32 v37, 16, v33
    v_mul_f32 v6, v6, v37
    v_mul_f32 v7, v7, v38
    v_cvt_pk_bf16_f32 v36, v6, v7
    v_and_b32 v7, 0xffff0000, v36
    v_lshlrev_b32 v6, 16, v36
    v_and_b32 v38, 0xffff0000, v29
    v_lshlrev_b32 v37, 16, v29
    v_add_f32 v6, v6, v37
    v_add_f32 v7, v7, v38
    v_cvt_pk_bf16_f32 v41, v6, v7
    v_cvt_pk_bf16_f32 v36, v8, v9
    v_and_b32 v9, 0xffff0000, v36
    v_lshlrev_b32 v8, 16, v36
    v_and_b32 v38, 0xffff0000, v34
    v_lshlrev_b32 v37, 16, v34
    v_mul_f32 v8, v8, v37
    v_mul_f32 v9, v9, v38
    v_cvt_pk_bf16_f32 v36, v8, v9
    v_and_b32 v9, 0xffff0000, v36
    v_lshlrev_b32 v8, 16, v36
    v_and_b32 v38, 0xffff0000, v30
    v_lshlrev_b32 v37, 16, v30
    v_add_f32 v8, v8, v37
    v_add_f32 v9, v9, v38
    v_cvt_pk_bf16_f32 v42, v8, v9
    v_cvt_pk_bf16_f32 v36, v10, v11
    v_and_b32 v11, 0xffff0000, v36
    v_lshlrev_b32 v10, 16, v36
    v_and_b32 v38, 0xffff0000, v35
    v_lshlrev_b32 v37, 16, v35
    v_mul_f32 v10, v10, v37
    v_mul_f32 v11, v11, v38
    v_cvt_pk_bf16_f32 v36, v10, v11
    v_and_b32 v11, 0xffff0000, v36
    v_lshlrev_b32 v10, 16, v36
    v_and_b32 v38, 0xffff0000, v31
    v_lshlrev_b32 v37, 16, v31
    v_add_f32 v10, v10, v37
    v_add_f32 v11, v11, v38
    v_cvt_pk_bf16_f32 v43, v10, v11
    buffer_store_dwordx4 v[40:43], v1, s[16:19], 0 offen
fin_done_174:
    s_endpgm
.section .rodata,"a"
.p2align 6
.amdhsa_kernel mega_kernel
  .amdhsa_next_free_vgpr 496
  .amdhsa_next_free_sgpr 102
  .amdhsa_accum_offset 256
  .amdhsa_group_segment_fixed_size 0
  .amdhsa_kernarg_size 120
  .amdhsa_user_sgpr_count 2
  .amdhsa_user_sgpr_kernarg_segment_ptr 1
  .amdhsa_system_sgpr_workgroup_id_x 1
.end_amdhsa_kernel
.p2align 6
.amdhsa_kernel final_kernel
  .amdhsa_next_free_vgpr 52
  .amdhsa_next_free_sgpr 40
  .amdhsa_accum_offset 52
  .amdhsa_group_segment_fixed_size 0
  .amdhsa_kernarg_size 120
  .amdhsa_user_sgpr_count 2
  .amdhsa_user_sgpr_kernarg_segment_ptr 1
  .amdhsa_system_sgpr_workgroup_id_x 1
.end_amdhsa_kernel
```
